```python
import torch

def _softmax(x, axis=-1):
    return torch.softmax(x, dim=axis)
def _gelu(x):
    return torch.nn.functional.gelu(x, approximate="tanh")
def _silu(x):
    return torch.nn.functional.silu(x)
def _sigmoid(x):
    return torch.sigmoid(x)
def _layernorm(x, axis=-1, eps=1e-5):
    m = x.mean(dim=axis, keepdim=True)
    v = x.var(dim=axis, keepdim=True, unbiased=False)
    return (x - m) / torch.sqrt(v + eps)
def _scatter_add(tgt, idx, src, axis=0):
    return tgt.clone().index_add_(axis, idx, src)
def _segment_sum(src, seg, n):
    out = torch.zeros((n,) + src.shape[1:], dtype=src.dtype)
    return out.index_add_(0, seg, src)
def _pad(x, pw):
    flat = tuple(v for pair in reversed(pw) for v in pair)
    return torch.nn.functional.pad(x, flat)

kernel_name = 'recurrent_scan__sliding_block__swiglu_ffn__prompt'

def setup_inputs():

    _w = (lambda a: (lambda t: t.to(torch.bfloat16) if t.is_floating_point() else t)(torch.as_tensor(a)))
    def _A_setup():
        B, S, D = 1, 2048, 640
        return {
            "x": _w((lambda *s: torch.randn(*s, dtype=torch.bfloat16) * 0.05)(B, S, D)),
            "wqkv": _w((lambda *s: torch.randn(*s, dtype=torch.bfloat16) * 0.05)(D, 3 * D)),
            "wo": _w((lambda *s: torch.randn(*s, dtype=torch.bfloat16) * 0.05)(D, D)),
        }
    _A_in = _A_setup()

    def _B_setup():
        B, S, D, F = 1, 2048, 640, 1536
        return {
            "x": _w((lambda *s: torch.randn(*s, dtype=torch.bfloat16) * 0.05)(B, S, D)),
            "w_gate": _w((lambda *s: torch.randn(*s, dtype=torch.bfloat16) * 0.05)(D, F)),
            "w_up": _w((lambda *s: torch.randn(*s, dtype=torch.bfloat16) * 0.05)(D, F)),
            "w_down": _w((lambda *s: torch.randn(*s, dtype=torch.bfloat16) * 0.05)(F, D)),
        }
    _B_in = _B_setup()

    return {
        "A_x": _A_in["x"],
        "A_wqkv": _A_in["wqkv"],
        "A_wo": _A_in["wo"],
        "B_x": _B_in["x"],
        "B_w_gate": _B_in["w_gate"],
        "B_w_up": _B_in["w_up"],
        "B_w_down": _B_in["w_down"],
    }

def reference(A_x, A_wqkv, A_wo, B_x, B_w_gate, B_w_up, B_w_down):
    def _A_ref(x, wqkv, wo):
        B, S, D = x.shape
        H = 32; Dh = D // H; W = 256
        qkv = (lambda x, *d: x.permute(*d))((x @ wqkv).reshape(B, S, 3, H, Dh), 2, 0, 3, 1, 4)
        q, k, v = qkv[0], qkv[1], qkv[2]
        scores = torch.einsum("bhqd,bhkd->bhqk", q, k) * (Dh ** -0.5)
        idx = torch.arange(S)
        mask = (idx[:, None] - idx[None, :] >= 0) & (idx[:, None] - idx[None, :] < W)
        scores = torch.where(mask[None, None], scores, -1e9)
        p = _softmax(scores, axis=-1)
        o = torch.einsum("bhqk,bhkd->bhqd", p, v)
        return (lambda x, *d: x.permute(*d))(o, 0, 2, 1, 3).reshape(B, S, D) @ wo

    def _B_ref(x, w_gate, w_up, w_down):
        g = _silu(x @ w_gate)
        u = x @ w_up
        return (g * u) @ w_down

    x = A_x
    xn = _layernorm(x, axis=-1)
    s = _A_ref(xn, A_wqkv, A_wo)
    g = _silu(_B_ref(xn, B_w_gate, B_w_up, B_w_down))
    return x + s * g
```

```asm
; @launch grid=(256,1,1) block=(256,1,1) lds=163840
.amdgcn_target "amdgcn-amd-amdhsa--gfx950"
.text
.globl recurrent_scan__sliding_block__swiglu_ffn__prompt_kernel
.p2align 8
.type recurrent_scan__sliding_block__swiglu_ffn__prompt_kernel,@function
recurrent_scan__sliding_block__swiglu_ffn__prompt_kernel:
    s_cmp_ge_u32 s2, 256
    s_cbranch_scc1 L_end
    s_load_dwordx4 s[24:27], s[0:1], 0
    s_getpc_b64 s[68:69]
L_pc:
    s_lshr_b32 s57, s2, 3
    s_lshl_b32 s57, s57, 11
    s_min_u32 s57, s57, L_codeend-L_pc-2048
    v_lshlrev_b32 v80, 3, v0
    v_add_u32 v80, s57, v80
    global_load_dword v95, v80, s[68:69]
    v_and_b32 v1, 63, v0
    v_lshrrev_b32 v80, 6, v0
    s_and_b32 s56, s2, 7
    s_lshr_b32 s57, s2, 3
    v_readfirstlane_b32 s54, v80
    s_and_b32 s52, s56, 1
    s_lshl_b32 s52, s52, 3
    s_lshr_b32 s58, s57, 2
    s_add_u32 s52, s52, s58
    s_lshr_b32 s53, s56, 1
    s_lshl_b32 s53, s53, 2
    s_and_b32 s57, s57, 3
    s_add_u32 s53, s53, s57
    s_lshl_b32 s55, s52, 4
    s_add_u32 s55, s55, s53
    s_lshl_b32 s60, s54, 12
    s_lshl_b32 s56, s52, 2
    s_add_u32 s56, s56, s54
    s_mul_i32 s56, s56, 40960
    v_lshrrev_b32 v81, 3, v1
    v_lshrrev_b32 v82, 4, v1
    v_and_b32 v83, 7, v1
    v_mul_u32_u24 v84, 1280, v81
    v_xor_b32 v80, v82, v83
    v_lshl_add_u32 v80, v80, 4, v84
    v_add_u32 v32, s56, v80
    v_xor_b32 v33, 64, v32
    s_mul_i32 s56, s55, 10240
    s_mul_i32 s57, s54, 2560
    s_add_u32 s56, s56, s57
    v_min_u32 v80, 19, v1
    v_lshl_add_u32 v22, v80, 7, s56
    s_lshl_b32 s57, s53, 8
    s_cmp_eq_u32 s53, 15
    s_cselect_b32 s57, 2146435072, s57
    s_mul_i32 s58, s52, 38400
    s_add_u32 s57, s57, s58
    s_mul_i32 s58, s54, 5
    v_min_u32 v80, 4, v1
    v_add_u32 v80, s58, v80
    v_lshrrev_b32 v91, 1, v80
    v_mul_u32_u24 v91, 3584, v91
    v_lshl_add_u32 v80, v80, 7, v91
    v_add_u32 v37, s57, v80
    s_mov_b32 s30, 2457600
    s_mov_b32 s31, 0x20000
    s_mov_b32 s42, 2621440
    s_mov_b32 s43, 0x20000
    s_mov_b32 s50, 256
    s_mov_b32 s51, 0x20000
    s_mov_b32 s46, 33554432
    s_mov_b32 s47, 0x20000
    v_and_b32 v92, 15, v1
    v_bfe_u32 v80, v1, 1, 3
    v_xor_b32 v80, v80, v82
    v_lshlrev_b32 v80, 4, v80
    v_lshl_add_u32 v80, v92, 7, v80
    v_add_u32 v40, s60, v80
    v_xor_b32 v41, 64, v40
    v_mov_b32 v44, 0
    v_mov_b32 v45, 0
    v_mov_b32 v46, 0
    s_waitcnt lgkmcnt(0)
    s_mov_b32 s28, s26
    s_mov_b32 s29, s27
    s_mov_b32 s26, 2621440
    s_mov_b32 s27, 0x20000
    s_mov_b64 exec, 1048575
    buffer_load_dword v19, v22, s[24:27], 0 offen
    s_mov_b64 exec, -1
    s_add_u32 m0, s60, 0
    s_mov_b32 s95, 0
    buffer_load_dwordx4 v32, s[24:27], s95 offen offset:0 lds
    s_load_dwordx2 s[36:37], s[0:1], 48
    s_load_dwordx2 s[38:39], s[0:1], 16
    s_mov_b32 s61, 9216
    buffer_load_dwordx4 v33, s[24:27], s61 offen offset:1024 lds
    s_load_dwordx2 s[40:41], s[0:1], 56
    s_load_dwordx2 s[48:49], s[0:1], 64
    s_mov_b32 s95, 18432
    buffer_load_dwordx4 v32, s[24:27], s95 offen offset:2048 lds
    s_load_dwordx2 s[44:45], s[0:1], 72
    s_load_dwordx4 s[32:35], s[0:1], 32
    s_mov_b32 s61, 27648
    buffer_load_dwordx4 v33, s[24:27], s61 offen offset:3072 lds
    v_mov_b32 v47, 0
    s_mov_b32 s76, 0x3f803f80
    s_mov_b32 s95, 0
    s_mov_b64 exec, 31
    buffer_load_dword v19, v37, s[28:31], s95 offen
    s_mov_b64 exec, -1
    s_mov_b32 s61, 614400
    s_mov_b64 exec, 31
    buffer_load_dword v19, v37, s[28:31], s61 offen
    s_mov_b64 exec, -1
    s_lshl_b32 s56, s54, 8
    s_add_u32 s56, s56, s55
    s_mul_i32 s57, s56, 6554
    s_lshr_b32 s57, s57, 16
    s_mul_i32 s58, s57, 10
    s_sub_u32 s58, s56, s58
    s_cmp_ge_u32 s57, 48
    s_cselect_b32 s59, 48, 0
    s_cselect_b32 s65, 1, 0
    s_sub_u32 s59, s57, s59
    s_mul_i32 s59, s59, 40960
    s_lshl_b32 s58, s58, 7
    s_add_u32 s59, s59, s58
    s_sub_u32 s57, s56, 680
    s_mul_i32 s58, s57, 1639
    s_lshr_b32 s58, s58, 16
    s_mul_i32 s83, s58, 40
    s_sub_u32 s83, s57, s83
    s_lshr_b32 s83, s83, 1
    s_mul_i32 s83, s83, 98304
    s_mul_i32 s58, s58, 384
    s_add_u32 s58, s58, s83
    s_add_u32 s58, s58, 128
    s_and_b32 s57, s57, 1
    s_add_u32 s57, s57, 2
    s_movk_i32 s83, 1280
    s_cmp_ge_u32 s56, 680
    s_cselect_b32 s59, s58, s59
    s_cselect_b32 s65, s57, s65
    s_cselect_b32 s83, 3072, s83
    s_lshl_b32 s57, s56, 12
    s_add_u32 s57, s57, 19922944
    s_cmp_ge_u32 s56, 1000
    s_cselect_b32 s57, 2146435072, s57
    s_cselect_b32 s59, 2146435072, s59
    v_mul_u32_u24 v80, s83, v81
    v_lshl_add_u32 v80, v83, 4, v80
    v_add_u32 v35, s59, v80
    s_lshl_b32 s83, s83, 3
    s_sub_u32 s83, s83, 1024
    v_lshlrev_b32 v10, 4, v1
    v_add_u32 v11, 4096, v10
    v_add_u32 v43, s57, v10
    s_lshl_b32 s59, s52, 13
    s_lshr_b32 s56, s53, 2
    s_lshl_b32 s56, s56, 1
    s_lshr_b32 s57, s54, 1
    s_add_u32 s56, s56, s57
    s_lshl_b32 s56, s56, 7
    s_and_b32 s57, s53, 3
    s_lshl_b32 s57, s57, 3
    s_add_u32 s56, s56, s57
    s_and_b32 s57, s54, 1
    s_lshl_b32 s57, s57, 2
    s_add_u32 s56, s56, s57
    s_add_u32 s56, s56, s59
    s_add_u32 s5, s56, 2048
    s_add_u32 s6, s56, 3072
    s_add_u32 s7, s56, 4096
    s_lshl_b32 s58, s53, 4
    s_add_u32 s81, s58, s59
    s_add_u32 s58, s58, s54
    s_lshl_b32 s58, s58, 2
    s_add_u32 s58, s58, s59
    s_add_u32 s4, s58, 1024
    s_cmp_eq_u32 s54, 0
    s_cselect_b32 s81, s81, 2146435072
    s_lshl_b32 s56, s53, 2
    s_add_u32 s56, s56, s54
    s_lshl_b32 s77, s52, 2
    s_cmp_eq_u32 s56, 60
    s_cselect_b32 s77, s77, 2146435072
    s_cselect_b32 s82, s59, 2146435072
    v_mov_b32 v30, 1
    s_and_b32 s58, s54, 1
    s_lshr_b32 s56, s54, 1
    s_lshl_b32 s56, s56, 2
    s_add_u32 s56, s56, s58
    s_mul_i32 s56, s56, 30720
    s_lshl_b32 s57, s53, 8
    s_add_u32 s56, s56, s57
    s_lshl_b32 s58, s58, 3
    s_cmp_eq_u32 s53, 15
    s_cselect_b32 s56, 2146435072, s56
    v_mul_u32_u24 v80, 3840, v82
    v_add_u32 v80, s56, v80
    v_lshl_add_u32 v91, v82, 1, s58
    v_xor_b32 v91, v91, v92
    v_lshl_add_u32 v34, v91, 4, v80
    v_and_b32 v85, 1, v82
    v_lshrrev_b32 v86, 5, v1
    v_bfe_u32 v87, v1, 2, 2
    v_and_b32 v93, 3, v1
    v_lshlrev_b32 v88, 3, v93
    v_lshl_add_u32 v90, v85, 1, v86
    v_lshl_add_u32 v89, v85, 2, v87
    v_lshl_add_u32 v80, v89, 5, v88
    v_lshl_add_u32 v80, v87, 8, v80
    v_lshl_add_u32 v56, v90, 11, v80
    v_xor_b32 v57, 32, v56
    v_xor_b32 v58, 64, v56
    v_xor_b32 v59, 96, v56
    v_xor_b32 v60, 128, v56
    v_xor_b32 v61, 160, v56
    v_xor_b32 v62, 192, v56
    v_xor_b32 v63, 224, v56
    v_mov_b32 v18, v10
    v_lshrrev_b32 v80, 1, v89
    v_lshl_add_u32 v80, v80, 5, v88
    v_lshl_add_u32 v80, v89, 7, v80
    v_lshl_add_u32 v3, v86, 11, v80
    v_xor_b32 v4, 32, v3
    v_xor_b32 v5, 64, v3
    v_xor_b32 v6, 96, v3
    v_lshl_add_u32 v80, v82, 3, v87
    v_lshl_add_u32 v80, v80, 7, v88
    v_add_u32 v42, s60, v80
    s_and_b32 s56, s54, 1
    s_lshr_b32 s57, s54, 1
    s_and_b32 s58, s53, 1
    s_mul_i32 s59, s53, 192
    s_lshl_b32 s8, s58, 6
    s_add_u32 s8, s8, s59
    s_mul_i32 s64, s56, 98304
    s_add_u32 s64, s64, s8
    v_lshlrev_b32 v80, 1, v82
    v_xor_b32 v80, v80, v83
    v_lshl_add_u32 v91, v86, 2, v81
    v_mul_u32_u24 v91, 3072, v91
    v_lshl_add_u32 v80, v80, 4, v91
    v_add_u32 v2, s64, v80
    s_lshr_b32 s101, s53, 1
    s_mul_i32 s101, s101, 20
    s_add_u32 s101, s101, s54
    s_lshl_b32 s101, s101, 2
    s_add_u32 s101, s101, s58
    s_lshl_b32 s101, s101, 11
    s_add_u32 s101, s101, 22708224
    s_xor_b32 s58, s58, 1
    s_lshl_b32 s58, s58, 7
    s_add_u32 s9, s59, s58
    s_lshl_b32 s58, s52, 1
    s_add_u32 s58, s58, s56
    s_mul_i32 s58, s58, 61440
    s_add_u32 s58, s58, s8
    v_min_u32 v80, 9, v1
    v_mul_u32_u24 v80, 3072, v80
    v_add_u32 v36, s58, v80
    s_lshl_b32 s58, s52, 1
    s_add_u32 s58, s58, s57
    s_mul_i32 s10, s58, 81920
    s_mul_i32 s58, s58, 196608
    s_add_u32 s58, s58, 9437184
    s_lshl_b32 s8, s8, 6
    s_add_u32 s8, s8, s58
    s_lshl_b32 s9, s9, 6
    s_add_u32 s9, s9, s58
    s_mul_i32 s58, s53, 5120
    s_add_u32 s10, s10, s58
    s_add_u32 s10, s10, 16777216
    v_lshlrev_b32 v80, 4, v92
    v_lshl_add_u32 v7, v90, 11, v80
    s_lshl_b32 s58, s56, 9
    v_lshl_add_u32 v80, v90, 10, v80
    v_add_u32 v8, s58, v80
    v_lshlrev_b32 v9, 2, v92
    s_lshl_b32 s58, s54, 15
    v_lshlrev_b32 v80, 13, v82
    v_lshl_add_u32 v80, v92, 4, v80
    v_add_u32 v21, s58, v80
    s_mul_i32 s58, s53, 5
    s_mul_i32 s59, s57, 80
    s_add_u32 s59, s59, 80
    v_cmp_eq_u32 vcc, 3, v87
    v_mov_b32 v80, s59
    v_lshlrev_b32 v91, 1, v1
    v_cndmask_b32_e64 v80, v80, 0, vcc
    v_and_b32 v91, 4, v91
    v_add3_u32 v80, v80, v91, s58
    v_lshrrev_b32 v80, 4, v80
    s_lshl_b32 s58, s56, 1
    v_and_or_b32 v91, v1, 1, s58
    v_mov_b32 v94, s54
    v_cndmask_b32 v91, v91, v94, vcc
    v_lshl_add_u32 v80, v80, 4, v91
    s_sub_u32 s58, s52, 2
    v_min_u32 v91, 2, v87
    v_add_u32 v91, s58, v91
    v_max_i32 v91, 0, v91
    v_lshlrev_b32 v91, 13, v91
    v_lshl_add_u32 v20, v80, 2, v91
    s_mul_i32 s59, s53, 10240
    s_add_u32 s93, s59, 1048576
    s_mul_i32 s15, s57, 163840
    s_add_u32 s15, s15, s93
    s_lshl_b32 s58, s56, 10
    s_add_u32 s15, s15, s58
    s_add_u32 s15, s15, 163840
    s_cmp_eq_u32 s57, 0
    s_mov_b32 s84, 129024
    s_cselect_b32 s84, 98304, s84
    s_mov_b32 s85, 135488
    s_cselect_b32 s85, 104448, s85
    s_mov_b32 s86, 141952
    s_cselect_b32 s86, 110592, s86
    s_mov_b32 s87, 148224
    s_cselect_b32 s87, 116736, s87
    s_mov_b32 s88, 154688
    s_cselect_b32 s88, 122880, s88
    s_add_u32 s84, s84, s58
    s_add_u32 s85, s85, s58
    s_add_u32 s86, s86, s58
    s_add_u32 s87, s87, s58
    s_add_u32 s88, s88, s58
    s_sub_u32 s58, s52, 2
    s_max_i32 s58, s58, 0
    s_mul_i32 s78, s58, 491520
    s_sub_u32 s58, s52, 1
    s_max_i32 s58, s58, 0
    s_mul_i32 s79, s58, 491520
    s_sub_u32 s58, s52, 0
    s_max_i32 s58, s58, 0
    s_mul_i32 s80, s58, 491520
    s_lshl_b32 s58, s54, 9
    s_add_u32 s93, s93, s58
    s_add_u32 s93, s93, s80
    s_add_u32 s78, s78, s15
    s_add_u32 s79, s79, s15
    s_add_u32 s80, s80, s15
    s_mul_i32 s64, s52, 491520
    s_lshl_b32 s59, s53, 15
    s_add_u32 s64, s64, s59
    s_add_u32 s64, s64, s58
    s_add_u32 s64, s64, 1048576
    s_cmp_eq_u32 s53, 15
    s_cselect_b32 s64, 2146435072, s64
    s_cmp_lt_u32 s53, 5
    s_cselect_b32 s63, 0x3ea52b5c, 1.0
    s_mov_b32 s62, 0xffff0000
    s_mov_b32 s66, 0
    s_mov_b32 s67, -1
    s_mov_b32 s72, 0xbfb8aa3b
    s_lshl_b32 s16, s52, 7
    s_sub_u32 s16, 256, s16
    s_bfe_u32 s56, s53, 0x10002
    s_lshr_b32 s57, s53, 3
    s_lshl_b32 s57, s57, 2
    s_and_b32 s58, s53, 3
    s_add_u32 s57, s57, s58
    s_mul_i32 s58, s57, 5120
    s_add_u32 s58, s58, 19922944
    s_mul_i32 s91, s54, 491520
    s_add_u32 s91, s91, s58
    s_mul_i32 s92, s54, 204800
    s_add_u32 s92, s92, s58
    s_add_u32 s92, s92, 1966080
    s_mul_i32 s94, s54, 20480
    s_lshl_b32 s58, s52, 1
    s_add_u32 s58, s58, s56
    s_mul_i32 s89, s58, 196608
    s_mul_i32 s59, s54, 49152
    s_add_u32 s89, s89, s59
    s_add_u32 s89, s89, 9437184
    s_mul_i32 s90, s58, 81920
    s_add_u32 s90, s90, s94
    s_add_u32 s90, s90, 16777216
    s_and_b32 s59, s57, 0
    s_xor_b32 s15, s59, s54
    s_lshl_b32 s58, s58, 2
    s_add_u32 s58, s58, s15
    s_mul_i32 s14, s58, 20480
    s_mul_i32 s57, s57, 160
    s_add_u32 s14, s14, s57
    s_add_u32 s75, s60, 61440
    s_lshl_b32 s58, s52, 5
    s_add_u32 s58, s58, s54
    s_lshl_b32 s58, s58, 1
    s_add_u32 s58, s58, s56
    s_lshl_b32 s58, s58, 7
    s_add_u32 s11, s58, 2048
    s_add_u32 s12, s58, 3072
    s_add_u32 s13, s58, 4096
    s_lshl_b32 s15, s15, 8
    s_xor_b32 s56, s54, 1
    s_mul_i32 s56, s56, 15360
    s_add_u32 s17, s56, 0
    s_xor_b32 s56, s54, 2
    s_mul_i32 s56, s56, 15360
    s_add_u32 s18, s56, 5120
    s_xor_b32 s56, s54, 3
    s_mul_i32 s56, s56, 15360
    s_add_u32 s19, s56, 10240
    s_mul_i32 s20, s54, 15360
    v_lshlrev_b32 v80, 4, v93
    v_mov_b32 v38, 0x3f80
    v_mov_b32 v39, 0
    v_lshlrev_b64 v[38:39], v80, v[38:39]
    s_mov_b32 s100, 0
    s_cmp_eq_u32 s65, 1
    s_waitcnt lgkmcnt(0)
    s_cselect_b32 s36, s38, s36
    s_cselect_b32 s37, s39, s37
    s_cmp_eq_u32 s65, 2
    s_cselect_b32 s36, s32, s36
    s_cselect_b32 s37, s33, s37
    s_cmp_eq_u32 s65, 3
    s_cselect_b32 s36, s34, s36
    s_cselect_b32 s37, s35, s37
    s_mov_b32 s38, 1966080
    s_cmp_eq_u32 s65, 1
    s_cselect_b32 s38, 819200, s38
    s_mov_b32 s39, 0x20000
    s_cmp_ge_u32 s54, 2
    s_cselect_b32 s32, s34, s32
    s_cselect_b32 s33, s35, s33
    s_mov_b32 s34, 1966080
    s_mov_b32 s35, 0x20000
    s_add_u32 m0, s60, 16384
    s_mov_b32 s95, 128
    buffer_load_dwordx4 v32, s[24:27], s95 offen offset:0 lds
    s_mov_b32 s61, 9344
    buffer_load_dwordx4 v33, s[24:27], s61 offen offset:1024 lds
    s_mov_b32 s95, 18560
    buffer_load_dwordx4 v32, s[24:27], s95 offen offset:2048 lds
    s_mov_b32 s61, 27776
    buffer_load_dwordx4 v33, s[24:27], s61 offen offset:3072 lds
    s_add_u32 m0, s60, 32768
    s_mov_b32 s95, 256
    buffer_load_dwordx4 v32, s[24:27], s95 offen offset:0 lds
    s_mov_b32 s61, 9472
    buffer_load_dwordx4 v33, s[24:27], s61 offen offset:1024 lds
    s_mov_b32 s95, 18688
    buffer_load_dwordx4 v32, s[24:27], s95 offen offset:2048 lds
    s_mov_b32 s61, 27904
    buffer_load_dwordx4 v33, s[24:27], s61 offen offset:3072 lds
    s_waitcnt vmcnt(10)
    ds_read_b128 v[96:99], v40 offset:0
    ds_read_b128 v[100:103], v40 offset:2048
    ds_read_b128 v[104:107], v41 offset:0
    ds_read_b128 v[108:111], v41 offset:2048
    s_add_u32 m0, s60, 49152
    s_mov_b32 s95, 384
    buffer_load_dwordx4 v32, s[24:27], s95 offen offset:0 lds
    s_mov_b32 s61, 9600
    buffer_load_dwordx4 v33, s[24:27], s61 offen offset:1024 lds
    s_mov_b32 s95, 18816
    buffer_load_dwordx4 v32, s[24:27], s95 offen offset:2048 lds
    s_mov_b32 s61, 28032
    buffer_load_dwordx4 v33, s[24:27], s61 offen offset:3072 lds
    s_waitcnt vmcnt(8)
    ds_read_b128 v[112:115], v40 offset:16384
    ds_read_b128 v[116:119], v40 offset:18432
    ds_read_b128 v[120:123], v41 offset:16384
    ds_read_b128 v[124:127], v41 offset:18432
    s_add_u32 m0, s60, 65536
    s_mov_b32 s95, 512
    buffer_load_dwordx4 v32, s[24:27], s95 offen offset:0 lds
    s_waitcnt lgkmcnt(7)
    v_dot2c_f32_bf16 v44, s76, v96
    v_dot2c_f32_bf16 v46, v96, v96
    v_dot2c_f32_bf16 v44, s76, v97
    v_dot2c_f32_bf16 v46, v97, v97
    v_dot2c_f32_bf16 v44, s76, v98
    v_dot2c_f32_bf16 v46, v98, v98
    v_dot2c_f32_bf16 v44, s76, v99
    v_dot2c_f32_bf16 v46, v99, v99
    s_mov_b32 s61, 9728
    buffer_load_dwordx4 v33, s[24:27], s61 offen offset:1024 lds
    s_waitcnt lgkmcnt(6)
    v_dot2c_f32_bf16 v45, s76, v100
    v_dot2c_f32_bf16 v47, v100, v100
    v_dot2c_f32_bf16 v45, s76, v101
    v_dot2c_f32_bf16 v47, v101, v101
    v_dot2c_f32_bf16 v45, s76, v102
    v_dot2c_f32_bf16 v47, v102, v102
    v_dot2c_f32_bf16 v45, s76, v103
    v_dot2c_f32_bf16 v47, v103, v103
    s_mov_b32 s95, 18944
    buffer_load_dwordx4 v32, s[24:27], s95 offen offset:2048 lds
    s_waitcnt lgkmcnt(5)
    v_dot2c_f32_bf16 v44, s76, v104
    v_dot2c_f32_bf16 v46, v104, v104
    v_dot2c_f32_bf16 v44, s76, v105
    v_dot2c_f32_bf16 v46, v105, v105
    v_dot2c_f32_bf16 v44, s76, v106
    v_dot2c_f32_bf16 v46, v106, v106
    v_dot2c_f32_bf16 v44, s76, v107
    v_dot2c_f32_bf16 v46, v107, v107
    s_mov_b32 s61, 28160
    buffer_load_dwordx4 v33, s[24:27], s61 offen offset:3072 lds
    s_waitcnt lgkmcnt(4)
    v_dot2c_f32_bf16 v45, s76, v108
    v_dot2c_f32_bf16 v47, v108, v108
    v_dot2c_f32_bf16 v45, s76, v109
    v_dot2c_f32_bf16 v47, v109, v109
    v_dot2c_f32_bf16 v45, s76, v110
    v_dot2c_f32_bf16 v47, v110, v110
    v_dot2c_f32_bf16 v45, s76, v111
    v_dot2c_f32_bf16 v47, v111, v111
    s_waitcnt vmcnt(8)
    ds_read_b128 v[128:131], v40 offset:32768
    ds_read_b128 v[132:135], v40 offset:34816
    ds_read_b128 v[136:139], v41 offset:32768
    ds_read_b128 v[140:143], v41 offset:34816
    s_add_u32 m0, s60, 81920
    s_mov_b32 s95, 640
    buffer_load_dwordx4 v32, s[24:27], s95 offen offset:0 lds
    s_waitcnt lgkmcnt(7)
    v_dot2c_f32_bf16 v44, s76, v112
    v_dot2c_f32_bf16 v46, v112, v112
    v_dot2c_f32_bf16 v44, s76, v113
    v_dot2c_f32_bf16 v46, v113, v113
    v_dot2c_f32_bf16 v44, s76, v114
    v_dot2c_f32_bf16 v46, v114, v114
    v_dot2c_f32_bf16 v44, s76, v115
    v_dot2c_f32_bf16 v46, v115, v115
    s_mov_b32 s61, 9856
    buffer_load_dwordx4 v33, s[24:27], s61 offen offset:1024 lds
    s_waitcnt lgkmcnt(6)
    v_dot2c_f32_bf16 v45, s76, v116
    v_dot2c_f32_bf16 v47, v116, v116
    v_dot2c_f32_bf16 v45, s76, v117
    v_dot2c_f32_bf16 v47, v117, v117
    v_dot2c_f32_bf16 v45, s76, v118
    v_dot2c_f32_bf16 v47, v118, v118
    v_dot2c_f32_bf16 v45, s76, v119
    v_dot2c_f32_bf16 v47, v119, v119
    s_mov_b32 s95, 19072
    buffer_load_dwordx4 v32, s[24:27], s95 offen offset:2048 lds
    s_waitcnt lgkmcnt(5)
    v_dot2c_f32_bf16 v44, s76, v120
    v_dot2c_f32_bf16 v46, v120, v120
    v_dot2c_f32_bf16 v44, s76, v121
    v_dot2c_f32_bf16 v46, v121, v121
    v_dot2c_f32_bf16 v44, s76, v122
    v_dot2c_f32_bf16 v46, v122, v122
    v_dot2c_f32_bf16 v44, s76, v123
    v_dot2c_f32_bf16 v46, v123, v123
    s_mov_b32 s61, 28288
    buffer_load_dwordx4 v33, s[24:27], s61 offen offset:3072 lds
    s_waitcnt lgkmcnt(4)
    v_dot2c_f32_bf16 v45, s76, v124
    v_dot2c_f32_bf16 v47, v124, v124
    v_dot2c_f32_bf16 v45, s76, v125
    v_dot2c_f32_bf16 v47, v125, v125
    v_dot2c_f32_bf16 v45, s76, v126
    v_dot2c_f32_bf16 v47, v126, v126
    v_dot2c_f32_bf16 v45, s76, v127
    v_dot2c_f32_bf16 v47, v127, v127
    s_mov_b64 exec, 0
    s_cmp_eq_u32 s54, 0
    s_cbranch_scc1 L_page0
    s_cmp_eq_u32 s54, 1
    s_cbranch_scc1 L_page1
    s_cmp_eq_u32 s54, 2
    s_cbranch_scc1 L_page2
    s_branch L_page3
L_tret0:
    s_mov_b64 exec, -1
    s_waitcnt vmcnt(8)
    ds_read_b128 v[144:147], v40 offset:49152
    ds_read_b128 v[148:151], v40 offset:51200
    ds_read_b128 v[152:155], v41 offset:49152
    ds_read_b128 v[156:159], v41 offset:51200
    s_add_u32 m0, s60, 98304
    s_mov_b32 s95, 768
    buffer_load_dwordx4 v32, s[24:27], s95 offen offset:0 lds
    s_waitcnt lgkmcnt(7)
    v_dot2c_f32_bf16 v44, s76, v128
    v_dot2c_f32_bf16 v46, v128, v128
    v_dot2c_f32_bf16 v44, s76, v129
    v_dot2c_f32_bf16 v46, v129, v129
    v_dot2c_f32_bf16 v44, s76, v130
    v_dot2c_f32_bf16 v46, v130, v130
    v_dot2c_f32_bf16 v44, s76, v131
    v_dot2c_f32_bf16 v46, v131, v131
    s_mov_b32 s61, 9984
    buffer_load_dwordx4 v33, s[24:27], s61 offen offset:1024 lds
    s_waitcnt lgkmcnt(6)
    v_dot2c_f32_bf16 v45, s76, v132
    v_dot2c_f32_bf16 v47, v132, v132
    v_dot2c_f32_bf16 v45, s76, v133
    v_dot2c_f32_bf16 v47, v133, v133
    v_dot2c_f32_bf16 v45, s76, v134
    v_dot2c_f32_bf16 v47, v134, v134
    v_dot2c_f32_bf16 v45, s76, v135
    v_dot2c_f32_bf16 v47, v135, v135
    s_mov_b32 s95, 19200
    buffer_load_dwordx4 v32, s[24:27], s95 offen offset:2048 lds
    s_waitcnt lgkmcnt(5)
    v_dot2c_f32_bf16 v44, s76, v136
    v_dot2c_f32_bf16 v46, v136, v136
    v_dot2c_f32_bf16 v44, s76, v137
    v_dot2c_f32_bf16 v46, v137, v137
    v_dot2c_f32_bf16 v44, s76, v138
    v_dot2c_f32_bf16 v46, v138, v138
    v_dot2c_f32_bf16 v44, s76, v139
    v_dot2c_f32_bf16 v46, v139, v139
    s_mov_b32 s61, 28416
    buffer_load_dwordx4 v33, s[24:27], s61 offen offset:3072 lds
    s_waitcnt lgkmcnt(4)
    v_dot2c_f32_bf16 v45, s76, v140
    v_dot2c_f32_bf16 v47, v140, v140
    v_dot2c_f32_bf16 v45, s76, v141
    v_dot2c_f32_bf16 v47, v141, v141
    v_dot2c_f32_bf16 v45, s76, v142
    v_dot2c_f32_bf16 v47, v142, v142
    v_dot2c_f32_bf16 v45, s76, v143
    v_dot2c_f32_bf16 v47, v143, v143
    v_add_u32 v40, 65536, v40
    v_add_u32 v41, 65536, v41
    s_waitcnt vmcnt(8)
    ds_read_b128 v[160:163], v40 offset:0
    ds_read_b128 v[164:167], v40 offset:2048
    ds_read_b128 v[168:171], v41 offset:0
    ds_read_b128 v[172:175], v41 offset:2048
    s_add_u32 m0, s60, 114688
    s_mov_b32 s95, 896
    buffer_load_dwordx4 v32, s[24:27], s95 offen offset:0 lds
    s_waitcnt lgkmcnt(7)
    v_dot2c_f32_bf16 v44, s76, v144
    v_dot2c_f32_bf16 v46, v144, v144
    v_dot2c_f32_bf16 v44, s76, v145
    v_dot2c_f32_bf16 v46, v145, v145
    v_dot2c_f32_bf16 v44, s76, v146
    v_dot2c_f32_bf16 v46, v146, v146
    v_dot2c_f32_bf16 v44, s76, v147
    v_dot2c_f32_bf16 v46, v147, v147
    s_mov_b32 s61, 10112
    buffer_load_dwordx4 v33, s[24:27], s61 offen offset:1024 lds
    s_waitcnt lgkmcnt(6)
    v_dot2c_f32_bf16 v45, s76, v148
    v_dot2c_f32_bf16 v47, v148, v148
    v_dot2c_f32_bf16 v45, s76, v149
    v_dot2c_f32_bf16 v47, v149, v149
    v_dot2c_f32_bf16 v45, s76, v150
    v_dot2c_f32_bf16 v47, v150, v150
    v_dot2c_f32_bf16 v45, s76, v151
    v_dot2c_f32_bf16 v47, v151, v151
    s_mov_b32 s95, 19328
    buffer_load_dwordx4 v32, s[24:27], s95 offen offset:2048 lds
    s_waitcnt lgkmcnt(5)
    v_dot2c_f32_bf16 v44, s76, v152
    v_dot2c_f32_bf16 v46, v152, v152
    v_dot2c_f32_bf16 v44, s76, v153
    v_dot2c_f32_bf16 v46, v153, v153
    v_dot2c_f32_bf16 v44, s76, v154
    v_dot2c_f32_bf16 v46, v154, v154
    v_dot2c_f32_bf16 v44, s76, v155
    v_dot2c_f32_bf16 v46, v155, v155
    s_mov_b32 s61, 28544
    buffer_load_dwordx4 v33, s[24:27], s61 offen offset:3072 lds
    s_waitcnt lgkmcnt(4)
    v_dot2c_f32_bf16 v45, s76, v156
    v_dot2c_f32_bf16 v47, v156, v156
    v_dot2c_f32_bf16 v45, s76, v157
    v_dot2c_f32_bf16 v47, v157, v157
    v_dot2c_f32_bf16 v45, s76, v158
    v_dot2c_f32_bf16 v47, v158, v158
    v_dot2c_f32_bf16 v45, s76, v159
    v_dot2c_f32_bf16 v47, v159, v159
    s_waitcnt vmcnt(8)
    ds_read_b128 v[176:179], v40 offset:16384
    ds_read_b128 v[180:183], v40 offset:18432
    ds_read_b128 v[184:187], v41 offset:16384
    ds_read_b128 v[188:191], v41 offset:18432
    s_add_u32 m0, s60, 131072
    s_mov_b32 s95, 1024
    buffer_load_dwordx4 v32, s[24:27], s95 offen offset:0 lds
    s_waitcnt lgkmcnt(7)
    v_dot2c_f32_bf16 v44, s76, v160
    v_dot2c_f32_bf16 v46, v160, v160
    v_dot2c_f32_bf16 v44, s76, v161
    v_dot2c_f32_bf16 v46, v161, v161
    v_dot2c_f32_bf16 v44, s76, v162
    v_dot2c_f32_bf16 v46, v162, v162
    v_dot2c_f32_bf16 v44, s76, v163
    v_dot2c_f32_bf16 v46, v163, v163
    s_mov_b32 s61, 10240
    buffer_load_dwordx4 v33, s[24:27], s61 offen offset:1024 lds
    s_waitcnt lgkmcnt(6)
    v_dot2c_f32_bf16 v45, s76, v164
    v_dot2c_f32_bf16 v47, v164, v164
    v_dot2c_f32_bf16 v45, s76, v165
    v_dot2c_f32_bf16 v47, v165, v165
    v_dot2c_f32_bf16 v45, s76, v166
    v_dot2c_f32_bf16 v47, v166, v166
    v_dot2c_f32_bf16 v45, s76, v167
    v_dot2c_f32_bf16 v47, v167, v167
    s_mov_b32 s95, 19456
    buffer_load_dwordx4 v32, s[24:27], s95 offen offset:2048 lds
    s_waitcnt lgkmcnt(5)
    v_dot2c_f32_bf16 v44, s76, v168
    v_dot2c_f32_bf16 v46, v168, v168
    v_dot2c_f32_bf16 v44, s76, v169
    v_dot2c_f32_bf16 v46, v169, v169
    v_dot2c_f32_bf16 v44, s76, v170
    v_dot2c_f32_bf16 v46, v170, v170
    v_dot2c_f32_bf16 v44, s76, v171
    v_dot2c_f32_bf16 v46, v171, v171
    s_mov_b32 s61, 28672
    buffer_load_dwordx4 v33, s[24:27], s61 offen offset:3072 lds
    s_waitcnt lgkmcnt(4)
    v_dot2c_f32_bf16 v45, s76, v172
    v_dot2c_f32_bf16 v47, v172, v172
    v_dot2c_f32_bf16 v45, s76, v173
    v_dot2c_f32_bf16 v47, v173, v173
    v_dot2c_f32_bf16 v45, s76, v174
    v_dot2c_f32_bf16 v47, v174, v174
    v_dot2c_f32_bf16 v45, s76, v175
    v_dot2c_f32_bf16 v47, v175, v175
    s_mov_b64 exec, 0
    s_cmp_eq_u32 s54, 0
    s_cbranch_scc1 L_page4
    s_cmp_eq_u32 s54, 1
    s_cbranch_scc1 L_page5
    s_cmp_eq_u32 s54, 2
    s_cbranch_scc1 L_page6
    s_branch L_page7
L_tret1:
    s_mov_b64 exec, -1
    s_waitcnt vmcnt(8)
    ds_read_b128 v[192:195], v40 offset:32768
    ds_read_b128 v[196:199], v40 offset:34816
    ds_read_b128 v[200:203], v41 offset:32768
    ds_read_b128 v[204:207], v41 offset:34816
    s_add_u32 m0, s60, 147456
    s_mov_b32 s95, 1152
    buffer_load_dwordx4 v32, s[24:27], s95 offen offset:0 lds
    s_waitcnt lgkmcnt(7)
    v_dot2c_f32_bf16 v44, s76, v176
    v_dot2c_f32_bf16 v46, v176, v176
    v_dot2c_f32_bf16 v44, s76, v177
    v_dot2c_f32_bf16 v46, v177, v177
    v_dot2c_f32_bf16 v44, s76, v178
    v_dot2c_f32_bf16 v46, v178, v178
    v_dot2c_f32_bf16 v44, s76, v179
    v_dot2c_f32_bf16 v46, v179, v179
    s_mov_b32 s61, 10368
    buffer_load_dwordx4 v33, s[24:27], s61 offen offset:1024 lds
    s_waitcnt lgkmcnt(6)
    v_dot2c_f32_bf16 v45, s76, v180
    v_dot2c_f32_bf16 v47, v180, v180
    v_dot2c_f32_bf16 v45, s76, v181
    v_dot2c_f32_bf16 v47, v181, v181
    v_dot2c_f32_bf16 v45, s76, v182
    v_dot2c_f32_bf16 v47, v182, v182
    v_dot2c_f32_bf16 v45, s76, v183
    v_dot2c_f32_bf16 v47, v183, v183
    s_mov_b32 s95, 19584
    buffer_load_dwordx4 v32, s[24:27], s95 offen offset:2048 lds
    s_waitcnt lgkmcnt(5)
    v_dot2c_f32_bf16 v44, s76, v184
    v_dot2c_f32_bf16 v46, v184, v184
    v_dot2c_f32_bf16 v44, s76, v185
    v_dot2c_f32_bf16 v46, v185, v185
    v_dot2c_f32_bf16 v44, s76, v186
    v_dot2c_f32_bf16 v46, v186, v186
    v_dot2c_f32_bf16 v44, s76, v187
    v_dot2c_f32_bf16 v46, v187, v187
    s_mov_b32 s61, 28800
    buffer_load_dwordx4 v33, s[24:27], s61 offen offset:3072 lds
    s_waitcnt lgkmcnt(4)
    v_dot2c_f32_bf16 v45, s76, v188
    v_dot2c_f32_bf16 v47, v188, v188
    v_dot2c_f32_bf16 v45, s76, v189
    v_dot2c_f32_bf16 v47, v189, v189
    v_dot2c_f32_bf16 v45, s76, v190
    v_dot2c_f32_bf16 v47, v190, v190
    v_dot2c_f32_bf16 v45, s76, v191
    v_dot2c_f32_bf16 v47, v191, v191
    s_waitcnt vmcnt(8)
    ds_read_b128 v[208:211], v40 offset:49152
    ds_read_b128 v[212:215], v40 offset:51200
    ds_read_b128 v[216:219], v41 offset:49152
    ds_read_b128 v[220:223], v41 offset:51200
    s_add_u32 m0, s60, 0
    s_mov_b32 s95, 0
    buffer_load_dwordx4 v34, s[28:31], s95 offen offset:0 lds
    s_waitcnt lgkmcnt(7)
    v_dot2c_f32_bf16 v44, s76, v192
    v_dot2c_f32_bf16 v46, v192, v192
    v_dot2c_f32_bf16 v44, s76, v193
    v_dot2c_f32_bf16 v46, v193, v193
    v_dot2c_f32_bf16 v44, s76, v194
    v_dot2c_f32_bf16 v46, v194, v194
    v_dot2c_f32_bf16 v44, s76, v195
    v_dot2c_f32_bf16 v46, v195, v195
    s_mov_b32 s61, 14336
    buffer_load_dwordx4 v34, s[28:31], s61 offen offset:1024 lds
    s_waitcnt lgkmcnt(6)
    v_dot2c_f32_bf16 v45, s76, v196
    v_dot2c_f32_bf16 v47, v196, v196
    v_dot2c_f32_bf16 v45, s76, v197
    v_dot2c_f32_bf16 v47, v197, v197
    v_dot2c_f32_bf16 v45, s76, v198
    v_dot2c_f32_bf16 v47, v198, v198
    v_dot2c_f32_bf16 v45, s76, v199
    v_dot2c_f32_bf16 v47, v199, v199
    s_mov_b32 s95, 59392
    buffer_load_dwordx4 v34, s[28:31], s95 offen offset:2048 lds
    s_waitcnt lgkmcnt(5)
    v_dot2c_f32_bf16 v44, s76, v200
    v_dot2c_f32_bf16 v46, v200, v200
    v_dot2c_f32_bf16 v44, s76, v201
    v_dot2c_f32_bf16 v46, v201, v201
    v_dot2c_f32_bf16 v44, s76, v202
    v_dot2c_f32_bf16 v46, v202, v202
    v_dot2c_f32_bf16 v44, s76, v203
    v_dot2c_f32_bf16 v46, v203, v203
    s_mov_b32 s61, 73728
    buffer_load_dwordx4 v34, s[28:31], s61 offen offset:3072 lds
    s_waitcnt lgkmcnt(4)
    v_dot2c_f32_bf16 v45, s76, v204
    v_dot2c_f32_bf16 v47, v204, v204
    v_dot2c_f32_bf16 v45, s76, v205
    v_dot2c_f32_bf16 v47, v205, v205
    v_dot2c_f32_bf16 v45, s76, v206
    v_dot2c_f32_bf16 v47, v206, v206
    v_dot2c_f32_bf16 v45, s76, v207
    v_dot2c_f32_bf16 v47, v207, v207
    v_add_u32 v40, 65536, v40
    v_add_u32 v41, 65536, v41
    s_waitcnt vmcnt(8)
    ds_read_b128 v[224:227], v40 offset:0
    ds_read_b128 v[228:231], v40 offset:2048
    ds_read_b128 v[232:235], v41 offset:0
    ds_read_b128 v[236:239], v41 offset:2048
    s_add_u32 m0, s60, 16384
    s_mov_b32 s95, 245760
    buffer_load_dwordx4 v34, s[28:31], s95 offen offset:0 lds
    s_waitcnt lgkmcnt(7)
    v_dot2c_f32_bf16 v44, s76, v208
    v_dot2c_f32_bf16 v46, v208, v208
    v_dot2c_f32_bf16 v44, s76, v209
    v_dot2c_f32_bf16 v46, v209, v209
    v_dot2c_f32_bf16 v44, s76, v210
    v_dot2c_f32_bf16 v46, v210, v210
    v_dot2c_f32_bf16 v44, s76, v211
    v_dot2c_f32_bf16 v46, v211, v211
    s_mov_b32 s61, 260096
    buffer_load_dwordx4 v34, s[28:31], s61 offen offset:1024 lds
    s_waitcnt lgkmcnt(6)
    v_dot2c_f32_bf16 v45, s76, v212
    v_dot2c_f32_bf16 v47, v212, v212
    v_dot2c_f32_bf16 v45, s76, v213
    v_dot2c_f32_bf16 v47, v213, v213
    v_dot2c_f32_bf16 v45, s76, v214
    v_dot2c_f32_bf16 v47, v214, v214
    v_dot2c_f32_bf16 v45, s76, v215
    v_dot2c_f32_bf16 v47, v215, v215
    s_mov_b32 s95, 305152
    buffer_load_dwordx4 v34, s[28:31], s95 offen offset:2048 lds
    s_waitcnt lgkmcnt(5)
    v_dot2c_f32_bf16 v44, s76, v216
    v_dot2c_f32_bf16 v46, v216, v216
    v_dot2c_f32_bf16 v44, s76, v217
    v_dot2c_f32_bf16 v46, v217, v217
    v_dot2c_f32_bf16 v44, s76, v218
    v_dot2c_f32_bf16 v46, v218, v218
    v_dot2c_f32_bf16 v44, s76, v219
    v_dot2c_f32_bf16 v46, v219, v219
    s_mov_b32 s61, 319488
    buffer_load_dwordx4 v34, s[28:31], s61 offen offset:3072 lds
    s_waitcnt lgkmcnt(4)
    v_dot2c_f32_bf16 v45, s76, v220
    v_dot2c_f32_bf16 v47, v220, v220
    v_dot2c_f32_bf16 v45, s76, v221
    v_dot2c_f32_bf16 v47, v221, v221
    v_dot2c_f32_bf16 v45, s76, v222
    v_dot2c_f32_bf16 v47, v222, v222
    v_dot2c_f32_bf16 v45, s76, v223
    v_dot2c_f32_bf16 v47, v223, v223
    s_waitcnt lgkmcnt(3)
    v_dot2c_f32_bf16 v44, s76, v224
    v_dot2c_f32_bf16 v46, v224, v224
    v_dot2c_f32_bf16 v44, s76, v225
    v_dot2c_f32_bf16 v46, v225, v225
    v_dot2c_f32_bf16 v44, s76, v226
    v_dot2c_f32_bf16 v46, v226, v226
    v_dot2c_f32_bf16 v44, s76, v227
    v_dot2c_f32_bf16 v46, v227, v227
    s_waitcnt lgkmcnt(2)
    v_dot2c_f32_bf16 v45, s76, v228
    v_dot2c_f32_bf16 v47, v228, v228
    v_dot2c_f32_bf16 v45, s76, v229
    v_dot2c_f32_bf16 v47, v229, v229
    v_dot2c_f32_bf16 v45, s76, v230
    v_dot2c_f32_bf16 v47, v230, v230
    v_dot2c_f32_bf16 v45, s76, v231
    v_dot2c_f32_bf16 v47, v231, v231
    s_waitcnt lgkmcnt(1)
    v_dot2c_f32_bf16 v44, s76, v232
    v_dot2c_f32_bf16 v46, v232, v232
    v_dot2c_f32_bf16 v44, s76, v233
    v_dot2c_f32_bf16 v46, v233, v233
    v_dot2c_f32_bf16 v44, s76, v234
    v_dot2c_f32_bf16 v46, v234, v234
    v_dot2c_f32_bf16 v44, s76, v235
    v_dot2c_f32_bf16 v46, v235, v235
    s_waitcnt lgkmcnt(0)
    v_dot2c_f32_bf16 v45, s76, v236
    v_dot2c_f32_bf16 v47, v236, v236
    v_dot2c_f32_bf16 v45, s76, v237
    v_dot2c_f32_bf16 v47, v237, v237
    v_dot2c_f32_bf16 v45, s76, v238
    v_dot2c_f32_bf16 v47, v238, v238
    v_dot2c_f32_bf16 v45, s76, v239
    v_dot2c_f32_bf16 v47, v239, v239
    s_mov_b32 s95, 1228800
    s_mov_b64 exec, 31
    buffer_load_dword v19, v37, s[28:31], s95 offen
    s_mov_b64 exec, -1
    s_mov_b32 s61, 1843200
    s_mov_b64 exec, 31
    buffer_load_dword v19, v37, s[28:31], s61 offen
    s_mov_b64 exec, -1
    s_waitcnt vmcnt(10)
    ds_read_b128 v[240:243], v40 offset:16384
    ds_read_b128 v[244:247], v40 offset:18432
    ds_read_b128 v[248:251], v41 offset:16384
    ds_read_b128 v[252:255], v41 offset:18432
    s_waitcnt lgkmcnt(3)
    v_dot2c_f32_bf16 v44, s76, v240
    v_dot2c_f32_bf16 v44, s76, v241
    v_dot2c_f32_bf16 v44, s76, v242
    v_dot2c_f32_bf16 v44, s76, v243
    s_waitcnt lgkmcnt(2)
    v_dot2c_f32_bf16 v45, s76, v244
    v_dot2c_f32_bf16 v45, s76, v245
    v_dot2c_f32_bf16 v45, s76, v246
    v_dot2c_f32_bf16 v45, s76, v247
    s_waitcnt lgkmcnt(1)
    v_dot2c_f32_bf16 v44, s76, v248
    v_dot2c_f32_bf16 v44, s76, v249
    v_dot2c_f32_bf16 v44, s76, v250
    v_dot2c_f32_bf16 v44, s76, v251
    s_waitcnt lgkmcnt(0)
    v_dot2c_f32_bf16 v45, s76, v252
    v_dot2c_f32_bf16 v45, s76, v253
    v_dot2c_f32_bf16 v45, s76, v254
    v_dot2c_f32_bf16 v45, s76, v255
    v_dot2c_f32_bf16 v46, v240, v240
    v_dot2c_f32_bf16 v46, v241, v241
    v_dot2c_f32_bf16 v46, v242, v242
    v_permlane16_swap_b32 v44, v45
    v_add_f32 v44, v44, v45
    v_mov_b32 v45, v44
    v_dot2c_f32_bf16 v46, v243, v243
    v_dot2c_f32_bf16 v47, v244, v244
    v_permlane32_swap_b32 v44, v45
    v_add_f32 v44, v44, v45
    v_mul_f32 v32, 0xbacccccd, v44
    v_cvt_pk_bf16_f32 v40, v32, v32
    v_and_b32 v48, s62, v40
    v_and_b32 v52, s62, v40
    v_dot2c_f32_bf16 v47, v245, v245
    v_dot2c_f32_bf16 v47, v246, v246
    v_permlane16_swap_b32 v48, v52
    v_mov_b32 v49, v48
    v_mov_b32 v50, v48
    v_mov_b32 v51, v48
    v_mov_b32 v53, v52
    v_mov_b32 v54, v52
    v_mov_b32 v55, v52
    v_dot2c_f32_bf16 v47, v247, v247
    v_dot2c_f32_bf16 v46, v248, v248
    v_dot2c_f32_bf16 v46, v249, v249
    v_dot2c_f32_bf16 v46, v250, v250
    v_dot2c_f32_bf16 v46, v251, v251
    v_dot2c_f32_bf16 v47, v252, v252
    v_dot2c_f32_bf16 v47, v253, v253
    v_dot2c_f32_bf16 v47, v254, v254
    v_dot2c_f32_bf16 v47, v255, v255
    s_waitcnt vmcnt(6)
    s_barrier
    ds_read_b64_tr_b16 a[96:97], v56 offset:0
    ds_read_b64_tr_b16 a[98:99], v56 offset:1024
    ds_read_b64_tr_b16 a[100:101], v57 offset:0
    ds_read_b64_tr_b16 a[102:103], v57 offset:1024
    ds_read_b64_tr_b16 a[104:105], v58 offset:0
    ds_read_b64_tr_b16 a[106:107], v58 offset:1024
    ds_read_b64_tr_b16 a[108:109], v59 offset:0
    ds_read_b64_tr_b16 a[110:111], v59 offset:1024
    ds_read_b64_tr_b16 a[112:113], v60 offset:0
    ds_read_b64_tr_b16 a[114:115], v60 offset:1024
    ds_read_b64_tr_b16 a[116:117], v61 offset:0
    ds_read_b64_tr_b16 a[118:119], v61 offset:1024
    v_mfma_f32_4x4x4bf16_1k v[64:67], v[38:39], v[96:97], v[48:51]
    v_mfma_f32_4x4x4bf16_1k v[68:71], v[38:39], v[98:99], v[48:51]
    v_mfma_f32_4x4x4bf16_1k v[72:75], v[38:39], v[100:101], v[52:55]
    v_mfma_f32_4x4x4bf16_1k v[76:79], v[38:39], v[102:103], v[52:55]
    s_nop 1
    v_cvt_pk_bf16_f32 v96, v64, v65
    v_cvt_pk_bf16_f32 v97, v66, v67
    v_cvt_pk_bf16_f32 v98, v68, v69
    v_cvt_pk_bf16_f32 v99, v70, v71
    v_cvt_pk_bf16_f32 v100, v72, v73
    v_cvt_pk_bf16_f32 v101, v74, v75
    v_cvt_pk_bf16_f32 v102, v76, v77
    v_cvt_pk_bf16_f32 v103, v78, v79
    s_waitcnt lgkmcnt(10)
    v_mfma_f32_16x16x32_bf16 a[0:3], a[96:99], v[96:99], 0
    s_waitcnt lgkmcnt(8)
    ds_read_b64_tr_b16 a[120:121], v62 offset:0
    ds_read_b64_tr_b16 a[122:123], v62 offset:1024
    v_mfma_f32_16x16x32_bf16 a[8:11], a[96:99], v[100:103], 0
    s_add_u32 m0, s60, 32768
    s_mov_b32 s95, 491520
    buffer_load_dwordx4 v34, s[28:31], s95 offen offset:0 lds
    v_mfma_f32_4x4x4bf16_1k v[64:67], v[38:39], v[104:105], v[48:51]
    v_mfma_f32_4x4x4bf16_1k v[68:71], v[38:39], v[106:107], v[48:51]
    v_mfma_f32_4x4x4bf16_1k v[72:75], v[38:39], v[108:109], v[52:55]
    v_mfma_f32_4x4x4bf16_1k v[76:79], v[38:39], v[110:111], v[52:55]
    v_mfma_f32_4x4x4bf16_1k v[80:83], v[38:39], v[112:113], v[48:51]
    v_mfma_f32_4x4x4bf16_1k v[84:87], v[38:39], v[114:115], v[48:51]
    v_mfma_f32_4x4x4bf16_1k v[88:91], v[38:39], v[116:117], v[52:55]
    v_mfma_f32_4x4x4bf16_1k v[92:95], v[38:39], v[118:119], v[52:55]
    v_mfma_f32_16x16x32_bf16 a[4:7], a[100:103], v[96:99], 0
    s_waitcnt lgkmcnt(8)
    ds_read_b64_tr_b16 a[124:125], v63 offset:0
    ds_read_b64_tr_b16 a[126:127], v63 offset:1024
    v_mfma_f32_16x16x32_bf16 a[12:15], a[100:103], v[100:103], 0
    s_mov_b32 s61, 505856
    buffer_load_dwordx4 v34, s[28:31], s61 offen offset:1024 lds
    v_cvt_pk_bf16_f32 v104, v64, v65
    v_mfma_f32_16x16x32_bf16 a[16:19], a[104:107], v[96:99], 0
    s_waitcnt lgkmcnt(8)
    ds_read_b64_tr_b16 a[96:97], v56 offset:8192
    ds_read_b64_tr_b16 a[98:99], v56 offset:9216
    v_mfma_f32_16x16x32_bf16 a[24:27], a[104:107], v[100:103], 0
    s_mov_b32 s95, 550912
    buffer_load_dwordx4 v34, s[28:31], s95 offen offset:2048 lds
    v_cvt_pk_bf16_f32 v105, v66, v67
    v_mfma_f32_16x16x32_bf16 a[20:23], a[108:111], v[96:99], 0
    s_waitcnt lgkmcnt(8)
    ds_read_b64_tr_b16 a[100:101], v57 offset:8192
    ds_read_b64_tr_b16 a[102:103], v57 offset:9216
    v_mfma_f32_16x16x32_bf16 a[28:31], a[108:111], v[100:103], 0
    s_mov_b32 s61, 565248
    buffer_load_dwordx4 v34, s[28:31], s61 offen offset:3072 lds
    v_cvt_pk_bf16_f32 v106, v68, v69
    v_mfma_f32_16x16x32_bf16 a[32:35], a[112:115], v[96:99], 0
    s_waitcnt lgkmcnt(8)
    ds_read_b64_tr_b16 a[104:105], v58 offset:8192
    ds_read_b64_tr_b16 a[106:107], v58 offset:9216
    v_mfma_f32_16x16x32_bf16 a[40:43], a[112:115], v[100:103], 0
    v_cvt_pk_bf16_f32 v107, v70, v71
    v_cvt_pk_bf16_f32 v108, v72, v73
    v_cvt_pk_bf16_f32 v109, v74, v75
    v_cvt_pk_bf16_f32 v110, v76, v77
    v_mfma_f32_16x16x32_bf16 a[36:39], a[116:119], v[96:99], 0
    s_waitcnt lgkmcnt(8)
    ds_read_b64_tr_b16 a[108:109], v59 offset:8192
    ds_read_b64_tr_b16 a[110:111], v59 offset:9216
    v_mfma_f32_16x16x32_bf16 a[44:47], a[116:119], v[100:103], 0
    s_cmp_eq_u32 s82, 2146435072
    s_cbranch_scc1 L_norst
    v_mov_b32 v24, 0
    v_mov_b32 v25, 0
    v_mov_b32 v26, 0
    v_mov_b32 v27, 0
    buffer_store_dwordx4 v[24:27], v10, s[44:47], s82 offen offset:0 sc1
    buffer_store_dwordx4 v[24:27], v10, s[44:47], s82 offen offset:1024 sc1
    buffer_store_dwordx4 v[24:27], v10, s[44:47], s82 offen offset:2048 sc1
    buffer_store_dwordx4 v[24:27], v10, s[44:47], s82 offen offset:3072 sc1
    buffer_store_dwordx4 v[24:27], v11, s[44:47], s82 offen offset:0 sc1
    s_nop 1
L_norst:
    v_cvt_pk_bf16_f32 v111, v78, v79
    v_cvt_pk_bf16_f32 v112, v80, v81
    v_cvt_pk_bf16_f32 v113, v82, v83
    v_mfma_f32_16x16x32_bf16 a[48:51], a[120:123], v[96:99], 0
    s_waitcnt lgkmcnt(8)
    ds_read_b64_tr_b16 a[112:113], v60 offset:8192
    ds_read_b64_tr_b16 a[114:115], v60 offset:9216
    v_mfma_f32_16x16x32_bf16 a[56:59], a[120:123], v[100:103], 0
    s_mov_b32 s95, 0
    s_mov_b64 exec, 1023
    buffer_load_dword v19, v36, s[32:35], s95 offen
    s_mov_b64 exec, -1
    v_mfma_f32_16x16x32_bf16 a[52:55], a[124:127], v[96:99], 0
    s_waitcnt lgkmcnt(8)
    ds_read_b64_tr_b16 a[116:117], v61 offset:8192
    ds_read_b64_tr_b16 a[118:119], v61 offset:9216
    v_mfma_f32_16x16x32_bf16 a[60:63], a[124:127], v[100:103], 0
    v_cvt_pk_bf16_f32 v114, v84, v85
    v_cvt_pk_bf16_f32 v115, v86, v87
    v_cvt_pk_bf16_f32 v116, v88, v89
    v_cvt_pk_bf16_f32 v117, v90, v91
    v_mfma_f32_16x16x32_bf16 a[0:3], a[96:99], v[104:107], a[0:3]
    s_waitcnt lgkmcnt(8)
    ds_read_b64_tr_b16 a[120:121], v62 offset:8192
    ds_read_b64_tr_b16 a[122:123], v62 offset:9216
    v_mfma_f32_16x16x32_bf16 a[8:11], a[96:99], v[108:111], a[8:11]
    v_cvt_pk_bf16_f32 v118, v92, v93
    v_cvt_pk_bf16_f32 v119, v94, v95
    v_mfma_f32_16x16x32_bf16 a[4:7], a[100:103], v[104:107], a[4:7]
    s_waitcnt lgkmcnt(8)
    ds_read_b64_tr_b16 a[124:125], v63 offset:8192
    ds_read_b64_tr_b16 a[126:127], v63 offset:9216
    v_mfma_f32_16x16x32_bf16 a[12:15], a[100:103], v[108:111], a[12:15]
    v_mfma_f32_16x16x32_bf16 a[16:19], a[104:107], v[104:107], a[16:19]
    s_waitcnt lgkmcnt(8)
    s_waitcnt vmcnt(7)
    s_barrier
    ds_read_b64_tr_b16 a[96:97], v56 offset:16384
    ds_read_b64_tr_b16 a[98:99], v56 offset:17408
    v_mfma_f32_16x16x32_bf16 a[24:27], a[104:107], v[108:111], a[24:27]
    s_mov_b32 s61, 30720
    v_mfma_f32_4x4x4bf16_1k v[64:67], v[38:39], v[120:121], v[48:51]
    v_mfma_f32_4x4x4bf16_1k v[68:71], v[38:39], v[122:123], v[48:51]
    v_mfma_f32_4x4x4bf16_1k v[72:75], v[38:39], v[124:125], v[52:55]
    v_mfma_f32_4x4x4bf16_1k v[76:79], v[38:39], v[126:127], v[52:55]
    v_mfma_f32_4x4x4bf16_1k v[80:83], v[38:39], v[128:129], v[48:51]
    v_mfma_f32_4x4x4bf16_1k v[84:87], v[38:39], v[130:131], v[48:51]
    v_mfma_f32_4x4x4bf16_1k v[88:91], v[38:39], v[132:133], v[52:55]
    v_mfma_f32_4x4x4bf16_1k v[92:95], v[38:39], v[134:135], v[52:55]
    v_mfma_f32_16x16x32_bf16 a[20:23], a[108:111], v[104:107], a[20:23]
    s_waitcnt lgkmcnt(8)
    ds_read_b64_tr_b16 a[100:101], v57 offset:16384
    ds_read_b64_tr_b16 a[102:103], v57 offset:17408
    v_mfma_f32_16x16x32_bf16 a[28:31], a[108:111], v[108:111], a[28:31]
    s_mov_b64 exec, 1023
    buffer_load_dword v19, v36, s[32:35], s61 offen
    s_mov_b64 exec, -1
    v_mfma_f32_16x16x32_bf16 a[32:35], a[112:115], v[104:107], a[32:35]
    s_waitcnt lgkmcnt(8)
    ds_read_b64_tr_b16 a[104:105], v58 offset:16384
    ds_read_b64_tr_b16 a[106:107], v58 offset:17408
    v_mfma_f32_16x16x32_bf16 a[40:43], a[112:115], v[108:111], a[40:43]
    v_cvt_pk_bf16_f32 v120, v64, v65
    v_cvt_pk_bf16_f32 v121, v66, v67
    v_cvt_pk_bf16_f32 v122, v68, v69
    v_cvt_pk_bf16_f32 v123, v70, v71
    v_mfma_f32_16x16x32_bf16 a[36:39], a[116:119], v[104:107], a[36:39]
    s_waitcnt lgkmcnt(8)
    ds_read_b64_tr_b16 a[108:109], v59 offset:16384
    ds_read_b64_tr_b16 a[110:111], v59 offset:17408
    v_mfma_f32_16x16x32_bf16 a[44:47], a[116:119], v[108:111], a[44:47]
    v_cvt_pk_bf16_f32 v124, v72, v73
    v_cvt_pk_bf16_f32 v125, v74, v75
    v_cvt_pk_bf16_f32 v126, v76, v77
    v_cvt_pk_bf16_f32 v127, v78, v79
    v_mfma_f32_16x16x32_bf16 a[48:51], a[120:123], v[104:107], a[48:51]
    s_waitcnt lgkmcnt(8)
    ds_read_b64_tr_b16 a[112:113], v60 offset:16384
    ds_read_b64_tr_b16 a[114:115], v60 offset:17408
    v_mfma_f32_16x16x32_bf16 a[56:59], a[120:123], v[108:111], a[56:59]
    s_mov_b32 s95, 737280
    v_cvt_pk_bf16_f32 v128, v80, v81
    v_cvt_pk_bf16_f32 v129, v82, v83
    v_mfma_f32_16x16x32_bf16 a[52:55], a[124:127], v[104:107], a[52:55]
    s_waitcnt lgkmcnt(8)
    ds_read_b64_tr_b16 a[116:117], v61 offset:16384
    ds_read_b64_tr_b16 a[118:119], v61 offset:17408
    v_mfma_f32_16x16x32_bf16 a[60:63], a[124:127], v[108:111], a[60:63]
    s_add_u32 m0, s60, 49152
    v_cvt_pk_bf16_f32 v130, v84, v85
    v_cvt_pk_bf16_f32 v131, v86, v87
    v_mfma_f32_16x16x32_bf16 a[0:3], a[96:99], v[112:115], a[0:3]
    s_waitcnt lgkmcnt(8)
    ds_read_b64_tr_b16 a[120:121], v62 offset:16384
    ds_read_b64_tr_b16 a[122:123], v62 offset:17408
    v_mfma_f32_16x16x32_bf16 a[8:11], a[96:99], v[116:119], a[8:11]
    buffer_load_dwordx4 v34, s[28:31], s95 offen offset:0 lds
    v_mfma_f32_16x16x32_bf16 a[4:7], a[100:103], v[112:115], a[4:7]
    s_waitcnt lgkmcnt(8)
    ds_read_b64_tr_b16 a[124:125], v63 offset:16384
    ds_read_b64_tr_b16 a[126:127], v63 offset:17408
    v_mfma_f32_16x16x32_bf16 a[12:15], a[100:103], v[116:119], a[12:15]
    s_mov_b32 s61, 751616
    buffer_load_dwordx4 v34, s[28:31], s61 offen offset:1024 lds
    v_mfma_f32_16x16x32_bf16 a[16:19], a[104:107], v[112:115], a[16:19]
    s_waitcnt lgkmcnt(8)
    ds_read_b64_tr_b16 a[96:97], v56 offset:24576
    ds_read_b64_tr_b16 a[98:99], v56 offset:25600
    v_mfma_f32_16x16x32_bf16 a[24:27], a[104:107], v[116:119], a[24:27]
    s_mov_b32 s95, 796672
    v_cvt_pk_bf16_f32 v132, v88, v89
    v_cvt_pk_bf16_f32 v133, v90, v91
    v_mfma_f32_16x16x32_bf16 a[20:23], a[108:111], v[112:115], a[20:23]
    s_waitcnt lgkmcnt(8)
    ds_read_b64_tr_b16 a[100:101], v57 offset:24576
    ds_read_b64_tr_b16 a[102:103], v57 offset:25600
    v_mfma_f32_16x16x32_bf16 a[28:31], a[108:111], v[116:119], a[28:31]
    buffer_load_dwordx4 v34, s[28:31], s95 offen offset:2048 lds
    v_mfma_f32_16x16x32_bf16 a[32:35], a[112:115], v[112:115], a[32:35]
    s_waitcnt lgkmcnt(8)
    ds_read_b64_tr_b16 a[104:105], v58 offset:24576
    ds_read_b64_tr_b16 a[106:107], v58 offset:25600
    v_mfma_f32_16x16x32_bf16 a[40:43], a[112:115], v[116:119], a[40:43]
    s_mov_b32 s61, 811008
    v_cvt_pk_bf16_f32 v134, v92, v93
    v_cvt_pk_bf16_f32 v135, v94, v95
    v_mfma_f32_4x4x4bf16_1k v[64:67], v[38:39], v[136:137], v[48:51]
    v_mfma_f32_4x4x4bf16_1k v[68:71], v[38:39], v[138:139], v[48:51]
    v_mfma_f32_4x4x4bf16_1k v[72:75], v[38:39], v[140:141], v[52:55]
    v_mfma_f32_4x4x4bf16_1k v[76:79], v[38:39], v[142:143], v[52:55]
    v_mfma_f32_4x4x4bf16_1k v[80:83], v[38:39], v[144:145], v[48:51]
    v_mfma_f32_4x4x4bf16_1k v[84:87], v[38:39], v[146:147], v[48:51]
    v_mfma_f32_4x4x4bf16_1k v[88:91], v[38:39], v[148:149], v[52:55]
    v_mfma_f32_4x4x4bf16_1k v[92:95], v[38:39], v[150:151], v[52:55]
    v_mfma_f32_16x16x32_bf16 a[36:39], a[116:119], v[112:115], a[36:39]
    s_waitcnt lgkmcnt(8)
    ds_read_b64_tr_b16 a[108:109], v59 offset:24576
    ds_read_b64_tr_b16 a[110:111], v59 offset:25600
    v_mfma_f32_16x16x32_bf16 a[44:47], a[116:119], v[116:119], a[44:47]
    buffer_load_dwordx4 v34, s[28:31], s61 offen offset:3072 lds
    v_mfma_f32_16x16x32_bf16 a[48:51], a[120:123], v[112:115], a[48:51]
    s_waitcnt lgkmcnt(8)
    ds_read_b64_tr_b16 a[112:113], v60 offset:24576
    ds_read_b64_tr_b16 a[114:115], v60 offset:25600
    v_mfma_f32_16x16x32_bf16 a[56:59], a[120:123], v[116:119], a[56:59]
    s_add_u32 m0, s60, 65536
    v_cvt_pk_bf16_f32 v136, v64, v65
    v_cvt_pk_bf16_f32 v137, v66, v67
    v_mfma_f32_16x16x32_bf16 a[52:55], a[124:127], v[112:115], a[52:55]
    s_waitcnt lgkmcnt(8)
    ds_read_b64_tr_b16 a[116:117], v61 offset:24576
    ds_read_b64_tr_b16 a[118:119], v61 offset:25600
    v_mfma_f32_16x16x32_bf16 a[60:63], a[124:127], v[116:119], a[60:63]
    s_mov_b32 s95, 983040
    buffer_load_dwordx4 v34, s[28:31], s95 offen offset:0 lds
    v_mfma_f32_16x16x32_bf16 a[0:3], a[96:99], v[120:123], a[0:3]
    s_waitcnt lgkmcnt(8)
    ds_read_b64_tr_b16 a[120:121], v62 offset:24576
    ds_read_b64_tr_b16 a[122:123], v62 offset:25600
    v_mfma_f32_16x16x32_bf16 a[8:11], a[96:99], v[124:127], a[8:11]
    s_mov_b32 s61, 997376
    v_cvt_pk_bf16_f32 v138, v68, v69
    v_cvt_pk_bf16_f32 v139, v70, v71
    s_branch L_main
.p2align 12
L_main:
L_page0:
    s_cbranch_execz L_tret0
    v_mfma_f32_16x16x32_bf16 a[4:7], a[100:103], v[120:123], a[4:7]
    s_waitcnt lgkmcnt(8)
    ds_read_b64_tr_b16 a[124:125], v63 offset:24576
    ds_read_b64_tr_b16 a[126:127], v63 offset:25600
    v_mfma_f32_16x16x32_bf16 a[12:15], a[100:103], v[124:127], a[12:15]
    buffer_load_dwordx4 v34, s[28:31], s61 offen offset:1024 lds
    v_mfma_f32_16x16x32_bf16 a[16:19], a[104:107], v[120:123], a[16:19]
    s_waitcnt lgkmcnt(8)
    s_waitcnt vmcnt(8)
    s_barrier
    ds_read_b64_tr_b16 a[96:97], v56 offset:32768
    ds_read_b64_tr_b16 a[98:99], v56 offset:33792
    v_mfma_f32_16x16x32_bf16 a[24:27], a[104:107], v[124:127], a[24:27]
    s_mov_b32 s95, 1042432
    v_mfma_f32_16x16x32_bf16 a[20:23], a[108:111], v[120:123], a[20:23]
    s_waitcnt lgkmcnt(8)
    ds_read_b64_tr_b16 a[100:101], v57 offset:32768
    ds_read_b64_tr_b16 a[102:103], v57 offset:33792
    v_mfma_f32_16x16x32_bf16 a[28:31], a[108:111], v[124:127], a[28:31]
    buffer_load_dwordx4 v34, s[28:31], s95 offen offset:2048 lds
    v_mfma_f32_16x16x32_bf16 a[32:35], a[112:115], v[120:123], a[32:35]
    s_waitcnt lgkmcnt(8)
    ds_read_b64_tr_b16 a[104:105], v58 offset:32768
    ds_read_b64_tr_b16 a[106:107], v58 offset:33792
    v_mfma_f32_16x16x32_bf16 a[40:43], a[112:115], v[124:127], a[40:43]
    s_mov_b32 s61, 1056768
    v_cvt_pk_bf16_f32 v140, v72, v73
    v_cvt_pk_bf16_f32 v141, v74, v75
    v_mfma_f32_16x16x32_bf16 a[36:39], a[116:119], v[120:123], a[36:39]
    s_waitcnt lgkmcnt(8)
    ds_read_b64_tr_b16 a[108:109], v59 offset:32768
    ds_read_b64_tr_b16 a[110:111], v59 offset:33792
    v_mfma_f32_16x16x32_bf16 a[44:47], a[116:119], v[124:127], a[44:47]
    buffer_load_dwordx4 v34, s[28:31], s61 offen offset:3072 lds
    v_mfma_f32_16x16x32_bf16 a[48:51], a[120:123], v[120:123], a[48:51]
    s_waitcnt lgkmcnt(8)
    ds_read_b64_tr_b16 a[112:113], v60 offset:32768
    ds_read_b64_tr_b16 a[114:115], v60 offset:33792
    v_mfma_f32_16x16x32_bf16 a[56:59], a[120:123], v[124:127], a[56:59]
    s_add_u32 m0, s60, 147456
    v_cvt_pk_bf16_f32 v142, v76, v77
    v_cvt_pk_bf16_f32 v143, v78, v79
    v_mfma_f32_16x16x32_bf16 a[52:55], a[124:127], v[120:123], a[52:55]
    s_waitcnt lgkmcnt(8)
    ds_read_b64_tr_b16 a[116:117], v61 offset:32768
    ds_read_b64_tr_b16 a[118:119], v61 offset:33792
    v_mfma_f32_16x16x32_bf16 a[60:63], a[124:127], v[124:127], a[60:63]
    s_mul_i32 s95, s83, 0
    buffer_load_dwordx4 v35, s[36:39], s95 offen offset:0 lds
    v_mfma_f32_16x16x32_bf16 a[0:3], a[96:99], v[128:131], a[0:3]
    s_waitcnt lgkmcnt(8)
    ds_read_b64_tr_b16 a[120:121], v62 offset:32768
    ds_read_b64_tr_b16 a[122:123], v62 offset:33792
    v_mfma_f32_16x16x32_bf16 a[8:11], a[96:99], v[132:135], a[8:11]
    s_add_u32 m0, s60, 81920
    v_cvt_pk_bf16_f32 v144, v80, v81
    v_cvt_pk_bf16_f32 v145, v82, v83
    v_mfma_f32_16x16x32_bf16 a[4:7], a[100:103], v[128:131], a[4:7]
    s_waitcnt lgkmcnt(8)
    ds_read_b64_tr_b16 a[124:125], v63 offset:32768
    ds_read_b64_tr_b16 a[126:127], v63 offset:33792
    v_mfma_f32_16x16x32_bf16 a[12:15], a[100:103], v[132:135], a[12:15]
    s_mov_b32 s61, 1228800
    buffer_load_dwordx4 v34, s[28:31], s61 offen offset:0 lds
    v_mfma_f32_16x16x32_bf16 a[16:19], a[104:107], v[128:131], a[16:19]
    s_waitcnt lgkmcnt(8)
    ds_read_b64_tr_b16 a[96:97], v56 offset:40960
    ds_read_b64_tr_b16 a[98:99], v56 offset:41984
    v_mfma_f32_16x16x32_bf16 a[24:27], a[104:107], v[132:135], a[24:27]
    s_mov_b32 s95, 1243136
    v_cvt_pk_bf16_f32 v146, v84, v85
    v_cvt_pk_bf16_f32 v147, v86, v87
    v_mfma_f32_16x16x32_bf16 a[20:23], a[108:111], v[128:131], a[20:23]
    s_waitcnt lgkmcnt(8)
    ds_read_b64_tr_b16 a[100:101], v57 offset:40960
    ds_read_b64_tr_b16 a[102:103], v57 offset:41984
    v_mfma_f32_16x16x32_bf16 a[28:31], a[108:111], v[132:135], a[28:31]
    buffer_load_dwordx4 v34, s[28:31], s95 offen offset:1024 lds
    v_mfma_f32_16x16x32_bf16 a[32:35], a[112:115], v[128:131], a[32:35]
    s_waitcnt lgkmcnt(8)
    ds_read_b64_tr_b16 a[104:105], v58 offset:40960
    ds_read_b64_tr_b16 a[106:107], v58 offset:41984
    v_mfma_f32_16x16x32_bf16 a[40:43], a[112:115], v[132:135], a[40:43]
    s_mov_b32 s61, 1288192
    v_cvt_pk_bf16_f32 v148, v88, v89
    v_cvt_pk_bf16_f32 v149, v90, v91
    v_mfma_f32_16x16x32_bf16 a[36:39], a[116:119], v[128:131], a[36:39]
    s_waitcnt lgkmcnt(8)
    ds_read_b64_tr_b16 a[108:109], v59 offset:40960
    ds_read_b64_tr_b16 a[110:111], v59 offset:41984
    v_mfma_f32_16x16x32_bf16 a[44:47], a[116:119], v[132:135], a[44:47]
    buffer_load_dwordx4 v34, s[28:31], s61 offen offset:2048 lds
    v_mfma_f32_16x16x32_bf16 a[48:51], a[120:123], v[128:131], a[48:51]
    s_waitcnt lgkmcnt(8)
    ds_read_b64_tr_b16 a[112:113], v60 offset:40960
    ds_read_b64_tr_b16 a[114:115], v60 offset:41984
    v_mfma_f32_16x16x32_bf16 a[56:59], a[120:123], v[132:135], a[56:59]
    s_mov_b32 s95, 1302528
    v_cvt_pk_bf16_f32 v150, v92, v93
    v_cvt_pk_bf16_f32 v151, v94, v95
    v_mfma_f32_4x4x4bf16_1k v[64:67], v[38:39], v[152:153], v[48:51]
    v_mfma_f32_4x4x4bf16_1k v[68:71], v[38:39], v[154:155], v[48:51]
    v_mfma_f32_4x4x4bf16_1k v[72:75], v[38:39], v[156:157], v[52:55]
    v_mfma_f32_4x4x4bf16_1k v[76:79], v[38:39], v[158:159], v[52:55]
    v_mfma_f32_4x4x4bf16_1k v[80:83], v[38:39], v[160:161], v[48:51]
    v_mfma_f32_4x4x4bf16_1k v[84:87], v[38:39], v[162:163], v[48:51]
    v_mfma_f32_4x4x4bf16_1k v[88:91], v[38:39], v[164:165], v[52:55]
    v_mfma_f32_4x4x4bf16_1k v[92:95], v[38:39], v[166:167], v[52:55]
    v_mfma_f32_16x16x32_bf16 a[52:55], a[124:127], v[128:131], a[52:55]
    s_waitcnt lgkmcnt(8)
    ds_read_b64_tr_b16 a[116:117], v61 offset:40960
    ds_read_b64_tr_b16 a[118:119], v61 offset:41984
    v_mfma_f32_16x16x32_bf16 a[60:63], a[124:127], v[132:135], a[60:63]
    buffer_load_dwordx4 v34, s[28:31], s95 offen offset:3072 lds
    v_mfma_f32_16x16x32_bf16 a[0:3], a[96:99], v[136:139], a[0:3]
    s_waitcnt lgkmcnt(8)
    ds_read_b64_tr_b16 a[120:121], v62 offset:40960
    ds_read_b64_tr_b16 a[122:123], v62 offset:41984
    v_mfma_f32_16x16x32_bf16 a[8:11], a[96:99], v[140:143], a[8:11]
    s_mul_i32 s61, s83, 1
    v_cvt_pk_bf16_f32 v152, v64, v65
    v_cvt_pk_bf16_f32 v153, v66, v67
    v_mfma_f32_16x16x32_bf16 a[4:7], a[100:103], v[136:139], a[4:7]
    s_waitcnt lgkmcnt(8)
    ds_read_b64_tr_b16 a[124:125], v63 offset:40960
    ds_read_b64_tr_b16 a[126:127], v63 offset:41984
    v_mfma_f32_16x16x32_bf16 a[12:15], a[100:103], v[140:143], a[12:15]
    s_add_u32 m0, s60, 147456
    v_cvt_pk_bf16_f32 v154, v68, v69
    v_cvt_pk_bf16_f32 v155, v70, v71
    v_mfma_f32_16x16x32_bf16 a[16:19], a[104:107], v[136:139], a[16:19]
    s_waitcnt lgkmcnt(8)
    s_waitcnt vmcnt(9)
    s_barrier
    ds_read_b64_tr_b16 a[96:97], v56 offset:49152
    ds_read_b64_tr_b16 a[98:99], v56 offset:50176
    v_mfma_f32_16x16x32_bf16 a[24:27], a[104:107], v[140:143], a[24:27]
    buffer_load_dwordx4 v35, s[36:39], s61 offen offset:1024 lds
    v_mfma_f32_16x16x32_bf16 a[20:23], a[108:111], v[136:139], a[20:23]
    s_waitcnt lgkmcnt(8)
    ds_read_b64_tr_b16 a[100:101], v57 offset:49152
    ds_read_b64_tr_b16 a[102:103], v57 offset:50176
    v_mfma_f32_16x16x32_bf16 a[28:31], a[108:111], v[140:143], a[28:31]
    s_mov_b64 exec, 1
    buffer_store_dword v30, off, s[48:51], s77 sc1
    s_mov_b64 exec, -1
    v_mfma_f32_16x16x32_bf16 a[32:35], a[112:115], v[136:139], a[32:35]
    s_waitcnt lgkmcnt(8)
    ds_read_b64_tr_b16 a[104:105], v58 offset:49152
    ds_read_b64_tr_b16 a[106:107], v58 offset:50176
    v_mfma_f32_16x16x32_bf16 a[40:43], a[112:115], v[140:143], a[40:43]
    v_cvt_pk_bf16_f32 v156, v72, v73
    v_cvt_pk_bf16_f32 v157, v74, v75
    v_mfma_f32_16x16x32_bf16 a[36:39], a[116:119], v[136:139], a[36:39]
    s_waitcnt lgkmcnt(8)
    ds_read_b64_tr_b16 a[108:109], v59 offset:49152
    ds_read_b64_tr_b16 a[110:111], v59 offset:50176
    v_mfma_f32_16x16x32_bf16 a[44:47], a[116:119], v[140:143], a[44:47]
    v_cvt_pk_bf16_f32 v158, v76, v77
    v_cvt_pk_bf16_f32 v159, v78, v79
    v_mfma_f32_16x16x32_bf16 a[48:51], a[120:123], v[136:139], a[48:51]
    s_waitcnt lgkmcnt(8)
    ds_read_b64_tr_b16 a[112:113], v60 offset:49152
    ds_read_b64_tr_b16 a[114:115], v60 offset:50176
    v_mfma_f32_16x16x32_bf16 a[56:59], a[120:123], v[140:143], a[56:59]
    v_cvt_pk_bf16_f32 v160, v80, v81
    v_cvt_pk_bf16_f32 v161, v82, v83
    v_mfma_f32_16x16x32_bf16 a[52:55], a[124:127], v[136:139], a[52:55]
    s_waitcnt lgkmcnt(8)
    ds_read_b64_tr_b16 a[116:117], v61 offset:49152
    ds_read_b64_tr_b16 a[118:119], v61 offset:50176
    v_mfma_f32_16x16x32_bf16 a[60:63], a[124:127], v[140:143], a[60:63]
    v_cvt_pk_bf16_f32 v162, v84, v85
    v_cvt_pk_bf16_f32 v163, v86, v87
    v_mfma_f32_16x16x32_bf16 a[0:3], a[96:99], v[144:147], a[0:3]
    s_waitcnt lgkmcnt(8)
    ds_read_b64_tr_b16 a[120:121], v62 offset:49152
    ds_read_b64_tr_b16 a[122:123], v62 offset:50176
    v_mfma_f32_16x16x32_bf16 a[8:11], a[96:99], v[148:151], a[8:11]
    s_mov_b32 s95, 1474560
    v_cvt_pk_bf16_f32 v164, v88, v89
    v_cvt_pk_bf16_f32 v165, v90, v91
    v_mfma_f32_16x16x32_bf16 a[4:7], a[100:103], v[144:147], a[4:7]
    s_waitcnt lgkmcnt(8)
    ds_read_b64_tr_b16 a[124:125], v63 offset:49152
    ds_read_b64_tr_b16 a[126:127], v63 offset:50176
    v_mfma_f32_16x16x32_bf16 a[12:15], a[100:103], v[148:151], a[12:15]
    s_add_u32 m0, s60, 98304
    v_cvt_pk_bf16_f32 v166, v92, v93
    v_cvt_pk_bf16_f32 v167, v94, v95
    v_mfma_f32_4x4x4bf16_1k v[64:67], v[38:39], v[168:169], v[48:51]
    v_mfma_f32_4x4x4bf16_1k v[68:71], v[38:39], v[170:171], v[48:51]
    v_mfma_f32_4x4x4bf16_1k v[72:75], v[38:39], v[172:173], v[52:55]
    v_mfma_f32_4x4x4bf16_1k v[76:79], v[38:39], v[174:175], v[52:55]
    v_mfma_f32_4x4x4bf16_1k v[80:83], v[38:39], v[176:177], v[48:51]
    v_mfma_f32_4x4x4bf16_1k v[84:87], v[38:39], v[178:179], v[48:51]
    v_mfma_f32_4x4x4bf16_1k v[88:91], v[38:39], v[180:181], v[52:55]
    v_mfma_f32_4x4x4bf16_1k v[92:95], v[38:39], v[182:183], v[52:55]
    v_mfma_f32_16x16x32_bf16 a[16:19], a[104:107], v[144:147], a[16:19]
    s_waitcnt lgkmcnt(8)
    ds_read_b64_tr_b16 a[96:97], v56 offset:57344
    ds_read_b64_tr_b16 a[98:99], v56 offset:58368
    v_mfma_f32_16x16x32_bf16 a[24:27], a[104:107], v[148:151], a[24:27]
    buffer_load_dwordx4 v34, s[28:31], s95 offen offset:0 lds
    v_mfma_f32_16x16x32_bf16 a[20:23], a[108:111], v[144:147], a[20:23]
    s_waitcnt lgkmcnt(8)
    ds_read_b64_tr_b16 a[100:101], v57 offset:57344
    ds_read_b64_tr_b16 a[102:103], v57 offset:58368
    v_mfma_f32_16x16x32_bf16 a[28:31], a[108:111], v[148:151], a[28:31]
    s_mov_b32 s61, 1488896
    buffer_load_dwordx4 v34, s[28:31], s61 offen offset:1024 lds
    v_mfma_f32_16x16x32_bf16 a[32:35], a[112:115], v[144:147], a[32:35]
    s_waitcnt lgkmcnt(8)
    ds_read_b64_tr_b16 a[104:105], v58 offset:57344
    ds_read_b64_tr_b16 a[106:107], v58 offset:58368
    v_mfma_f32_16x16x32_bf16 a[40:43], a[112:115], v[148:151], a[40:43]
    s_mov_b32 s95, 1533952
    buffer_load_dwordx4 v34, s[28:31], s95 offen offset:2048 lds
    v_mfma_f32_16x16x32_bf16 a[36:39], a[116:119], v[144:147], a[36:39]
    s_waitcnt lgkmcnt(8)
    ds_read_b64_tr_b16 a[108:109], v59 offset:57344
    ds_read_b64_tr_b16 a[110:111], v59 offset:58368
    v_mfma_f32_16x16x32_bf16 a[44:47], a[116:119], v[148:151], a[44:47]
    s_mov_b32 s61, 1548288
    v_cvt_pk_bf16_f32 v168, v64, v65
    v_cvt_pk_bf16_f32 v169, v66, v67
    v_mfma_f32_16x16x32_bf16 a[48:51], a[120:123], v[144:147], a[48:51]
    s_waitcnt lgkmcnt(8)
    ds_read_b64_tr_b16 a[112:113], v60 offset:57344
    ds_read_b64_tr_b16 a[114:115], v60 offset:58368
    v_mfma_f32_16x16x32_bf16 a[56:59], a[120:123], v[148:151], a[56:59]
    buffer_load_dwordx4 v34, s[28:31], s61 offen offset:3072 lds
    v_mfma_f32_16x16x32_bf16 a[52:55], a[124:127], v[144:147], a[52:55]
    s_waitcnt lgkmcnt(8)
    ds_read_b64_tr_b16 a[116:117], v61 offset:57344
    ds_read_b64_tr_b16 a[118:119], v61 offset:58368
    v_mfma_f32_16x16x32_bf16 a[60:63], a[124:127], v[148:151], a[60:63]
    s_add_u32 m0, s60, 147456
    v_cvt_pk_bf16_f32 v170, v68, v69
    v_cvt_pk_bf16_f32 v171, v70, v71
    v_mfma_f32_16x16x32_bf16 a[0:3], a[96:99], v[152:155], a[0:3]
    s_waitcnt lgkmcnt(8)
    ds_read_b64_tr_b16 a[120:121], v62 offset:57344
    ds_read_b64_tr_b16 a[122:123], v62 offset:58368
    v_mfma_f32_16x16x32_bf16 a[8:11], a[96:99], v[156:159], a[8:11]
    s_mul_i32 s95, s83, 2
    buffer_load_dwordx4 v35, s[36:39], s95 offen offset:2048 lds
    v_mfma_f32_16x16x32_bf16 a[4:7], a[100:103], v[152:155], a[4:7]
    s_waitcnt lgkmcnt(8)
    ds_read_b64_tr_b16 a[124:125], v63 offset:57344
    ds_read_b64_tr_b16 a[126:127], v63 offset:58368
    v_mfma_f32_16x16x32_bf16 a[12:15], a[100:103], v[156:159], a[12:15]
    s_mov_b32 s61, 1720320
    v_cvt_pk_bf16_f32 v172, v72, v73
    v_cvt_pk_bf16_f32 v173, v74, v75
    v_add_u32 v56, 65536, v56
    v_mfma_f32_16x16x32_bf16 a[16:19], a[104:107], v[152:155], a[16:19]
    s_waitcnt lgkmcnt(8)
    s_waitcnt vmcnt(7)
    s_barrier
    ds_read_b64_tr_b16 a[96:97], v56 offset:0
    ds_read_b64_tr_b16 a[98:99], v56 offset:1024
    v_mfma_f32_16x16x32_bf16 a[24:27], a[104:107], v[156:159], a[24:27]
    s_add_u32 m0, s60, 114688
    v_add_u32 v57, 65536, v57
    v_mfma_f32_16x16x32_bf16 a[20:23], a[108:111], v[152:155], a[20:23]
    s_waitcnt lgkmcnt(8)
    ds_read_b64_tr_b16 a[100:101], v57 offset:0
    ds_read_b64_tr_b16 a[102:103], v57 offset:1024
    v_mfma_f32_16x16x32_bf16 a[28:31], a[108:111], v[156:159], a[28:31]
    buffer_load_dwordx4 v34, s[28:31], s61 offen offset:0 lds
    v_add_u32 v58, 65536, v58
    v_mfma_f32_16x16x32_bf16 a[32:35], a[112:115], v[152:155], a[32:35]
    s_waitcnt lgkmcnt(8)
    ds_read_b64_tr_b16 a[104:105], v58 offset:0
    ds_read_b64_tr_b16 a[106:107], v58 offset:1024
    v_mfma_f32_16x16x32_bf16 a[40:43], a[112:115], v[156:159], a[40:43]
    s_mov_b32 s95, 1734656
    v_cvt_pk_bf16_f32 v174, v76, v77
    v_cvt_pk_bf16_f32 v175, v78, v79
    v_add_u32 v59, 65536, v59
    v_mfma_f32_16x16x32_bf16 a[36:39], a[116:119], v[152:155], a[36:39]
    s_waitcnt lgkmcnt(8)
    ds_read_b64_tr_b16 a[108:109], v59 offset:0
    ds_read_b64_tr_b16 a[110:111], v59 offset:1024
    v_mfma_f32_16x16x32_bf16 a[44:47], a[116:119], v[156:159], a[44:47]
    buffer_load_dwordx4 v34, s[28:31], s95 offen offset:1024 lds
    v_add_u32 v60, 65536, v60
    v_mfma_f32_16x16x32_bf16 a[48:51], a[120:123], v[152:155], a[48:51]
    s_waitcnt lgkmcnt(8)
    ds_read_b64_tr_b16 a[112:113], v60 offset:0
    ds_read_b64_tr_b16 a[114:115], v60 offset:1024
    v_mfma_f32_16x16x32_bf16 a[56:59], a[120:123], v[156:159], a[56:59]
    s_mov_b32 s61, 1779712
    v_cvt_pk_bf16_f32 v176, v80, v81
    v_cvt_pk_bf16_f32 v177, v82, v83
    v_add_u32 v61, 65536, v61
    v_mfma_f32_16x16x32_bf16 a[52:55], a[124:127], v[152:155], a[52:55]
    s_waitcnt lgkmcnt(8)
    ds_read_b64_tr_b16 a[116:117], v61 offset:0
    ds_read_b64_tr_b16 a[118:119], v61 offset:1024
    v_mfma_f32_16x16x32_bf16 a[60:63], a[124:127], v[156:159], a[60:63]
    buffer_load_dwordx4 v34, s[28:31], s61 offen offset:2048 lds
    v_add_u32 v62, 65536, v62
    v_mfma_f32_16x16x32_bf16 a[0:3], a[96:99], v[160:163], a[0:3]
    s_waitcnt lgkmcnt(8)
    ds_read_b64_tr_b16 a[120:121], v62 offset:0
    ds_read_b64_tr_b16 a[122:123], v62 offset:1024
    v_mfma_f32_16x16x32_bf16 a[8:11], a[96:99], v[164:167], a[8:11]
    s_mov_b32 s95, 1794048
    v_cvt_pk_bf16_f32 v178, v84, v85
    v_cvt_pk_bf16_f32 v179, v86, v87
    v_add_u32 v63, 65536, v63
    v_mfma_f32_16x16x32_bf16 a[4:7], a[100:103], v[160:163], a[4:7]
    s_waitcnt lgkmcnt(8)
    ds_read_b64_tr_b16 a[124:125], v63 offset:0
    ds_read_b64_tr_b16 a[126:127], v63 offset:1024
    v_mfma_f32_16x16x32_bf16 a[12:15], a[100:103], v[164:167], a[12:15]
    buffer_load_dwordx4 v34, s[28:31], s95 offen offset:3072 lds
    v_mfma_f32_16x16x32_bf16 a[16:19], a[104:107], v[160:163], a[16:19]
    s_waitcnt lgkmcnt(8)
    ds_read_b64_tr_b16 a[96:97], v56 offset:8192
    ds_read_b64_tr_b16 a[98:99], v56 offset:9216
    v_mfma_f32_16x16x32_bf16 a[24:27], a[104:107], v[164:167], a[24:27]
    s_add_u32 m0, s60, 147456
    v_cvt_pk_bf16_f32 v180, v88, v89
    v_cvt_pk_bf16_f32 v181, v90, v91
    v_mfma_f32_16x16x32_bf16 a[20:23], a[108:111], v[160:163], a[20:23]
    s_waitcnt lgkmcnt(8)
    ds_read_b64_tr_b16 a[100:101], v57 offset:8192
    ds_read_b64_tr_b16 a[102:103], v57 offset:9216
    v_mfma_f32_16x16x32_bf16 a[28:31], a[108:111], v[164:167], a[28:31]
    s_mul_i32 s61, s83, 3
    buffer_load_dwordx4 v35, s[36:39], s61 offen offset:3072 lds
    v_mfma_f32_16x16x32_bf16 a[32:35], a[112:115], v[160:163], a[32:35]
    s_waitcnt lgkmcnt(8)
    ds_read_b64_tr_b16 a[104:105], v58 offset:8192
    ds_read_b64_tr_b16 a[106:107], v58 offset:9216
    v_mfma_f32_16x16x32_bf16 a[40:43], a[112:115], v[164:167], a[40:43]
    v_cvt_pk_bf16_f32 v182, v92, v93
    v_cvt_pk_bf16_f32 v183, v94, v95
    v_mfma_f32_4x4x4bf16_1k v[64:67], v[38:39], v[184:185], v[48:51]
    v_mfma_f32_4x4x4bf16_1k v[68:71], v[38:39], v[186:187], v[48:51]
    v_mfma_f32_4x4x4bf16_1k v[72:75], v[38:39], v[188:189], v[52:55]
    v_mfma_f32_4x4x4bf16_1k v[76:79], v[38:39], v[190:191], v[52:55]
    v_mfma_f32_4x4x4bf16_1k v[80:83], v[38:39], v[192:193], v[48:51]
    v_mfma_f32_4x4x4bf16_1k v[84:87], v[38:39], v[194:195], v[48:51]
    v_mfma_f32_4x4x4bf16_1k v[88:91], v[38:39], v[196:197], v[52:55]
    v_mfma_f32_4x4x4bf16_1k v[92:95], v[38:39], v[198:199], v[52:55]
    v_mfma_f32_16x16x32_bf16 a[36:39], a[116:119], v[160:163], a[36:39]
    s_waitcnt lgkmcnt(8)
    ds_read_b64_tr_b16 a[108:109], v59 offset:8192
    ds_read_b64_tr_b16 a[110:111], v59 offset:9216
    v_mfma_f32_16x16x32_bf16 a[44:47], a[116:119], v[164:167], a[44:47]
    v_cvt_pk_bf16_f32 v184, v64, v65
    v_cvt_pk_bf16_f32 v185, v66, v67
    v_mfma_f32_16x16x32_bf16 a[48:51], a[120:123], v[160:163], a[48:51]
    s_waitcnt lgkmcnt(8)
    ds_read_b64_tr_b16 a[112:113], v60 offset:8192
    ds_read_b64_tr_b16 a[114:115], v60 offset:9216
    v_mfma_f32_16x16x32_bf16 a[56:59], a[120:123], v[164:167], a[56:59]
    v_cvt_pk_bf16_f32 v186, v68, v69
    v_cvt_pk_bf16_f32 v187, v70, v71
    v_mfma_f32_16x16x32_bf16 a[52:55], a[124:127], v[160:163], a[52:55]
    s_waitcnt lgkmcnt(8)
    ds_read_b64_tr_b16 a[116:117], v61 offset:8192
    ds_read_b64_tr_b16 a[118:119], v61 offset:9216
    v_mfma_f32_16x16x32_bf16 a[60:63], a[124:127], v[164:167], a[60:63]
    s_mov_b32 s95, 1966080
    v_cvt_pk_bf16_f32 v188, v72, v73
    v_cvt_pk_bf16_f32 v189, v74, v75
    v_mfma_f32_16x16x32_bf16 a[0:3], a[96:99], v[168:171], a[0:3]
    s_waitcnt lgkmcnt(8)
    ds_read_b64_tr_b16 a[120:121], v62 offset:8192
    ds_read_b64_tr_b16 a[122:123], v62 offset:9216
    v_mfma_f32_16x16x32_bf16 a[8:11], a[96:99], v[172:175], a[8:11]
    s_add_u32 m0, s60, 131072
    v_cvt_pk_bf16_f32 v190, v76, v77
    v_cvt_pk_bf16_f32 v191, v78, v79
    v_mfma_f32_16x16x32_bf16 a[4:7], a[100:103], v[168:171], a[4:7]
    s_waitcnt lgkmcnt(8)
    ds_read_b64_tr_b16 a[124:125], v63 offset:8192
    ds_read_b64_tr_b16 a[126:127], v63 offset:9216
    v_mfma_f32_16x16x32_bf16 a[12:15], a[100:103], v[172:175], a[12:15]
    buffer_load_dwordx4 v34, s[28:31], s95 offen offset:0 lds
    v_mfma_f32_16x16x32_bf16 a[16:19], a[104:107], v[168:171], a[16:19]
    s_waitcnt lgkmcnt(8)
    ds_read_b64_tr_b16 a[96:97], v56 offset:16384
    ds_read_b64_tr_b16 a[98:99], v56 offset:17408
    v_mfma_f32_16x16x32_bf16 a[24:27], a[104:107], v[172:175], a[24:27]
    buffer_load_dword v19, v9, s[48:51], 0 offen sc1
    v_mfma_f32_16x16x32_bf16 a[20:23], a[108:111], v[168:171], a[20:23]
    s_waitcnt lgkmcnt(8)
    ds_read_b64_tr_b16 a[100:101], v57 offset:16384
    ds_read_b64_tr_b16 a[102:103], v57 offset:17408
    v_mfma_f32_16x16x32_bf16 a[28:31], a[108:111], v[172:175], a[28:31]
    s_mov_b32 s61, 1980416
    v_cvt_pk_bf16_f32 v192, v80, v81
    v_cvt_pk_bf16_f32 v193, v82, v83
    v_mfma_f32_16x16x32_bf16 a[32:35], a[112:115], v[168:171], a[32:35]
    s_waitcnt lgkmcnt(8)
    ds_read_b64_tr_b16 a[104:105], v58 offset:16384
    ds_read_b64_tr_b16 a[106:107], v58 offset:17408
    v_mfma_f32_16x16x32_bf16 a[40:43], a[112:115], v[172:175], a[40:43]
    buffer_load_dwordx4 v34, s[28:31], s61 offen offset:1024 lds
    v_mfma_f32_16x16x32_bf16 a[36:39], a[116:119], v[168:171], a[36:39]
    s_waitcnt lgkmcnt(8)
    ds_read_b64_tr_b16 a[108:109], v59 offset:16384
    ds_read_b64_tr_b16 a[110:111], v59 offset:17408
    v_mfma_f32_16x16x32_bf16 a[44:47], a[116:119], v[172:175], a[44:47]
    s_mov_b32 s95, 2025472
    v_cvt_pk_bf16_f32 v194, v84, v85
    v_cvt_pk_bf16_f32 v195, v86, v87
    v_mfma_f32_16x16x32_bf16 a[48:51], a[120:123], v[168:171], a[48:51]
    s_waitcnt lgkmcnt(8)
    ds_read_b64_tr_b16 a[112:113], v60 offset:16384
    ds_read_b64_tr_b16 a[114:115], v60 offset:17408
    v_mfma_f32_16x16x32_bf16 a[56:59], a[120:123], v[172:175], a[56:59]
    buffer_load_dwordx4 v34, s[28:31], s95 offen offset:2048 lds
    v_mfma_f32_16x16x32_bf16 a[52:55], a[124:127], v[168:171], a[52:55]
    s_waitcnt lgkmcnt(8)
    ds_read_b64_tr_b16 a[116:117], v61 offset:16384
    ds_read_b64_tr_b16 a[118:119], v61 offset:17408
    v_mfma_f32_16x16x32_bf16 a[60:63], a[124:127], v[172:175], a[60:63]
    s_mov_b32 s61, 2039808
    v_cvt_pk_bf16_f32 v196, v88, v89
    v_cvt_pk_bf16_f32 v197, v90, v91
    v_mfma_f32_16x16x32_bf16 a[0:3], a[96:99], v[176:179], a[0:3]
    s_waitcnt lgkmcnt(8)
    ds_read_b64_tr_b16 a[120:121], v62 offset:16384
    ds_read_b64_tr_b16 a[122:123], v62 offset:17408
    v_mfma_f32_16x16x32_bf16 a[8:11], a[96:99], v[180:183], a[8:11]
    buffer_load_dwordx4 v34, s[28:31], s61 offen offset:3072 lds
    v_mfma_f32_16x16x32_bf16 a[4:7], a[100:103], v[176:179], a[4:7]
    s_waitcnt lgkmcnt(8)
    ds_read_b64_tr_b16 a[124:125], v63 offset:16384
    ds_read_b64_tr_b16 a[126:127], v63 offset:17408
    v_mfma_f32_16x16x32_bf16 a[12:15], a[100:103], v[180:183], a[12:15]
    s_add_u32 m0, s60, 0
    v_cvt_pk_bf16_f32 v198, v92, v93
    v_cvt_pk_bf16_f32 v199, v94, v95
    v_mfma_f32_4x4x4bf16_1k v[64:67], v[38:39], v[200:201], v[48:51]
    v_mfma_f32_4x4x4bf16_1k v[68:71], v[38:39], v[202:203], v[48:51]
    v_mfma_f32_4x4x4bf16_1k v[72:75], v[38:39], v[204:205], v[52:55]
    v_mfma_f32_4x4x4bf16_1k v[76:79], v[38:39], v[206:207], v[52:55]
    v_mfma_f32_4x4x4bf16_1k v[80:83], v[38:39], v[208:209], v[48:51]
    v_mfma_f32_4x4x4bf16_1k v[84:87], v[38:39], v[210:211], v[48:51]
    v_mfma_f32_4x4x4bf16_1k v[88:91], v[38:39], v[212:213], v[52:55]
    v_mfma_f32_4x4x4bf16_1k v[92:95], v[38:39], v[214:215], v[52:55]
    v_mfma_f32_16x16x32_bf16 a[16:19], a[104:107], v[176:179], a[16:19]
    s_waitcnt lgkmcnt(8)
    ds_read_b64_tr_b16 a[96:97], v56 offset:24576
    ds_read_b64_tr_b16 a[98:99], v56 offset:25600
    v_mfma_f32_16x16x32_bf16 a[24:27], a[104:107], v[180:183], a[24:27]
    s_mov_b32 s95, 2211840
    buffer_load_dwordx4 v34, s[28:31], s95 offen offset:0 lds
    v_mfma_f32_16x16x32_bf16 a[20:23], a[108:111], v[176:179], a[20:23]
    s_waitcnt lgkmcnt(8)
    ds_read_b64_tr_b16 a[100:101], v57 offset:24576
    ds_read_b64_tr_b16 a[102:103], v57 offset:25600
    v_mfma_f32_16x16x32_bf16 a[28:31], a[108:111], v[180:183], a[28:31]
    s_mov_b32 s61, 2226176
    buffer_load_dwordx4 v34, s[28:31], s61 offen offset:1024 lds
    v_mfma_f32_16x16x32_bf16 a[32:35], a[112:115], v[176:179], a[32:35]
    s_waitcnt lgkmcnt(8)
    ds_read_b64_tr_b16 a[104:105], v58 offset:24576
    ds_read_b64_tr_b16 a[106:107], v58 offset:25600
    v_mfma_f32_16x16x32_bf16 a[40:43], a[112:115], v[180:183], a[40:43]
    s_mov_b32 s95, 2271232
    buffer_load_dwordx4 v34, s[28:31], s95 offen offset:2048 lds
    v_mfma_f32_16x16x32_bf16 a[36:39], a[116:119], v[176:179], a[36:39]
    s_waitcnt lgkmcnt(8)
    ds_read_b64_tr_b16 a[108:109], v59 offset:24576
    ds_read_b64_tr_b16 a[110:111], v59 offset:25600
    v_mfma_f32_16x16x32_bf16 a[44:47], a[116:119], v[180:183], a[44:47]
    s_mov_b32 s61, 2285568
    v_cvt_pk_bf16_f32 v200, v64, v65
    v_cvt_pk_bf16_f32 v201, v66, v67
    v_mfma_f32_16x16x32_bf16 a[48:51], a[120:123], v[176:179], a[48:51]
    s_waitcnt lgkmcnt(8)
    ds_read_b64_tr_b16 a[112:113], v60 offset:24576
    ds_read_b64_tr_b16 a[114:115], v60 offset:25600
    v_mfma_f32_16x16x32_bf16 a[56:59], a[120:123], v[180:183], a[56:59]
    buffer_load_dwordx4 v34, s[28:31], s61 offen offset:3072 lds
    v_mfma_f32_16x16x32_bf16 a[52:55], a[124:127], v[176:179], a[52:55]
    s_waitcnt lgkmcnt(8)
    ds_read_b64_tr_b16 a[116:117], v61 offset:24576
    ds_read_b64_tr_b16 a[118:119], v61 offset:25600
    v_mfma_f32_16x16x32_bf16 a[60:63], a[124:127], v[180:183], a[60:63]
    s_add_u32 m0, s60, 16384
    v_cvt_pk_bf16_f32 v202, v68, v69
    v_cvt_pk_bf16_f32 v203, v70, v71
    v_mfma_f32_16x16x32_bf16 a[0:3], a[96:99], v[184:187], a[0:3]
    s_waitcnt lgkmcnt(8)
    ds_read_b64_tr_b16 a[120:121], v62 offset:24576
    ds_read_b64_tr_b16 a[122:123], v62 offset:25600
    v_mfma_f32_16x16x32_bf16 a[8:11], a[96:99], v[188:191], a[8:11]
    s_mov_b32 s95, 0
    buffer_load_dwordx4 v2, s[32:35], s95 offen offset:0 lds
    v_mfma_f32_16x16x32_bf16 a[4:7], a[100:103], v[184:187], a[4:7]
    s_waitcnt lgkmcnt(8)
    ds_read_b64_tr_b16 a[124:125], v63 offset:24576
    ds_read_b64_tr_b16 a[126:127], v63 offset:25600
    v_mfma_f32_16x16x32_bf16 a[12:15], a[100:103], v[188:191], a[12:15]
    s_mov_b32 s61, 11264
    v_cvt_pk_bf16_f32 v204, v72, v73
    v_cvt_pk_bf16_f32 v205, v74, v75
    v_mfma_f32_16x16x32_bf16 a[16:19], a[104:107], v[184:187], a[16:19]
    s_waitcnt lgkmcnt(8)
    s_waitcnt vmcnt(11)
    s_barrier
    ds_read_b64_tr_b16 a[96:97], v56 offset:32768
    ds_read_b64_tr_b16 a[98:99], v56 offset:33792
    v_mfma_f32_16x16x32_bf16 a[24:27], a[104:107], v[188:191], a[24:27]
    buffer_load_dwordx4 v2, s[32:35], s61 offen offset:1024 lds
    v_mfma_f32_16x16x32_bf16 a[20:23], a[108:111], v[184:187], a[20:23]
    s_waitcnt lgkmcnt(8)
    ds_read_b64_tr_b16 a[100:101], v57 offset:32768
    ds_read_b64_tr_b16 a[102:103], v57 offset:33792
    v_mfma_f32_16x16x32_bf16 a[28:31], a[108:111], v[188:191], a[28:31]
    s_mov_b32 s95, 47104
    v_cvt_pk_bf16_f32 v206, v76, v77
    v_cvt_pk_bf16_f32 v207, v78, v79
    v_mfma_f32_16x16x32_bf16 a[32:35], a[112:115], v[184:187], a[32:35]
    s_waitcnt lgkmcnt(8)
    ds_read_b64_tr_b16 a[104:105], v58 offset:32768
    ds_read_b64_tr_b16 a[106:107], v58 offset:33792
    v_mfma_f32_16x16x32_bf16 a[40:43], a[112:115], v[188:191], a[40:43]
    buffer_load_dwordx4 v2, s[32:35], s95 offen offset:2048 lds
    v_mfma_f32_16x16x32_bf16 a[36:39], a[116:119], v[184:187], a[36:39]
    s_waitcnt lgkmcnt(8)
    ds_read_b64_tr_b16 a[108:109], v59 offset:32768
    ds_read_b64_tr_b16 a[110:111], v59 offset:33792
    v_mfma_f32_16x16x32_bf16 a[44:47], a[116:119], v[188:191], a[44:47]
    s_mov_b32 s61, 58368
    v_cvt_pk_bf16_f32 v208, v80, v81
    v_cvt_pk_bf16_f32 v209, v82, v83
    v_mfma_f32_16x16x32_bf16 a[48:51], a[120:123], v[184:187], a[48:51]
    s_waitcnt lgkmcnt(8)
    ds_read_b64_tr_b16 a[112:113], v60 offset:32768
    ds_read_b64_tr_b16 a[114:115], v60 offset:33792
    v_mfma_f32_16x16x32_bf16 a[56:59], a[120:123], v[188:191], a[56:59]
    buffer_load_dwordx4 v2, s[32:35], s61 offen offset:3072 lds
    v_mfma_f32_16x16x32_bf16 a[52:55], a[124:127], v[184:187], a[52:55]
    s_waitcnt lgkmcnt(8)
    ds_read_b64_tr_b16 a[116:117], v61 offset:32768
    ds_read_b64_tr_b16 a[118:119], v61 offset:33792
    v_mfma_f32_16x16x32_bf16 a[60:63], a[124:127], v[188:191], a[60:63]
    s_add_u32 m0, s60, 32768
    v_cvt_pk_bf16_f32 v210, v84, v85
    v_cvt_pk_bf16_f32 v211, v86, v87
    v_add_u32 v42, 131072, v42
    v_mfma_f32_16x16x32_bf16 a[0:3], a[96:99], v[192:195], a[0:3]
    s_waitcnt lgkmcnt(8)
    ds_read_b64_tr_b16 a[120:121], v62 offset:32768
    ds_read_b64_tr_b16 a[122:123], v62 offset:33792
L_page1:
    s_cbranch_execz L_tret0
    v_mfma_f32_16x16x32_bf16 a[8:11], a[96:99], v[196:199], a[8:11]
    s_mov_b32 s95, 196608
    buffer_load_dwordx4 v2, s[32:35], s95 offen offset:0 lds
    v_mfma_f32_16x16x32_bf16 a[4:7], a[100:103], v[192:195], a[4:7]
    s_waitcnt lgkmcnt(8)
    ds_read_b64_tr_b16 a[124:125], v63 offset:32768
    ds_read_b64_tr_b16 a[126:127], v63 offset:33792
    v_mfma_f32_16x16x32_bf16 a[12:15], a[100:103], v[196:199], a[12:15]
    s_mov_b32 s61, 207872
    s_waitcnt vmcnt(14)
    ds_read_b64_tr_b16 a[128:129], v42 offset:16384
    ds_read_b64_tr_b16 a[130:131], v42 offset:16896
    v_cvt_pk_bf16_f32 v212, v88, v89
    v_cvt_pk_bf16_f32 v213, v90, v91
    v_mfma_f32_16x16x32_bf16 a[16:19], a[104:107], v[192:195], a[16:19]
    s_waitcnt lgkmcnt(10)
    ds_read_b64_tr_b16 a[96:97], v56 offset:40960
    ds_read_b64_tr_b16 a[98:99], v56 offset:41984
    v_mfma_f32_16x16x32_bf16 a[24:27], a[104:107], v[196:199], a[24:27]
    buffer_load_dwordx4 v2, s[32:35], s61 offen offset:1024 lds
    ds_read_b64_tr_b16 a[132:133], v42 offset:16416
    ds_read_b64_tr_b16 a[134:135], v42 offset:16928
    v_mfma_f32_16x16x32_bf16 a[20:23], a[108:111], v[192:195], a[20:23]
    s_waitcnt lgkmcnt(12)
    ds_read_b64_tr_b16 a[100:101], v57 offset:40960
    ds_read_b64_tr_b16 a[102:103], v57 offset:41984
    v_mfma_f32_16x16x32_bf16 a[28:31], a[108:111], v[196:199], a[28:31]
    s_mov_b32 s95, 243712
    ds_read_b64_tr_b16 a[136:137], v42 offset:16448
    ds_read_b64_tr_b16 a[138:139], v42 offset:16960
    v_cvt_pk_bf16_f32 v214, v92, v93
    v_cvt_pk_bf16_f32 v215, v94, v95
    v_mfma_f32_4x4x4bf16_1k v[64:67], v[38:39], v[216:217], v[48:51]
    v_mfma_f32_4x4x4bf16_1k v[68:71], v[38:39], v[218:219], v[48:51]
    v_mfma_f32_4x4x4bf16_1k v[72:75], v[38:39], v[220:221], v[52:55]
    v_mfma_f32_4x4x4bf16_1k v[76:79], v[38:39], v[222:223], v[52:55]
    v_mfma_f32_4x4x4bf16_1k v[80:83], v[38:39], v[224:225], v[48:51]
    v_mfma_f32_4x4x4bf16_1k v[84:87], v[38:39], v[226:227], v[48:51]
    v_mfma_f32_4x4x4bf16_1k v[88:91], v[38:39], v[228:229], v[52:55]
    v_mfma_f32_4x4x4bf16_1k v[92:95], v[38:39], v[230:231], v[52:55]
    v_mfma_f32_16x16x32_bf16 a[32:35], a[112:115], v[192:195], a[32:35]
    s_waitcnt lgkmcnt(14)
    ds_read_b64_tr_b16 a[104:105], v58 offset:40960
    ds_read_b64_tr_b16 a[106:107], v58 offset:41984
    v_mfma_f32_16x16x32_bf16 a[40:43], a[112:115], v[196:199], a[40:43]
    buffer_load_dwordx4 v2, s[32:35], s95 offen offset:2048 lds
    ds_read_b64_tr_b16 a[140:141], v42 offset:16480
    ds_read_b64_tr_b16 a[142:143], v42 offset:16992
    s_waitcnt vmcnt(14)
    v_cmp_ne_u32 vcc, 1, v19
    s_nop 1
    s_cbranch_vccnz L_retry0
L_cont0:
    v_mfma_f32_16x16x32_bf16 a[36:39], a[116:119], v[192:195], a[36:39]
    s_waitcnt lgkmcnt(15)
    ds_read_b64_tr_b16 a[108:109], v59 offset:40960
    ds_read_b64_tr_b16 a[110:111], v59 offset:41984
    v_mfma_f32_16x16x32_bf16 a[44:47], a[116:119], v[196:199], a[44:47]
    s_mov_b32 s61, 254976
    buffer_load_dwordx4 v2, s[32:35], s61 offen offset:3072 lds
    v_mfma_f32_16x16x32_bf16 a[48:51], a[120:123], v[192:195], a[48:51]
    s_waitcnt lgkmcnt(15)
    ds_read_b64_tr_b16 a[112:113], v60 offset:40960
    ds_read_b64_tr_b16 a[114:115], v60 offset:41984
    v_mfma_f32_16x16x32_bf16 a[56:59], a[120:123], v[196:199], a[56:59]
    s_add_u32 m0, s60, 49152
    s_mov_b32 s95, 393216
    buffer_load_dwordx4 v2, s[32:35], s95 offen offset:0 lds
    v_mfma_f32_16x16x32_bf16 a[52:55], a[124:127], v[192:195], a[52:55]
    s_waitcnt lgkmcnt(14)
    ds_read_b64_tr_b16 a[116:117], v61 offset:40960
    ds_read_b64_tr_b16 a[118:119], v61 offset:41984
    v_mfma_f32_16x16x32_bf16 a[60:63], a[124:127], v[196:199], a[60:63]
    s_mov_b32 s61, 404480
    buffer_load_dwordx4 v2, s[32:35], s61 offen offset:1024 lds
    v_mfma_f32_16x16x32_bf16 a[0:3], a[96:99], v[200:203], a[0:3]
    s_waitcnt lgkmcnt(12)
    ds_read_b64_tr_b16 a[120:121], v62 offset:40960
    ds_read_b64_tr_b16 a[122:123], v62 offset:41984
    v_mfma_f32_16x16x32_bf16 a[8:11], a[96:99], v[204:207], a[8:11]
    v_cvt_pk_bf16_f32 v216, v64, v65
    v_cvt_pk_bf16_f32 v217, v66, v67
    v_mfma_f32_16x16x32_bf16 a[4:7], a[100:103], v[200:203], a[4:7]
    s_waitcnt lgkmcnt(10)
    ds_read_b64_tr_b16 a[124:125], v63 offset:40960
    ds_read_b64_tr_b16 a[126:127], v63 offset:41984
    v_mfma_f32_16x16x32_bf16 a[12:15], a[100:103], v[204:207], a[12:15]
    s_waitcnt lgkmcnt(10)
    buffer_store_dwordx4 a[128:131], v43, s[44:47], 0 offen offset:0 sc1
    v_mfma_f32_16x16x32_bf16 a[16:19], a[104:107], v[200:203], a[16:19]
    s_waitcnt lgkmcnt(8)
    ds_read_b64_tr_b16 a[96:97], v56 offset:49152
    ds_read_b64_tr_b16 a[98:99], v56 offset:50176
    v_mfma_f32_16x16x32_bf16 a[24:27], a[104:107], v[204:207], a[24:27]
    v_cvt_pk_bf16_f32 v218, v68, v69
    v_cvt_pk_bf16_f32 v219, v70, v71
    v_mfma_f32_16x16x32_bf16 a[20:23], a[108:111], v[200:203], a[20:23]
    s_waitcnt lgkmcnt(8)
    ds_read_b64_tr_b16 a[100:101], v57 offset:49152
    ds_read_b64_tr_b16 a[102:103], v57 offset:50176
    v_mfma_f32_16x16x32_bf16 a[28:31], a[108:111], v[204:207], a[28:31]
    v_cvt_pk_bf16_f32 v220, v72, v73
    v_cvt_pk_bf16_f32 v221, v74, v75
    v_mfma_f32_16x16x32_bf16 a[32:35], a[112:115], v[200:203], a[32:35]
    s_waitcnt lgkmcnt(8)
    ds_read_b64_tr_b16 a[104:105], v58 offset:49152
    ds_read_b64_tr_b16 a[106:107], v58 offset:50176
    v_mfma_f32_16x16x32_bf16 a[40:43], a[112:115], v[204:207], a[40:43]
    v_cvt_pk_bf16_f32 v222, v76, v77
    v_cvt_pk_bf16_f32 v223, v78, v79
    v_mfma_f32_16x16x32_bf16 a[36:39], a[116:119], v[200:203], a[36:39]
    s_waitcnt lgkmcnt(8)
    ds_read_b64_tr_b16 a[108:109], v59 offset:49152
    ds_read_b64_tr_b16 a[110:111], v59 offset:50176
    v_mfma_f32_16x16x32_bf16 a[44:47], a[116:119], v[204:207], a[44:47]
    v_cvt_pk_bf16_f32 v224, v80, v81
    v_cvt_pk_bf16_f32 v225, v82, v83
    v_mfma_f32_16x16x32_bf16 a[48:51], a[120:123], v[200:203], a[48:51]
    s_waitcnt lgkmcnt(8)
    ds_read_b64_tr_b16 a[112:113], v60 offset:49152
    ds_read_b64_tr_b16 a[114:115], v60 offset:50176
    v_mfma_f32_16x16x32_bf16 a[56:59], a[120:123], v[204:207], a[56:59]
    v_cvt_pk_bf16_f32 v226, v84, v85
    v_cvt_pk_bf16_f32 v227, v86, v87
    v_mfma_f32_16x16x32_bf16 a[52:55], a[124:127], v[200:203], a[52:55]
    s_waitcnt lgkmcnt(8)
    ds_read_b64_tr_b16 a[116:117], v61 offset:49152
    ds_read_b64_tr_b16 a[118:119], v61 offset:50176
    v_mfma_f32_16x16x32_bf16 a[60:63], a[124:127], v[204:207], a[60:63]
    v_cvt_pk_bf16_f32 v228, v88, v89
    v_cvt_pk_bf16_f32 v229, v90, v91
    v_mfma_f32_16x16x32_bf16 a[0:3], a[96:99], v[208:211], a[0:3]
    s_waitcnt lgkmcnt(8)
    ds_read_b64_tr_b16 a[120:121], v62 offset:49152
    ds_read_b64_tr_b16 a[122:123], v62 offset:50176
    v_mfma_f32_16x16x32_bf16 a[8:11], a[96:99], v[212:215], a[8:11]
    s_mov_b32 s95, 440320
    v_cvt_pk_bf16_f32 v230, v92, v93
    v_cvt_pk_bf16_f32 v231, v94, v95
    v_mfma_f32_4x4x4bf16_1k v[64:67], v[38:39], v[232:233], v[48:51]
    v_mfma_f32_4x4x4bf16_1k v[68:71], v[38:39], v[234:235], v[48:51]
    v_mfma_f32_4x4x4bf16_1k v[72:75], v[38:39], v[236:237], v[52:55]
    v_mfma_f32_4x4x4bf16_1k v[76:79], v[38:39], v[238:239], v[52:55]
    v_mfma_f32_4x4x4bf16_1k v[80:83], v[38:39], v[240:241], v[48:51]
    v_mfma_f32_4x4x4bf16_1k v[84:87], v[38:39], v[242:243], v[48:51]
    v_mfma_f32_4x4x4bf16_1k v[88:91], v[38:39], v[244:245], v[52:55]
    v_mfma_f32_4x4x4bf16_1k v[92:95], v[38:39], v[246:247], v[52:55]
    v_mfma_f32_16x16x32_bf16 a[4:7], a[100:103], v[208:211], a[4:7]
    s_waitcnt lgkmcnt(8)
    ds_read_b64_tr_b16 a[124:125], v63 offset:49152
    ds_read_b64_tr_b16 a[126:127], v63 offset:50176
    v_mfma_f32_16x16x32_bf16 a[12:15], a[100:103], v[212:215], a[12:15]
    buffer_load_dwordx4 v2, s[32:35], s95 offen offset:2048 lds
    v_mfma_f32_16x16x32_bf16 a[16:19], a[104:107], v[208:211], a[16:19]
    s_waitcnt lgkmcnt(8)
    ds_read_b64_tr_b16 a[96:97], v56 offset:57344
    ds_read_b64_tr_b16 a[98:99], v56 offset:58368
    v_mfma_f32_16x16x32_bf16 a[24:27], a[104:107], v[212:215], a[24:27]
    buffer_store_dwordx4 a[132:135], v43, s[44:47], 0 offen offset:1024 sc1
    v_mfma_f32_16x16x32_bf16 a[20:23], a[108:111], v[208:211], a[20:23]
    s_waitcnt lgkmcnt(8)
    ds_read_b64_tr_b16 a[100:101], v57 offset:57344
    ds_read_b64_tr_b16 a[102:103], v57 offset:58368
    v_mfma_f32_16x16x32_bf16 a[28:31], a[108:111], v[212:215], a[28:31]
    v_cvt_pk_bf16_f32 v232, v64, v65
    v_cvt_pk_bf16_f32 v233, v66, v67
    v_mfma_f32_16x16x32_bf16 a[32:35], a[112:115], v[208:211], a[32:35]
    s_waitcnt lgkmcnt(8)
    ds_read_b64_tr_b16 a[104:105], v58 offset:57344
    ds_read_b64_tr_b16 a[106:107], v58 offset:58368
    v_mfma_f32_16x16x32_bf16 a[40:43], a[112:115], v[212:215], a[40:43]
    v_cvt_pk_bf16_f32 v234, v68, v69
    v_cvt_pk_bf16_f32 v235, v70, v71
    v_mfma_f32_16x16x32_bf16 a[36:39], a[116:119], v[208:211], a[36:39]
    s_waitcnt lgkmcnt(8)
    ds_read_b64_tr_b16 a[108:109], v59 offset:57344
    ds_read_b64_tr_b16 a[110:111], v59 offset:58368
    v_mfma_f32_16x16x32_bf16 a[44:47], a[116:119], v[212:215], a[44:47]
    v_cvt_pk_bf16_f32 v236, v72, v73
    v_cvt_pk_bf16_f32 v237, v74, v75
    v_mfma_f32_16x16x32_bf16 a[48:51], a[120:123], v[208:211], a[48:51]
    s_waitcnt lgkmcnt(8)
    ds_read_b64_tr_b16 a[112:113], v60 offset:57344
    ds_read_b64_tr_b16 a[114:115], v60 offset:58368
    v_mfma_f32_16x16x32_bf16 a[56:59], a[120:123], v[212:215], a[56:59]
    v_cvt_pk_bf16_f32 v238, v76, v77
    v_cvt_pk_bf16_f32 v239, v78, v79
    v_mfma_f32_16x16x32_bf16 a[52:55], a[124:127], v[208:211], a[52:55]
    s_waitcnt lgkmcnt(8)
    ds_read_b64_tr_b16 a[116:117], v61 offset:57344
    ds_read_b64_tr_b16 a[118:119], v61 offset:58368
    v_mfma_f32_16x16x32_bf16 a[60:63], a[124:127], v[212:215], a[60:63]
    v_cvt_pk_bf16_f32 v240, v80, v81
    v_cvt_pk_bf16_f32 v241, v82, v83
    v_mfma_f32_16x16x32_bf16 a[0:3], a[96:99], v[216:219], a[0:3]
    s_waitcnt lgkmcnt(8)
    ds_read_b64_tr_b16 a[120:121], v62 offset:57344
    ds_read_b64_tr_b16 a[122:123], v62 offset:58368
    v_mfma_f32_16x16x32_bf16 a[8:11], a[96:99], v[220:223], a[8:11]
    v_cvt_pk_bf16_f32 v242, v84, v85
    v_cvt_pk_bf16_f32 v243, v86, v87
    v_add_u32 v57, 65536, v57
    v_mfma_f32_16x16x32_bf16 a[4:7], a[100:103], v[216:219], a[4:7]
    s_waitcnt lgkmcnt(8)
    ds_read_b64_tr_b16 a[124:125], v63 offset:57344
    ds_read_b64_tr_b16 a[126:127], v63 offset:58368
    v_mfma_f32_16x16x32_bf16 a[12:15], a[100:103], v[220:223], a[12:15]
    s_mov_b32 s61, 451584
    v_cvt_pk_bf16_f32 v244, v88, v89
    v_cvt_pk_bf16_f32 v245, v90, v91
    v_add_u32 v56, 65536, v56
    v_mfma_f32_16x16x32_bf16 a[16:19], a[104:107], v[216:219], a[16:19]
    s_waitcnt lgkmcnt(8)
    s_waitcnt vmcnt(13)
    s_barrier
    ds_read_b64_tr_b16 a[96:97], v56 offset:0
    ds_read_b64_tr_b16 a[98:99], v56 offset:1024
    v_mfma_f32_16x16x32_bf16 a[24:27], a[104:107], v[220:223], a[24:27]
    buffer_load_dwordx4 v2, s[32:35], s61 offen offset:3072 lds
    v_mfma_f32_16x16x32_bf16 a[20:23], a[108:111], v[216:219], a[20:23]
    s_waitcnt lgkmcnt(8)
    ds_read_b64_tr_b16 a[100:101], v57 offset:0
    ds_read_b64_tr_b16 a[102:103], v57 offset:1024
    v_mfma_f32_16x16x32_bf16 a[28:31], a[108:111], v[220:223], a[28:31]
    v_cvt_pk_bf16_f32 v246, v92, v93
    v_cvt_pk_bf16_f32 v247, v94, v95
    v_add_u32 v58, 65536, v58
    v_mfma_f32_4x4x4bf16_1k v[64:67], v[38:39], v[248:249], v[48:51]
    v_mfma_f32_4x4x4bf16_1k v[68:71], v[38:39], v[250:251], v[48:51]
    v_mfma_f32_4x4x4bf16_1k v[72:75], v[38:39], v[252:253], v[52:55]
    v_mfma_f32_4x4x4bf16_1k v[76:79], v[38:39], v[254:255], v[52:55]
    v_mfma_f32_16x16x32_bf16 a[32:35], a[112:115], v[216:219], a[32:35]
    s_waitcnt lgkmcnt(8)
    ds_read_b64_tr_b16 a[104:105], v58 offset:0
    ds_read_b64_tr_b16 a[106:107], v58 offset:1024
    v_mfma_f32_16x16x32_bf16 a[40:43], a[112:115], v[220:223], a[40:43]
    buffer_store_dwordx4 a[136:139], v43, s[44:47], 0 offen offset:2048 sc1
    v_add_u32 v59, 65536, v59
    v_mfma_f32_16x16x32_bf16 a[36:39], a[116:119], v[216:219], a[36:39]
    s_waitcnt lgkmcnt(8)
    ds_read_b64_tr_b16 a[108:109], v59 offset:0
    ds_read_b64_tr_b16 a[110:111], v59 offset:1024
    v_mfma_f32_16x16x32_bf16 a[44:47], a[116:119], v[220:223], a[44:47]
    v_cvt_pk_bf16_f32 v248, v64, v65
    v_cvt_pk_bf16_f32 v249, v66, v67
    v_add_u32 v60, 65536, v60
    v_mfma_f32_16x16x32_bf16 a[48:51], a[120:123], v[216:219], a[48:51]
    s_waitcnt lgkmcnt(8)
    ds_read_b64_tr_b16 a[112:113], v60 offset:0
    ds_read_b64_tr_b16 a[114:115], v60 offset:1024
    v_mfma_f32_16x16x32_bf16 a[56:59], a[120:123], v[220:223], a[56:59]
    v_cvt_pk_bf16_f32 v250, v68, v69
    v_cvt_pk_bf16_f32 v251, v70, v71
    v_add_u32 v61, 65536, v61
    v_mfma_f32_16x16x32_bf16 a[52:55], a[124:127], v[216:219], a[52:55]
    s_waitcnt lgkmcnt(8)
    ds_read_b64_tr_b16 a[116:117], v61 offset:0
    ds_read_b64_tr_b16 a[118:119], v61 offset:1024
    v_mfma_f32_16x16x32_bf16 a[60:63], a[124:127], v[220:223], a[60:63]
    v_cvt_pk_bf16_f32 v252, v72, v73
    v_cvt_pk_bf16_f32 v253, v74, v75
    v_add_u32 v62, 65536, v62
    v_mfma_f32_16x16x32_bf16 a[0:3], a[96:99], v[224:227], a[0:3]
    s_waitcnt lgkmcnt(8)
    ds_read_b64_tr_b16 a[120:121], v62 offset:0
    ds_read_b64_tr_b16 a[122:123], v62 offset:1024
    v_mfma_f32_16x16x32_bf16 a[8:11], a[96:99], v[228:231], a[8:11]
    v_cvt_pk_bf16_f32 v254, v76, v77
    v_cvt_pk_bf16_f32 v255, v78, v79
    v_add_u32 v63, 65536, v63
    v_mfma_f32_16x16x32_bf16 a[4:7], a[100:103], v[224:227], a[4:7]
    s_waitcnt lgkmcnt(8)
    ds_read_b64_tr_b16 a[124:125], v63 offset:0
    ds_read_b64_tr_b16 a[126:127], v63 offset:1024
    v_mfma_f32_16x16x32_bf16 a[12:15], a[100:103], v[228:231], a[12:15]
    s_mov_b32 s95, 589824
    v_permlane16_swap_b32 v46, v47
    v_add_f32 v46, v46, v47
    v_mfma_f32_16x16x32_bf16 a[16:19], a[104:107], v[224:227], a[16:19]
    s_waitcnt lgkmcnt(8)
    ds_read_b64_tr_b16 a[96:97], v56 offset:8192
    ds_read_b64_tr_b16 a[98:99], v56 offset:9216
    v_mfma_f32_16x16x32_bf16 a[24:27], a[104:107], v[228:231], a[24:27]
    s_add_u32 m0, s60, 65536
    v_mov_b32 v47, v46
    v_accvgpr_write_b32 a64, v184
    v_mfma_f32_16x16x32_bf16 a[20:23], a[108:111], v[224:227], a[20:23]
    s_waitcnt lgkmcnt(8)
    ds_read_b64_tr_b16 a[100:101], v57 offset:8192
    ds_read_b64_tr_b16 a[102:103], v57 offset:9216
    v_mfma_f32_16x16x32_bf16 a[28:31], a[108:111], v[228:231], a[28:31]
    buffer_load_dwordx4 v2, s[32:35], s95 offen offset:0 lds
    v_mfma_f32_16x16x32_bf16 a[32:35], a[112:115], v[224:227], a[32:35]
    s_waitcnt lgkmcnt(8)
    ds_read_b64_tr_b16 a[104:105], v58 offset:8192
    ds_read_b64_tr_b16 a[106:107], v58 offset:9216
    v_mfma_f32_16x16x32_bf16 a[40:43], a[112:115], v[228:231], a[40:43]
    s_mov_b32 s61, 601088
    v_permlane32_swap_b32 v46, v47
    v_add_f32 v46, v46, v47
    v_mfma_f32_16x16x32_bf16 a[36:39], a[116:119], v[224:227], a[36:39]
    s_waitcnt lgkmcnt(8)
    ds_read_b64_tr_b16 a[108:109], v59 offset:8192
    ds_read_b64_tr_b16 a[110:111], v59 offset:9216
    v_mfma_f32_16x16x32_bf16 a[44:47], a[116:119], v[228:231], a[44:47]
    buffer_load_dwordx4 v2, s[32:35], s61 offen offset:1024 lds
    v_mfma_f32_16x16x32_bf16 a[48:51], a[120:123], v[224:227], a[48:51]
    s_waitcnt lgkmcnt(8)
    ds_read_b64_tr_b16 a[112:113], v60 offset:8192
    ds_read_b64_tr_b16 a[114:115], v60 offset:9216
    v_mfma_f32_16x16x32_bf16 a[56:59], a[120:123], v[228:231], a[56:59]
    v_mul_f32 v33, 0x3acccccd, v46
    v_fma_f32 v33, -v32, v32, v33
    v_mfma_f32_16x16x32_bf16 a[52:55], a[124:127], v[224:227], a[52:55]
    s_waitcnt lgkmcnt(8)
    ds_read_b64_tr_b16 a[116:117], v61 offset:8192
    ds_read_b64_tr_b16 a[118:119], v61 offset:9216
    v_mfma_f32_16x16x32_bf16 a[60:63], a[124:127], v[228:231], a[60:63]
    buffer_store_dwordx4 a[140:143], v43, s[44:47], 0 offen offset:3072 sc1
    v_mfma_f32_16x16x32_bf16 a[0:3], a[96:99], v[232:235], a[0:3]
    s_waitcnt lgkmcnt(8)
    ds_read_b64_tr_b16 a[120:121], v62 offset:8192
    ds_read_b64_tr_b16 a[122:123], v62 offset:9216
    v_mfma_f32_16x16x32_bf16 a[8:11], a[96:99], v[236:239], a[8:11]
    v_max_f32 v33, 0, v33
    v_cvt_pk_bf16_f32 v33, v33, v33
    v_mfma_f32_16x16x32_bf16 a[4:7], a[100:103], v[232:235], a[4:7]
    s_waitcnt lgkmcnt(8)
    ds_read_b64_tr_b16 a[124:125], v63 offset:8192
    ds_read_b64_tr_b16 a[126:127], v63 offset:9216
    v_mfma_f32_16x16x32_bf16 a[12:15], a[100:103], v[236:239], a[12:15]
    v_and_b32 v33, s62, v33
    v_add_f32 v33, 0x3727c5ac, v33
    v_subrev_u32 v56, 131072, v56
    v_mfma_f32_16x16x32_bf16 a[16:19], a[104:107], v[232:235], a[16:19]
    s_waitcnt lgkmcnt(8)
    ds_read_b64_tr_b16 a[96:97], v56 offset:0
    ds_read_b64_tr_b16 a[98:99], v56 offset:1024
    v_mfma_f32_16x16x32_bf16 a[24:27], a[104:107], v[236:239], a[24:27]
    v_cvt_pk_bf16_f32 v33, v33, v33
    v_and_b32 v33, s62, v33
    v_subrev_u32 v57, 131072, v57
    v_mfma_f32_16x16x32_bf16 a[20:23], a[108:111], v[232:235], a[20:23]
    s_waitcnt lgkmcnt(8)
    ds_read_b64_tr_b16 a[100:101], v57 offset:0
    ds_read_b64_tr_b16 a[102:103], v57 offset:1024
    v_mfma_f32_16x16x32_bf16 a[28:31], a[108:111], v[236:239], a[28:31]
    v_sqrt_f32 v33, v33
    v_subrev_u32 v58, 131072, v58
    v_mfma_f32_16x16x32_bf16 a[32:35], a[112:115], v[232:235], a[32:35]
    s_waitcnt lgkmcnt(8)
    ds_read_b64_tr_b16 a[104:105], v58 offset:0
    ds_read_b64_tr_b16 a[106:107], v58 offset:1024
    v_mfma_f32_16x16x32_bf16 a[40:43], a[112:115], v[236:239], a[40:43]
    v_cvt_pk_bf16_f32 v33, v33, v33
    v_and_b32 v33, s62, v33
    v_subrev_u32 v59, 131072, v59
    v_mfma_f32_16x16x32_bf16 a[36:39], a[116:119], v[232:235], a[36:39]
    s_waitcnt lgkmcnt(8)
    ds_read_b64_tr_b16 a[108:109], v59 offset:0
    ds_read_b64_tr_b16 a[110:111], v59 offset:1024
    v_mfma_f32_16x16x32_bf16 a[44:47], a[116:119], v[236:239], a[44:47]
    v_rcp_f32 v32, v33
    v_subrev_u32 v60, 131072, v60
    v_mfma_f32_16x16x32_bf16 a[48:51], a[120:123], v[232:235], a[48:51]
    s_waitcnt lgkmcnt(8)
    ds_read_b64_tr_b16 a[112:113], v60 offset:0
    ds_read_b64_tr_b16 a[114:115], v60 offset:1024
    v_mfma_f32_16x16x32_bf16 a[56:59], a[120:123], v[236:239], a[56:59]
    s_mov_b32 s95, 636928
    v_mul_f32 v12, v33, v33
    v_mov_b32 v13, v12
    v_subrev_u32 v61, 131072, v61
    v_mfma_f32_16x16x32_bf16 a[52:55], a[124:127], v[232:235], a[52:55]
    s_waitcnt lgkmcnt(8)
    ds_read_b64_tr_b16 a[116:117], v61 offset:0
    ds_read_b64_tr_b16 a[118:119], v61 offset:1024
    v_mfma_f32_16x16x32_bf16 a[60:63], a[124:127], v[236:239], a[60:63]
    buffer_load_dwordx4 v2, s[32:35], s95 offen offset:2048 lds
    v_subrev_u32 v62, 131072, v62
    v_mfma_f32_16x16x32_bf16 a[0:3], a[96:99], v[240:243], a[0:3]
    s_waitcnt lgkmcnt(8)
    ds_read_b64_tr_b16 a[120:121], v62 offset:0
    ds_read_b64_tr_b16 a[122:123], v62 offset:1024
    v_mfma_f32_16x16x32_bf16 a[8:11], a[96:99], v[244:247], a[8:11]
    v_mov_b32 v40, v32
    v_accvgpr_write_b32 a65, v185
    v_subrev_u32 v63, 131072, v63
    v_mfma_f32_16x16x32_bf16 a[4:7], a[100:103], v[240:243], a[4:7]
    s_waitcnt lgkmcnt(8)
    ds_read_b64_tr_b16 a[124:125], v63 offset:0
    ds_read_b64_tr_b16 a[126:127], v63 offset:1024
    v_mfma_f32_16x16x32_bf16 a[12:15], a[100:103], v[244:247], a[12:15]
    s_mov_b32 s61, 648192
    v_permlane16_swap_b32 v12, v13
    v_permlane16_swap_b32 v32, v40
    v_mfma_f32_16x16x32_bf16 a[16:19], a[104:107], v[240:243], a[16:19]
    s_waitcnt lgkmcnt(8)
    ds_read_b64_tr_b16 a[96:97], v56 offset:8192
    ds_read_b64_tr_b16 a[98:99], v56 offset:9216
    v_mfma_f32_16x16x32_bf16 a[24:27], a[104:107], v[244:247], a[24:27]
    buffer_load_dwordx4 v2, s[32:35], s61 offen offset:3072 lds
    v_mfma_f32_16x16x32_bf16 a[20:23], a[108:111], v[240:243], a[20:23]
    s_waitcnt lgkmcnt(8)
    ds_read_b64_tr_b16 a[100:101], v57 offset:8192
    ds_read_b64_tr_b16 a[102:103], v57 offset:9216
    v_mfma_f32_16x16x32_bf16 a[28:31], a[108:111], v[244:247], a[28:31]
    s_add_u32 m0, s60, 147456
    v_mul_f32 v28, s72, v32
    v_mul_f32 v29, s72, v40
    v_mfma_f32_16x16x32_bf16 a[32:35], a[112:115], v[240:243], a[32:35]
    s_waitcnt lgkmcnt(8)
    ds_read_b64_tr_b16 a[104:105], v58 offset:8192
    ds_read_b64_tr_b16 a[106:107], v58 offset:9216
    v_mfma_f32_16x16x32_bf16 a[40:43], a[112:115], v[244:247], a[40:43]
    s_mov_b32 s95, 786432
    buffer_load_dwordx4 v2, s[32:35], s95 offen offset:0 lds
    v_mfma_f32_16x16x32_bf16 a[36:39], a[116:119], v[240:243], a[36:39]
    s_waitcnt lgkmcnt(8)
    ds_read_b64_tr_b16 a[108:109], v59 offset:8192
    ds_read_b64_tr_b16 a[110:111], v59 offset:9216
    v_mfma_f32_16x16x32_bf16 a[44:47], a[116:119], v[244:247], a[44:47]
    s_mov_b32 s61, 797696
    v_mul_f32 v0, s63, v40
    v_mul_f32 v9, s63, v32
    v_mfma_f32_16x16x32_bf16 a[48:51], a[120:123], v[240:243], a[48:51]
    s_waitcnt lgkmcnt(8)
    ds_read_b64_tr_b16 a[112:113], v60 offset:8192
    ds_read_b64_tr_b16 a[114:115], v60 offset:9216
    v_mfma_f32_16x16x32_bf16 a[56:59], a[120:123], v[244:247], a[56:59]
    buffer_load_dwordx4 v2, s[32:35], s61 offen offset:1024 lds
    v_accvgpr_write_b32 a66, v186
    v_mfma_f32_16x16x32_bf16 a[52:55], a[124:127], v[240:243], a[52:55]
    s_waitcnt lgkmcnt(8)
    ds_read_b64_tr_b16 a[116:117], v61 offset:8192
    ds_read_b64_tr_b16 a[118:119], v61 offset:9216
    v_mfma_f32_16x16x32_bf16 a[60:63], a[124:127], v[244:247], a[60:63]
    s_mov_b32 s95, 833536
    buffer_load_dwordx4 v2, s[32:35], s95 offen offset:2048 lds
    v_mfma_f32_16x16x32_bf16 a[0:3], a[96:99], v[248:251], a[0:3]
    s_waitcnt lgkmcnt(8)
    ds_read_b64_tr_b16 a[120:121], v62 offset:8192
    ds_read_b64_tr_b16 a[122:123], v62 offset:9216
    v_mfma_f32_16x16x32_bf16 a[8:11], a[96:99], v[252:255], a[8:11]
    s_mov_b32 s61, 844800
    v_accvgpr_write_b32 a67, v187
    v_accvgpr_write_b32 a68, v188
    v_accvgpr_write_b32 a69, v189
    v_mfma_f32_16x16x32_bf16 a[4:7], a[100:103], v[248:251], a[4:7]
    s_waitcnt lgkmcnt(8)
    ds_read_b64_tr_b16 a[124:125], v63 offset:8192
    ds_read_b64_tr_b16 a[126:127], v63 offset:9216
    v_mfma_f32_16x16x32_bf16 a[12:15], a[100:103], v[252:255], a[12:15]
    buffer_load_dwordx4 v2, s[32:35], s61 offen offset:3072 lds
    v_accvgpr_write_b32 a70, v190
    v_mfma_f32_16x16x32_bf16 a[16:19], a[104:107], v[248:251], a[16:19]
    s_waitcnt lgkmcnt(8)
    s_waitcnt vmcnt(6)
    s_barrier
    ds_read_b64_tr_b16 a[96:97], v3 offset:16384
    ds_read_b64_tr_b16 a[98:99], v3 offset:17408
    v_mfma_f32_16x16x32_bf16 a[24:27], a[104:107], v[252:255], a[24:27]
    v_accvgpr_write_b32 a71, v191
    v_mfma_f32_16x16x32_bf16 a[20:23], a[108:111], v[248:251], a[20:23]
    s_waitcnt lgkmcnt(8)
    ds_read_b64_tr_b16 a[100:101], v4 offset:16384
    ds_read_b64_tr_b16 a[102:103], v4 offset:17408
    v_mfma_f32_16x16x32_bf16 a[28:31], a[108:111], v[252:255], a[28:31]
    s_mov_b64 exec, 1
    buffer_store_dword v30, off, s[44:47], s81 sc1
    s_mov_b64 exec, -1
    v_mfma_f32_16x16x32_bf16 a[32:35], a[112:115], v[248:251], a[32:35]
    s_waitcnt lgkmcnt(8)
    ds_read_b64_tr_b16 a[104:105], v3 offset:24576
    ds_read_b64_tr_b16 a[106:107], v3 offset:25600
    v_mfma_f32_16x16x32_bf16 a[40:43], a[112:115], v[252:255], a[40:43]
    s_add_u32 m0, s60, 81920
    s_mov_b32 s95, 983040
    buffer_load_dwordx4 v2, s[32:35], s95 offen offset:0 lds
    v_mfma_f32_16x16x32_bf16 a[36:39], a[116:119], v[248:251], a[36:39]
    s_waitcnt lgkmcnt(8)
    ds_read_b64_tr_b16 a[108:109], v4 offset:24576
    ds_read_b64_tr_b16 a[110:111], v4 offset:25600
    v_mfma_f32_16x16x32_bf16 a[44:47], a[116:119], v[252:255], a[44:47]
    s_mov_b32 s61, 994304
    buffer_load_dwordx4 v2, s[32:35], s61 offen offset:1024 lds
    v_mfma_f32_16x16x32_bf16 a[48:51], a[120:123], v[248:251], a[48:51]
    s_waitcnt lgkmcnt(8)
    ds_read_b64_tr_b16 a[112:113], v5 offset:16384
    ds_read_b64_tr_b16 a[114:115], v5 offset:17408
    v_mfma_f32_16x16x32_bf16 a[56:59], a[120:123], v[252:255], a[56:59]
    s_mov_b32 s95, 1030144
    v_accvgpr_write_b32 a72, v192
    v_accvgpr_write_b32 a73, v193
    v_accvgpr_write_b32 a74, v194
    v_mfma_f32_16x16x32_bf16 a[52:55], a[124:127], v[248:251], a[52:55]
    s_waitcnt lgkmcnt(8)
    ds_read_b64_tr_b16 a[116:117], v6 offset:16384
    ds_read_b64_tr_b16 a[118:119], v6 offset:17408
    v_mfma_f32_16x16x32_bf16 a[60:63], a[124:127], v[252:255], a[60:63]
    buffer_load_dwordx4 v2, s[32:35], s95 offen offset:2048 lds
    v_accvgpr_write_b32 a75, v195
    v_mfma_f32_16x16x32_bf16 v[32:35], a[96:99], v[96:99], 0
    s_waitcnt lgkmcnt(8)
    ds_read_b64_tr_b16 a[120:121], v5 offset:24576
    ds_read_b64_tr_b16 a[122:123], v5 offset:25600
    v_mfma_f32_16x16x32_bf16 v[48:51], a[96:99], v[100:103], 0
    s_mov_b32 s61, 1041408
    v_accvgpr_write_b32 a76, v196
    v_accvgpr_write_b32 a77, v197
    v_accvgpr_write_b32 a78, v198
    v_mfma_f32_16x16x32_bf16 v[36:39], a[100:103], v[96:99], 0
    s_waitcnt lgkmcnt(8)
    ds_read_b64_tr_b16 a[124:125], v6 offset:24576
    ds_read_b64_tr_b16 a[126:127], v6 offset:25600
    v_mfma_f32_16x16x32_bf16 v[52:55], a[100:103], v[100:103], 0
    buffer_load_dwordx4 v2, s[32:35], s61 offen offset:3072 lds
    v_accvgpr_read_b32 v26, a0
    v_mfma_f32_16x16x32_bf16 v[40:43], a[104:107], v[96:99], 0
    s_waitcnt lgkmcnt(8)
    ds_read_b64_tr_b16 a[96:97], v3 offset:20480
    ds_read_b64_tr_b16 a[98:99], v3 offset:21504
    v_mfma_f32_16x16x32_bf16 v[56:59], a[104:107], v[100:103], 0
    s_add_u32 m0, s60, 98304
    v_accvgpr_read_b32 v27, a1
    v_mul_f32 v26, v9, v26
    v_mul_f32 v27, v9, v27
    v_mfma_f32_16x16x32_bf16 v[44:47], a[108:111], v[96:99], 0
    s_waitcnt lgkmcnt(8)
    ds_read_b64_tr_b16 a[100:101], v4 offset:20480
    ds_read_b64_tr_b16 a[102:103], v4 offset:21504
    v_mfma_f32_16x16x32_bf16 v[60:63], a[108:111], v[100:103], 0
    s_mov_b32 s95, 1179648
    buffer_load_dwordx4 v2, s[32:35], s95 offen offset:0 lds
    v_mfma_f32_16x16x32_bf16 v[64:67], a[112:115], v[96:99], 0
    s_waitcnt lgkmcnt(8)
    ds_read_b64_tr_b16 a[104:105], v3 offset:28672
    ds_read_b64_tr_b16 a[106:107], v3 offset:29696
    v_mfma_f32_16x16x32_bf16 v[80:83], a[112:115], v[100:103], 0
    s_mov_b32 s61, 1190912
    v_cvt_pk_bf16_f32 v14, v26, v27
    v_accvgpr_read_b32 v26, a2
    v_accvgpr_read_b32 v27, a3
    v_mfma_f32_16x16x32_bf16 v[68:71], a[116:119], v[96:99], 0
    s_waitcnt lgkmcnt(8)
    ds_read_b64_tr_b16 a[108:109], v4 offset:28672
    ds_read_b64_tr_b16 a[110:111], v4 offset:29696
    v_mfma_f32_16x16x32_bf16 v[84:87], a[116:119], v[100:103], 0
    buffer_load_dwordx4 v2, s[32:35], s61 offen offset:1024 lds
    v_mul_f32 v26, v9, v26
    v_mfma_f32_16x16x32_bf16 v[72:75], a[120:123], v[96:99], 0
    s_waitcnt lgkmcnt(8)
    ds_read_b64_tr_b16 a[112:113], v5 offset:20480
    ds_read_b64_tr_b16 a[114:115], v5 offset:21504
    v_mfma_f32_16x16x32_bf16 v[88:91], a[120:123], v[100:103], 0
    v_mul_f32 v27, v9, v27
    v_cvt_pk_bf16_f32 v15, v26, v27
    v_accvgpr_read_b32 v26, a4
    v_mfma_f32_16x16x32_bf16 v[76:79], a[124:127], v[96:99], 0
    s_waitcnt lgkmcnt(8)
    ds_read_b64_tr_b16 a[116:117], v6 offset:20480
    ds_read_b64_tr_b16 a[118:119], v6 offset:21504
    v_mfma_f32_16x16x32_bf16 v[92:95], a[124:127], v[100:103], 0
    s_mov_b32 s95, 1226752
    v_accvgpr_read_b32 v27, a5
    v_mul_f32 v26, v9, v26
L_page2:
    s_cbranch_execz L_tret0
    v_mul_f32 v27, v9, v27
    v_mfma_f32_16x16x32_bf16 v[32:35], a[96:99], v[104:107], v[32:35]
    s_waitcnt lgkmcnt(8)
    ds_read_b64_tr_b16 a[120:121], v5 offset:28672
    ds_read_b64_tr_b16 a[122:123], v5 offset:29696
    v_mfma_f32_16x16x32_bf16 v[48:51], a[96:99], v[108:111], v[48:51]
    buffer_load_dwordx4 v2, s[32:35], s95 offen offset:2048 lds
    v_cvt_pk_bf16_f32 v16, v26, v27
    v_mfma_f32_16x16x32_bf16 v[36:39], a[100:103], v[104:107], v[36:39]
    s_waitcnt lgkmcnt(8)
    ds_read_b64_tr_b16 a[124:125], v6 offset:28672
    ds_read_b64_tr_b16 a[126:127], v6 offset:29696
    v_mfma_f32_16x16x32_bf16 v[52:55], a[100:103], v[108:111], v[52:55]
    s_mov_b32 s61, 1238016
    v_accvgpr_read_b32 v26, a6
    v_accvgpr_read_b32 v27, a7
    v_mul_f32 v26, v9, v26
    v_mfma_f32_16x16x32_bf16 v[40:43], a[104:107], v[104:107], v[40:43]
    s_waitcnt lgkmcnt(8)
    ds_read_b64_tr_b16 a[96:97], v3 offset:32768
    ds_read_b64_tr_b16 a[98:99], v3 offset:33792
    v_mfma_f32_16x16x32_bf16 v[56:59], a[104:107], v[108:111], v[56:59]
    buffer_load_dwordx4 v2, s[32:35], s61 offen offset:3072 lds
    v_mul_f32 v27, v9, v27
    v_mfma_f32_16x16x32_bf16 v[44:47], a[108:111], v[104:107], v[44:47]
    s_waitcnt lgkmcnt(8)
    ds_read_b64_tr_b16 a[100:101], v4 offset:32768
    ds_read_b64_tr_b16 a[102:103], v4 offset:33792
    v_mfma_f32_16x16x32_bf16 v[60:63], a[108:111], v[108:111], v[60:63]
    v_cvt_pk_bf16_f32 v17, v26, v27
    v_permlane16_swap_b32 v14, v16
    s_nop 0
    v_permlane16_swap_b32 v15, v17
    v_mfma_f32_16x16x32_bf16 v[64:67], a[112:115], v[104:107], v[64:67]
    s_waitcnt lgkmcnt(8)
    ds_read_b64_tr_b16 a[104:105], v3 offset:40960
    ds_read_b64_tr_b16 a[106:107], v3 offset:41984
    v_mfma_f32_16x16x32_bf16 v[80:83], a[112:115], v[108:111], v[80:83]
    buffer_store_dwordx4 v[14:17], v7, s[44:47], s64 offen offset:0 sc1
    v_accvgpr_read_b32 v26, a8
    v_mfma_f32_16x16x32_bf16 v[68:71], a[116:119], v[104:107], v[68:71]
    s_waitcnt lgkmcnt(8)
    ds_read_b64_tr_b16 a[108:109], v4 offset:40960
    ds_read_b64_tr_b16 a[110:111], v4 offset:41984
    v_mfma_f32_16x16x32_bf16 v[84:87], a[116:119], v[108:111], v[84:87]
    v_accvgpr_read_b32 v27, a9
    v_mul_f32 v26, v0, v26
    v_mul_f32 v27, v0, v27
    v_mfma_f32_16x16x32_bf16 v[72:75], a[120:123], v[104:107], v[72:75]
    s_waitcnt lgkmcnt(8)
    ds_read_b64_tr_b16 a[112:113], v5 offset:32768
    ds_read_b64_tr_b16 a[114:115], v5 offset:33792
    v_mfma_f32_16x16x32_bf16 v[88:91], a[120:123], v[108:111], v[88:91]
    v_cvt_pk_bf16_f32 v22, v26, v27
    v_accvgpr_read_b32 v26, a10
    v_accvgpr_read_b32 v27, a11
    v_mfma_f32_16x16x32_bf16 v[76:79], a[124:127], v[104:107], v[76:79]
    s_waitcnt lgkmcnt(8)
    ds_read_b64_tr_b16 a[116:117], v6 offset:32768
    ds_read_b64_tr_b16 a[118:119], v6 offset:33792
    v_mfma_f32_16x16x32_bf16 v[92:95], a[124:127], v[108:111], v[92:95]
    v_mul_f32 v26, v0, v26
    v_mul_f32 v27, v0, v27
    v_cvt_pk_bf16_f32 v23, v26, v27
    v_mfma_f32_16x16x32_bf16 v[32:35], a[96:99], v[112:115], v[32:35]
    s_waitcnt lgkmcnt(8)
    ds_read_b64_tr_b16 a[120:121], v5 offset:40960
    ds_read_b64_tr_b16 a[122:123], v5 offset:41984
    v_mfma_f32_16x16x32_bf16 v[48:51], a[96:99], v[116:119], v[48:51]
    s_mov_b32 s95, 1376256
    v_accvgpr_read_b32 v26, a12
    v_accvgpr_read_b32 v27, a13
    v_mul_f32 v26, v0, v26
    v_mfma_f32_16x16x32_bf16 v[36:39], a[100:103], v[112:115], v[36:39]
    s_waitcnt lgkmcnt(8)
    ds_read_b64_tr_b16 a[124:125], v6 offset:40960
    ds_read_b64_tr_b16 a[126:127], v6 offset:41984
    v_mfma_f32_16x16x32_bf16 v[52:55], a[100:103], v[116:119], v[52:55]
    s_add_u32 m0, s60, 114688
    v_mul_f32 v27, v0, v27
    v_cvt_pk_bf16_f32 v24, v26, v27
    v_accvgpr_read_b32 v26, a14
    v_mfma_f32_16x16x32_bf16 v[40:43], a[104:107], v[112:115], v[40:43]
    s_waitcnt lgkmcnt(8)
    ds_read_b64_tr_b16 a[96:97], v3 offset:36864
    ds_read_b64_tr_b16 a[98:99], v3 offset:37888
    v_mfma_f32_16x16x32_bf16 v[56:59], a[104:107], v[116:119], v[56:59]
    buffer_load_dwordx4 v2, s[32:35], s95 offen offset:0 lds
    v_accvgpr_read_b32 v27, a15
    v_mfma_f32_16x16x32_bf16 v[44:47], a[108:111], v[112:115], v[44:47]
    s_waitcnt lgkmcnt(8)
    ds_read_b64_tr_b16 a[100:101], v4 offset:36864
    ds_read_b64_tr_b16 a[102:103], v4 offset:37888
    v_mfma_f32_16x16x32_bf16 v[60:63], a[108:111], v[116:119], v[60:63]
    s_mov_b32 s61, 1387520
    v_mul_f32 v26, v0, v26
    v_mul_f32 v27, v0, v27
    v_cvt_pk_bf16_f32 v25, v26, v27
    v_mfma_f32_16x16x32_bf16 v[64:67], a[112:115], v[112:115], v[64:67]
    s_waitcnt lgkmcnt(8)
    ds_read_b64_tr_b16 a[104:105], v3 offset:45056
    ds_read_b64_tr_b16 a[106:107], v3 offset:46080
    v_mfma_f32_16x16x32_bf16 v[80:83], a[112:115], v[116:119], v[80:83]
    buffer_load_dwordx4 v2, s[32:35], s61 offen offset:1024 lds
    v_permlane16_swap_b32 v22, v24
    v_mfma_f32_16x16x32_bf16 v[68:71], a[116:119], v[112:115], v[68:71]
    s_waitcnt lgkmcnt(8)
    ds_read_b64_tr_b16 a[108:109], v4 offset:45056
    ds_read_b64_tr_b16 a[110:111], v4 offset:46080
    v_mfma_f32_16x16x32_bf16 v[84:87], a[116:119], v[116:119], v[84:87]
    v_permlane16_swap_b32 v23, v25
    v_accvgpr_write_b32 a79, v199
    v_accvgpr_write_b32 a80, v200
    v_mfma_f32_16x16x32_bf16 v[72:75], a[120:123], v[112:115], v[72:75]
    s_waitcnt lgkmcnt(8)
    ds_read_b64_tr_b16 a[112:113], v5 offset:36864
    ds_read_b64_tr_b16 a[114:115], v5 offset:37888
    v_mfma_f32_16x16x32_bf16 v[88:91], a[120:123], v[116:119], v[88:91]
    buffer_store_dwordx4 v[22:25], v7, s[44:47], s64 offen offset:256 sc1
    s_add_u32 s64, s64, 8192
    v_mfma_f32_16x16x32_bf16 v[76:79], a[124:127], v[112:115], v[76:79]
    s_waitcnt lgkmcnt(8)
    ds_read_b64_tr_b16 a[116:117], v6 offset:36864
    ds_read_b64_tr_b16 a[118:119], v6 offset:37888
    v_mfma_f32_16x16x32_bf16 v[92:95], a[124:127], v[116:119], v[92:95]
    v_accvgpr_read_b32 v26, a16
    v_accvgpr_read_b32 v27, a17
    v_mul_f32 v26, v9, v26
    v_mfma_f32_16x16x32_bf16 v[32:35], a[96:99], v[120:123], v[32:35]
    s_waitcnt lgkmcnt(8)
    ds_read_b64_tr_b16 a[120:121], v5 offset:45056
    ds_read_b64_tr_b16 a[122:123], v5 offset:46080
    v_mfma_f32_16x16x32_bf16 v[48:51], a[96:99], v[124:127], v[48:51]
    v_mul_f32 v27, v9, v27
    v_cvt_pk_bf16_f32 v14, v26, v27
    v_accvgpr_read_b32 v26, a18
    v_mfma_f32_16x16x32_bf16 v[36:39], a[100:103], v[120:123], v[36:39]
    s_waitcnt lgkmcnt(8)
    ds_read_b64_tr_b16 a[124:125], v6 offset:45056
    ds_read_b64_tr_b16 a[126:127], v6 offset:46080
    v_mfma_f32_16x16x32_bf16 v[52:55], a[100:103], v[124:127], v[52:55]
    v_accvgpr_read_b32 v27, a19
    v_mul_f32 v26, v9, v26
    v_mul_f32 v27, v9, v27
    v_mfma_f32_16x16x32_bf16 v[40:43], a[104:107], v[120:123], v[40:43]
    s_waitcnt lgkmcnt(8)
    ds_read_b64_tr_b16 a[96:97], v3 offset:49152
    ds_read_b64_tr_b16 a[98:99], v3 offset:50176
    v_mfma_f32_16x16x32_bf16 v[56:59], a[104:107], v[124:127], v[56:59]
    v_cvt_pk_bf16_f32 v15, v26, v27
    v_accvgpr_read_b32 v26, a20
    v_accvgpr_read_b32 v27, a21
    v_mfma_f32_16x16x32_bf16 v[44:47], a[108:111], v[120:123], v[44:47]
    s_waitcnt lgkmcnt(8)
    ds_read_b64_tr_b16 a[100:101], v4 offset:49152
    ds_read_b64_tr_b16 a[102:103], v4 offset:50176
    v_mfma_f32_16x16x32_bf16 v[60:63], a[108:111], v[124:127], v[60:63]
    s_mov_b32 s95, 1423360
    v_mul_f32 v26, v9, v26
    v_mul_f32 v27, v9, v27
    v_cvt_pk_bf16_f32 v16, v26, v27
    v_mfma_f32_16x16x32_bf16 v[64:67], a[112:115], v[120:123], v[64:67]
    s_waitcnt lgkmcnt(8)
    ds_read_b64_tr_b16 a[104:105], v3 offset:57344
    ds_read_b64_tr_b16 a[106:107], v3 offset:58368
    v_mfma_f32_16x16x32_bf16 v[80:83], a[112:115], v[124:127], v[80:83]
    buffer_load_dwordx4 v2, s[32:35], s95 offen offset:2048 lds
    v_accvgpr_read_b32 v26, a22
    v_mfma_f32_16x16x32_bf16 v[68:71], a[116:119], v[120:123], v[68:71]
    s_waitcnt lgkmcnt(8)
    ds_read_b64_tr_b16 a[108:109], v4 offset:57344
    ds_read_b64_tr_b16 a[110:111], v4 offset:58368
    v_mfma_f32_16x16x32_bf16 v[84:87], a[116:119], v[124:127], v[84:87]
    s_mov_b32 s61, 1434624
    v_accvgpr_read_b32 v27, a23
    v_mul_f32 v26, v9, v26
    v_mul_f32 v27, v9, v27
    v_mfma_f32_16x16x32_bf16 v[72:75], a[120:123], v[120:123], v[72:75]
    s_waitcnt lgkmcnt(8)
    ds_read_b64_tr_b16 a[112:113], v5 offset:49152
    ds_read_b64_tr_b16 a[114:115], v5 offset:50176
    v_mfma_f32_16x16x32_bf16 v[88:91], a[120:123], v[124:127], v[88:91]
    buffer_load_dwordx4 v2, s[32:35], s61 offen offset:3072 lds
    v_cvt_pk_bf16_f32 v17, v26, v27
    v_mfma_f32_16x16x32_bf16 v[76:79], a[124:127], v[120:123], v[76:79]
    s_waitcnt lgkmcnt(8)
    ds_read_b64_tr_b16 a[116:117], v6 offset:49152
    ds_read_b64_tr_b16 a[118:119], v6 offset:50176
    v_mfma_f32_16x16x32_bf16 v[92:95], a[124:127], v[124:127], v[92:95]
    v_permlane16_swap_b32 v14, v16
    v_permlane16_swap_b32 v15, v17
    v_accvgpr_write_b32 a81, v201
    v_mfma_f32_16x16x32_bf16 v[32:35], a[96:99], v[128:131], v[32:35]
    s_waitcnt lgkmcnt(8)
    ds_read_b64_tr_b16 a[120:121], v5 offset:57344
    ds_read_b64_tr_b16 a[122:123], v5 offset:58368
    v_mfma_f32_16x16x32_bf16 v[48:51], a[96:99], v[132:135], v[48:51]
    buffer_store_dwordx4 v[14:17], v7, s[44:47], s64 offen offset:0 sc1
    v_accvgpr_read_b32 v26, a24
    v_mfma_f32_16x16x32_bf16 v[36:39], a[100:103], v[128:131], v[36:39]
    s_waitcnt lgkmcnt(8)
    ds_read_b64_tr_b16 a[124:125], v6 offset:57344
    ds_read_b64_tr_b16 a[126:127], v6 offset:58368
    v_mfma_f32_16x16x32_bf16 v[52:55], a[100:103], v[132:135], v[52:55]
    v_accvgpr_read_b32 v27, a25
    v_mul_f32 v26, v0, v26
    v_mul_f32 v27, v0, v27
    v_mfma_f32_16x16x32_bf16 v[40:43], a[104:107], v[128:131], v[40:43]
    s_waitcnt lgkmcnt(8)
    ds_read_b64_tr_b16 a[96:97], v3 offset:53248
    ds_read_b64_tr_b16 a[98:99], v3 offset:54272
    v_mfma_f32_16x16x32_bf16 v[56:59], a[104:107], v[132:135], v[56:59]
    v_cvt_pk_bf16_f32 v22, v26, v27
    v_accvgpr_read_b32 v26, a26
    v_accvgpr_read_b32 v27, a27
    v_mfma_f32_16x16x32_bf16 v[44:47], a[108:111], v[128:131], v[44:47]
    s_waitcnt lgkmcnt(8)
    ds_read_b64_tr_b16 a[100:101], v4 offset:53248
    ds_read_b64_tr_b16 a[102:103], v4 offset:54272
    v_mfma_f32_16x16x32_bf16 v[60:63], a[108:111], v[132:135], v[60:63]
    v_mul_f32 v26, v0, v26
    v_mul_f32 v27, v0, v27
    v_cvt_pk_bf16_f32 v23, v26, v27
    v_mfma_f32_16x16x32_bf16 v[64:67], a[112:115], v[128:131], v[64:67]
    s_waitcnt lgkmcnt(8)
    ds_read_b64_tr_b16 a[104:105], v3 offset:61440
    ds_read_b64_tr_b16 a[106:107], v3 offset:62464
    v_mfma_f32_16x16x32_bf16 v[80:83], a[112:115], v[132:135], v[80:83]
    s_mov_b32 s95, 1572864
    v_accvgpr_read_b32 v26, a28
    v_accvgpr_read_b32 v27, a29
    v_mul_f32 v26, v0, v26
    v_mfma_f32_16x16x32_bf16 v[68:71], a[116:119], v[128:131], v[68:71]
    s_waitcnt lgkmcnt(8)
    ds_read_b64_tr_b16 a[108:109], v4 offset:61440
    ds_read_b64_tr_b16 a[110:111], v4 offset:62464
    v_mfma_f32_16x16x32_bf16 v[84:87], a[116:119], v[132:135], v[84:87]
    s_add_u32 m0, s60, 131072
    v_mul_f32 v27, v0, v27
    v_cvt_pk_bf16_f32 v24, v26, v27
    v_accvgpr_read_b32 v26, a30
    v_mfma_f32_16x16x32_bf16 v[72:75], a[120:123], v[128:131], v[72:75]
    s_waitcnt lgkmcnt(8)
    ds_read_b64_tr_b16 a[112:113], v5 offset:53248
    ds_read_b64_tr_b16 a[114:115], v5 offset:54272
    v_mfma_f32_16x16x32_bf16 v[88:91], a[120:123], v[132:135], v[88:91]
    buffer_load_dwordx4 v2, s[32:35], s95 offen offset:0 lds
    v_accvgpr_read_b32 v27, a31
    v_mfma_f32_16x16x32_bf16 v[76:79], a[124:127], v[128:131], v[76:79]
    s_waitcnt lgkmcnt(8)
    ds_read_b64_tr_b16 a[116:117], v6 offset:53248
    ds_read_b64_tr_b16 a[118:119], v6 offset:54272
    v_mfma_f32_16x16x32_bf16 v[92:95], a[124:127], v[132:135], v[92:95]
    s_mov_b32 s61, 1584128
    v_mul_f32 v26, v0, v26
    v_mul_f32 v27, v0, v27
    v_cvt_pk_bf16_f32 v25, v26, v27
    v_mfma_f32_16x16x32_bf16 v[32:35], a[96:99], v[136:139], v[32:35]
    s_waitcnt lgkmcnt(8)
    ds_read_b64_tr_b16 a[120:121], v5 offset:61440
    ds_read_b64_tr_b16 a[122:123], v5 offset:62464
    v_mfma_f32_16x16x32_bf16 v[48:51], a[96:99], v[140:143], v[48:51]
    buffer_load_dwordx4 v2, s[32:35], s61 offen offset:1024 lds
    v_permlane16_swap_b32 v22, v24
    v_add_u32 v4, 65536, v4
    v_mfma_f32_16x16x32_bf16 v[36:39], a[100:103], v[136:139], v[36:39]
    s_waitcnt lgkmcnt(8)
    ds_read_b64_tr_b16 a[124:125], v6 offset:61440
    ds_read_b64_tr_b16 a[126:127], v6 offset:62464
    v_mfma_f32_16x16x32_bf16 v[52:55], a[100:103], v[140:143], v[52:55]
    v_permlane16_swap_b32 v23, v25
    v_accvgpr_write_b32 a82, v202
    v_accvgpr_write_b32 a83, v203
    v_add_u32 v3, 65536, v3
    v_mfma_f32_16x16x32_bf16 v[40:43], a[104:107], v[136:139], v[40:43]
    s_waitcnt lgkmcnt(8)
    s_waitcnt vmcnt(13)
    s_barrier
    ds_read_b64_tr_b16 a[96:97], v3 offset:0
    ds_read_b64_tr_b16 a[98:99], v3 offset:1024
    v_mfma_f32_16x16x32_bf16 v[56:59], a[104:107], v[140:143], v[56:59]
    buffer_store_dwordx4 v[22:25], v7, s[44:47], s64 offen offset:256 sc1
    s_add_u32 s64, s64, 8192
    v_mfma_f32_16x16x32_bf16 v[44:47], a[108:111], v[136:139], v[44:47]
    s_waitcnt lgkmcnt(8)
    ds_read_b64_tr_b16 a[100:101], v4 offset:0
    ds_read_b64_tr_b16 a[102:103], v4 offset:1024
    v_mfma_f32_16x16x32_bf16 v[60:63], a[108:111], v[140:143], v[60:63]
    v_accvgpr_read_b32 v26, a32
    v_accvgpr_read_b32 v27, a33
    v_mul_f32 v26, v9, v26
    v_mfma_f32_16x16x32_bf16 v[64:67], a[112:115], v[136:139], v[64:67]
    s_waitcnt lgkmcnt(8)
    ds_read_b64_tr_b16 a[104:105], v3 offset:8192
    ds_read_b64_tr_b16 a[106:107], v3 offset:9216
    v_mfma_f32_16x16x32_bf16 v[80:83], a[112:115], v[140:143], v[80:83]
    v_mul_f32 v27, v9, v27
    v_cvt_pk_bf16_f32 v14, v26, v27
    v_accvgpr_read_b32 v26, a34
    v_mfma_f32_16x16x32_bf16 v[68:71], a[116:119], v[136:139], v[68:71]
    s_waitcnt lgkmcnt(8)
    ds_read_b64_tr_b16 a[108:109], v4 offset:8192
    ds_read_b64_tr_b16 a[110:111], v4 offset:9216
    v_mfma_f32_16x16x32_bf16 v[84:87], a[116:119], v[140:143], v[84:87]
    v_accvgpr_read_b32 v27, a35
    v_mul_f32 v26, v9, v26
    v_mul_f32 v27, v9, v27
    v_add_u32 v5, 65536, v5
    v_mfma_f32_16x16x32_bf16 v[72:75], a[120:123], v[136:139], v[72:75]
    s_waitcnt lgkmcnt(8)
    ds_read_b64_tr_b16 a[112:113], v5 offset:0
    ds_read_b64_tr_b16 a[114:115], v5 offset:1024
    v_mfma_f32_16x16x32_bf16 v[88:91], a[120:123], v[140:143], v[88:91]
    v_cvt_pk_bf16_f32 v15, v26, v27
    v_accvgpr_read_b32 v26, a36
    v_accvgpr_read_b32 v27, a37
    v_add_u32 v6, 65536, v6
    v_mfma_f32_16x16x32_bf16 v[76:79], a[124:127], v[136:139], v[76:79]
    s_waitcnt lgkmcnt(8)
    ds_read_b64_tr_b16 a[116:117], v6 offset:0
    ds_read_b64_tr_b16 a[118:119], v6 offset:1024
    v_mfma_f32_16x16x32_bf16 v[92:95], a[124:127], v[140:143], v[92:95]
    s_mov_b32 s95, 1619968
    v_mul_f32 v26, v9, v26
    v_mul_f32 v27, v9, v27
    v_cvt_pk_bf16_f32 v16, v26, v27
    v_mfma_f32_16x16x32_bf16 v[32:35], a[96:99], v[144:147], v[32:35]
    s_waitcnt lgkmcnt(8)
    ds_read_b64_tr_b16 a[120:121], v5 offset:8192
    ds_read_b64_tr_b16 a[122:123], v5 offset:9216
    v_mfma_f32_16x16x32_bf16 v[48:51], a[96:99], v[148:151], v[48:51]
    buffer_load_dwordx4 v2, s[32:35], s95 offen offset:2048 lds
    v_accvgpr_read_b32 v26, a38
    v_mfma_f32_16x16x32_bf16 v[36:39], a[100:103], v[144:147], v[36:39]
    s_waitcnt lgkmcnt(8)
    ds_read_b64_tr_b16 a[124:125], v6 offset:8192
    ds_read_b64_tr_b16 a[126:127], v6 offset:9216
    v_mfma_f32_16x16x32_bf16 v[52:55], a[100:103], v[148:151], v[52:55]
    s_mov_b32 s61, 1631232
    v_accvgpr_read_b32 v27, a39
    v_mul_f32 v26, v9, v26
    v_mul_f32 v27, v9, v27
    v_mfma_f32_16x16x32_bf16 v[40:43], a[104:107], v[144:147], v[40:43]
    s_waitcnt lgkmcnt(8)
    ds_read_b64_tr_b16 a[96:97], v3 offset:4096
    ds_read_b64_tr_b16 a[98:99], v3 offset:5120
    v_mfma_f32_16x16x32_bf16 v[56:59], a[104:107], v[148:151], v[56:59]
    buffer_load_dwordx4 v2, s[32:35], s61 offen offset:3072 lds
    v_cvt_pk_bf16_f32 v17, v26, v27
    v_mfma_f32_16x16x32_bf16 v[44:47], a[108:111], v[144:147], v[44:47]
    s_waitcnt lgkmcnt(8)
    ds_read_b64_tr_b16 a[100:101], v4 offset:4096
    ds_read_b64_tr_b16 a[102:103], v4 offset:5120
    v_mfma_f32_16x16x32_bf16 v[60:63], a[108:111], v[148:151], v[60:63]
    v_permlane16_swap_b32 v14, v16
    v_permlane16_swap_b32 v15, v17
    v_accvgpr_write_b32 a84, v204
    v_mfma_f32_16x16x32_bf16 v[64:67], a[112:115], v[144:147], v[64:67]
    s_waitcnt lgkmcnt(8)
    ds_read_b64_tr_b16 a[104:105], v3 offset:12288
    ds_read_b64_tr_b16 a[106:107], v3 offset:13312
    v_mfma_f32_16x16x32_bf16 v[80:83], a[112:115], v[148:151], v[80:83]
    buffer_store_dwordx4 v[14:17], v7, s[44:47], s64 offen offset:0 sc1
    v_accvgpr_read_b32 v26, a40
    v_mfma_f32_16x16x32_bf16 v[68:71], a[116:119], v[144:147], v[68:71]
    s_waitcnt lgkmcnt(8)
    ds_read_b64_tr_b16 a[108:109], v4 offset:12288
    ds_read_b64_tr_b16 a[110:111], v4 offset:13312
    v_mfma_f32_16x16x32_bf16 v[84:87], a[116:119], v[148:151], v[84:87]
    v_accvgpr_read_b32 v27, a41
    v_mul_f32 v26, v0, v26
    v_mul_f32 v27, v0, v27
    v_mfma_f32_16x16x32_bf16 v[72:75], a[120:123], v[144:147], v[72:75]
    s_waitcnt lgkmcnt(8)
    ds_read_b64_tr_b16 a[112:113], v5 offset:4096
    ds_read_b64_tr_b16 a[114:115], v5 offset:5120
    v_mfma_f32_16x16x32_bf16 v[88:91], a[120:123], v[148:151], v[88:91]
    v_cvt_pk_bf16_f32 v22, v26, v27
    v_accvgpr_read_b32 v26, a42
    v_accvgpr_read_b32 v27, a43
    v_mfma_f32_16x16x32_bf16 v[76:79], a[124:127], v[144:147], v[76:79]
    s_waitcnt lgkmcnt(8)
    ds_read_b64_tr_b16 a[116:117], v6 offset:4096
    ds_read_b64_tr_b16 a[118:119], v6 offset:5120
    v_mfma_f32_16x16x32_bf16 v[92:95], a[124:127], v[148:151], v[92:95]
    v_mul_f32 v26, v0, v26
    v_mul_f32 v27, v0, v27
    v_cvt_pk_bf16_f32 v23, v26, v27
    v_mfma_f32_16x16x32_bf16 v[32:35], a[96:99], v[152:155], v[32:35]
    s_waitcnt lgkmcnt(8)
    ds_read_b64_tr_b16 a[120:121], v5 offset:12288
    ds_read_b64_tr_b16 a[122:123], v5 offset:13312
    v_mfma_f32_16x16x32_bf16 v[48:51], a[96:99], v[156:159], v[48:51]
    v_accvgpr_read_b32 v26, a44
    v_accvgpr_read_b32 v27, a45
    v_mul_f32 v26, v0, v26
    v_add_u32 v4, 81920, v4
    v_mfma_f32_16x16x32_bf16 v[36:39], a[100:103], v[152:155], v[36:39]
    s_waitcnt lgkmcnt(8)
    ds_read_b64_tr_b16 a[124:125], v6 offset:12288
    ds_read_b64_tr_b16 a[126:127], v6 offset:13312
    v_mfma_f32_16x16x32_bf16 v[52:55], a[100:103], v[156:159], v[52:55]
    buffer_load_dword v19, v21, s[44:47], 0 offen sc1
    v_mul_f32 v27, v0, v27
    v_add_u32 v3, 81920, v3
    v_mfma_f32_16x16x32_bf16 v[40:43], a[104:107], v[152:155], v[40:43]
    s_waitcnt lgkmcnt(8)
    ds_read_b64_tr_b16 a[96:97], v3 offset:0
    ds_read_b64_tr_b16 a[98:99], v3 offset:1024
    v_mfma_f32_16x16x32_bf16 v[56:59], a[104:107], v[156:159], v[56:59]
    s_add_u32 m0, s60, 0
    s_mov_b32 s95, 1769472
    buffer_load_dwordx4 v2, s[32:35], s95 offen offset:0 lds
    v_mfma_f32_16x16x32_bf16 v[44:47], a[108:111], v[152:155], v[44:47]
    s_waitcnt lgkmcnt(8)
    ds_read_b64_tr_b16 a[100:101], v4 offset:0
    ds_read_b64_tr_b16 a[102:103], v4 offset:1024
    v_mfma_f32_16x16x32_bf16 v[60:63], a[108:111], v[156:159], v[60:63]
    s_mov_b32 s61, 1780736
    v_cvt_pk_bf16_f32 v24, v26, v27
    v_accvgpr_read_b32 v26, a46
    v_accvgpr_read_b32 v27, a47
    v_mfma_f32_16x16x32_bf16 v[64:67], a[112:115], v[152:155], v[64:67]
    s_waitcnt lgkmcnt(8)
    ds_read_b64_tr_b16 a[104:105], v3 offset:8192
    ds_read_b64_tr_b16 a[106:107], v3 offset:9216
    v_mfma_f32_16x16x32_bf16 v[80:83], a[112:115], v[156:159], v[80:83]
    buffer_load_dwordx4 v2, s[32:35], s61 offen offset:1024 lds
    v_mul_f32 v26, v0, v26
    v_mfma_f32_16x16x32_bf16 v[68:71], a[116:119], v[152:155], v[68:71]
    s_waitcnt lgkmcnt(8)
    ds_read_b64_tr_b16 a[108:109], v4 offset:8192
    ds_read_b64_tr_b16 a[110:111], v4 offset:9216
    v_mfma_f32_16x16x32_bf16 v[84:87], a[116:119], v[156:159], v[84:87]
    v_mul_f32 v27, v0, v27
    v_cvt_pk_bf16_f32 v25, v26, v27
    v_permlane16_swap_b32 v22, v24
    v_add_u32 v5, 81920, v5
    v_mfma_f32_16x16x32_bf16 v[72:75], a[120:123], v[152:155], v[72:75]
    s_waitcnt lgkmcnt(8)
    ds_read_b64_tr_b16 a[112:113], v5 offset:0
    ds_read_b64_tr_b16 a[114:115], v5 offset:1024
    v_mfma_f32_16x16x32_bf16 v[88:91], a[120:123], v[156:159], v[88:91]
    v_permlane16_swap_b32 v23, v25
    v_accvgpr_write_b32 a85, v205
    v_accvgpr_write_b32 a86, v206
    v_add_u32 v6, 81920, v6
    v_mfma_f32_16x16x32_bf16 v[76:79], a[124:127], v[152:155], v[76:79]
    s_waitcnt lgkmcnt(8)
    ds_read_b64_tr_b16 a[116:117], v6 offset:0
    ds_read_b64_tr_b16 a[118:119], v6 offset:1024
    v_mfma_f32_16x16x32_bf16 v[92:95], a[124:127], v[156:159], v[92:95]
    buffer_store_dwordx4 v[22:25], v7, s[44:47], s64 offen offset:256 sc1
    s_add_u32 s64, s64, 8192
    v_mfma_f32_16x16x32_bf16 v[32:35], a[96:99], v[160:163], v[32:35]
    s_waitcnt lgkmcnt(8)
    ds_read_b64_tr_b16 a[120:121], v5 offset:8192
    ds_read_b64_tr_b16 a[122:123], v5 offset:9216
    v_mfma_f32_16x16x32_bf16 v[48:51], a[96:99], v[164:167], v[48:51]
    v_accvgpr_read_b32 v26, a48
    v_accvgpr_read_b32 v27, a49
    v_mul_f32 v26, v9, v26
    v_mfma_f32_16x16x32_bf16 v[36:39], a[100:103], v[160:163], v[36:39]
    s_waitcnt lgkmcnt(8)
    ds_read_b64_tr_b16 a[124:125], v6 offset:8192
    ds_read_b64_tr_b16 a[126:127], v6 offset:9216
    v_mfma_f32_16x16x32_bf16 v[52:55], a[100:103], v[164:167], v[52:55]
    v_mul_f32 v27, v9, v27
    v_cvt_pk_bf16_f32 v14, v26, v27
    v_accvgpr_read_b32 v26, a50
    v_mfma_f32_16x16x32_bf16 v[40:43], a[104:107], v[160:163], v[40:43]
    s_waitcnt lgkmcnt(8)
    ds_read_b64_tr_b16 a[96:97], v3 offset:4096
    ds_read_b64_tr_b16 a[98:99], v3 offset:5120
    v_mfma_f32_16x16x32_bf16 v[56:59], a[104:107], v[164:167], v[56:59]
    v_accvgpr_read_b32 v27, a51
    v_mul_f32 v26, v9, v26
    v_mul_f32 v27, v9, v27
    v_mfma_f32_16x16x32_bf16 v[44:47], a[108:111], v[160:163], v[44:47]
    s_waitcnt lgkmcnt(8)
    ds_read_b64_tr_b16 a[100:101], v4 offset:4096
    ds_read_b64_tr_b16 a[102:103], v4 offset:5120
    v_mfma_f32_16x16x32_bf16 v[60:63], a[108:111], v[164:167], v[60:63]
    s_mov_b32 s95, 1816576
    v_cvt_pk_bf16_f32 v15, v26, v27
    v_accvgpr_read_b32 v26, a52
    v_accvgpr_read_b32 v27, a53
    v_mfma_f32_16x16x32_bf16 v[64:67], a[112:115], v[160:163], v[64:67]
    s_waitcnt lgkmcnt(8)
    ds_read_b64_tr_b16 a[104:105], v3 offset:12288
    ds_read_b64_tr_b16 a[106:107], v3 offset:13312
    v_mfma_f32_16x16x32_bf16 v[80:83], a[112:115], v[164:167], v[80:83]
    buffer_load_dwordx4 v2, s[32:35], s95 offen offset:2048 lds
    v_mul_f32 v26, v9, v26
    v_mfma_f32_16x16x32_bf16 v[68:71], a[116:119], v[160:163], v[68:71]
    s_waitcnt lgkmcnt(8)
    ds_read_b64_tr_b16 a[108:109], v4 offset:12288
    ds_read_b64_tr_b16 a[110:111], v4 offset:13312
    v_mfma_f32_16x16x32_bf16 v[84:87], a[116:119], v[164:167], v[84:87]
    s_mov_b32 s61, 1827840
    v_mul_f32 v27, v9, v27
    v_cvt_pk_bf16_f32 v16, v26, v27
    v_accvgpr_read_b32 v26, a54
    v_mfma_f32_16x16x32_bf16 v[72:75], a[120:123], v[160:163], v[72:75]
    s_waitcnt lgkmcnt(8)
    ds_read_b64_tr_b16 a[112:113], v5 offset:4096
    ds_read_b64_tr_b16 a[114:115], v5 offset:5120
    v_mfma_f32_16x16x32_bf16 v[88:91], a[120:123], v[164:167], v[88:91]
    buffer_load_dwordx4 v2, s[32:35], s61 offen offset:3072 lds
    v_accvgpr_read_b32 v27, a55
    v_mfma_f32_16x16x32_bf16 v[76:79], a[124:127], v[160:163], v[76:79]
    s_waitcnt lgkmcnt(8)
    ds_read_b64_tr_b16 a[116:117], v6 offset:4096
    ds_read_b64_tr_b16 a[118:119], v6 offset:5120
    v_mfma_f32_16x16x32_bf16 v[92:95], a[124:127], v[164:167], v[92:95]
    v_mul_f32 v26, v9, v26
    v_mul_f32 v27, v9, v27
    v_cvt_pk_bf16_f32 v17, v26, v27
    v_mfma_f32_16x16x32_bf16 v[32:35], a[96:99], v[168:171], v[32:35]
    s_waitcnt lgkmcnt(8)
    ds_read_b64_tr_b16 a[120:121], v5 offset:12288
    ds_read_b64_tr_b16 a[122:123], v5 offset:13312
    v_mfma_f32_16x16x32_bf16 v[48:51], a[96:99], v[172:175], v[48:51]
    v_permlane16_swap_b32 v14, v16
    v_permlane16_swap_b32 v15, v17
    v_accvgpr_write_b32 a87, v207
    v_mfma_f32_16x16x32_bf16 v[36:39], a[100:103], v[168:171], v[36:39]
    s_waitcnt lgkmcnt(8)
    ds_read_b64_tr_b16 a[124:125], v6 offset:12288
    ds_read_b64_tr_b16 a[126:127], v6 offset:13312
    v_mfma_f32_16x16x32_bf16 v[52:55], a[100:103], v[172:175], v[52:55]
    buffer_store_dwordx4 v[14:17], v7, s[44:47], s64 offen offset:0 sc1
    v_accvgpr_read_b32 v26, a56
    v_subrev_u32 v3, 65536, v3
    v_mfma_f32_16x16x32_bf16 v[40:43], a[104:107], v[168:171], v[40:43]
    s_waitcnt lgkmcnt(8)
    ds_read_b64_tr_b16 a[96:97], v3 offset:0
    ds_read_b64_tr_b16 a[98:99], v3 offset:1024
    v_mfma_f32_16x16x32_bf16 v[56:59], a[104:107], v[172:175], v[56:59]
    v_accvgpr_read_b32 v27, a57
    v_mul_f32 v26, v0, v26
    v_mul_f32 v27, v0, v27
    v_subrev_u32 v4, 65536, v4
    v_mfma_f32_16x16x32_bf16 v[44:47], a[108:111], v[168:171], v[44:47]
    s_waitcnt lgkmcnt(8)
    ds_read_b64_tr_b16 a[100:101], v4 offset:0
    ds_read_b64_tr_b16 a[102:103], v4 offset:1024
    v_mfma_f32_16x16x32_bf16 v[60:63], a[108:111], v[172:175], v[60:63]
    v_cvt_pk_bf16_f32 v22, v26, v27
    v_accvgpr_read_b32 v26, a58
    v_accvgpr_read_b32 v27, a59
    v_mfma_f32_16x16x32_bf16 v[64:67], a[112:115], v[168:171], v[64:67]
    s_waitcnt lgkmcnt(8)
    ds_read_b64_tr_b16 a[104:105], v3 offset:8192
    ds_read_b64_tr_b16 a[106:107], v3 offset:9216
    v_mfma_f32_16x16x32_bf16 v[80:83], a[112:115], v[172:175], v[80:83]
    v_mul_f32 v26, v0, v26
    v_mul_f32 v27, v0, v27
    v_cvt_pk_bf16_f32 v23, v26, v27
    v_mfma_f32_16x16x32_bf16 v[68:71], a[116:119], v[168:171], v[68:71]
    s_waitcnt lgkmcnt(8)
    ds_read_b64_tr_b16 a[108:109], v4 offset:8192
    ds_read_b64_tr_b16 a[110:111], v4 offset:9216
    v_mfma_f32_16x16x32_bf16 v[84:87], a[116:119], v[172:175], v[84:87]
    v_accvgpr_read_b32 v26, a60
    v_accvgpr_read_b32 v27, a61
    v_mul_f32 v26, v0, v26
    v_subrev_u32 v5, 65536, v5
    v_mfma_f32_16x16x32_bf16 v[72:75], a[120:123], v[168:171], v[72:75]
    s_waitcnt lgkmcnt(8)
    ds_read_b64_tr_b16 a[112:113], v5 offset:0
    ds_read_b64_tr_b16 a[114:115], v5 offset:1024
    v_mfma_f32_16x16x32_bf16 v[88:91], a[120:123], v[172:175], v[88:91]
    v_mul_f32 v27, v0, v27
    v_cvt_pk_bf16_f32 v24, v26, v27
    v_accvgpr_read_b32 v26, a62
    v_subrev_u32 v6, 65536, v6
    v_mfma_f32_16x16x32_bf16 v[76:79], a[124:127], v[168:171], v[76:79]
    s_waitcnt lgkmcnt(8)
    ds_read_b64_tr_b16 a[116:117], v6 offset:0
    ds_read_b64_tr_b16 a[118:119], v6 offset:1024
    v_mfma_f32_16x16x32_bf16 v[92:95], a[124:127], v[172:175], v[92:95]
    v_accvgpr_read_b32 v27, a63
    v_mul_f32 v26, v0, v26
    v_mul_f32 v27, v0, v27
    v_mfma_f32_16x16x32_bf16 v[32:35], a[96:99], v[176:179], v[32:35]
L_page3:
    s_cbranch_execz L_tret0
    s_waitcnt lgkmcnt(8)
    ds_read_b64_tr_b16 a[120:121], v5 offset:8192
    ds_read_b64_tr_b16 a[122:123], v5 offset:9216
    v_mfma_f32_16x16x32_bf16 v[48:51], a[96:99], v[180:183], v[48:51]
    v_cvt_pk_bf16_f32 v25, v26, v27
    v_permlane16_swap_b32 v22, v24
    s_nop 0
    v_permlane16_swap_b32 v23, v25
    v_mfma_f32_16x16x32_bf16 v[36:39], a[100:103], v[176:179], v[36:39]
    s_waitcnt lgkmcnt(8)
    ds_read_b64_tr_b16 a[124:125], v6 offset:8192
    ds_read_b64_tr_b16 a[126:127], v6 offset:9216
    v_mfma_f32_16x16x32_bf16 v[52:55], a[100:103], v[180:183], v[52:55]
    v_accvgpr_write_b32 a88, v208
    v_accvgpr_write_b32 a89, v209
    v_accvgpr_write_b32 a90, v210
    v_mfma_f32_16x16x32_bf16 v[40:43], a[104:107], v[176:179], v[40:43]
    s_waitcnt lgkmcnt(8)
    ds_read_b64_tr_b16 a[96:97], v3 offset:4096
    ds_read_b64_tr_b16 a[98:99], v3 offset:5120
    v_mfma_f32_16x16x32_bf16 v[56:59], a[104:107], v[180:183], v[56:59]
    buffer_store_dwordx4 v[22:25], v7, s[44:47], s64 offen offset:256 sc1
    s_add_u32 s64, s64, 8192
    v_mfma_f32_16x16x32_bf16 v[44:47], a[108:111], v[176:179], v[44:47]
    s_waitcnt lgkmcnt(8)
    ds_read_b64_tr_b16 a[100:101], v4 offset:4096
    ds_read_b64_tr_b16 a[102:103], v4 offset:5120
    v_mfma_f32_16x16x32_bf16 v[60:63], a[108:111], v[180:183], v[60:63]
    v_accvgpr_write_b32 a91, v211
    v_accvgpr_write_b32 a92, v212
    v_accvgpr_write_b32 a93, v213
    v_mfma_f32_16x16x32_bf16 v[64:67], a[112:115], v[176:179], v[64:67]
    s_waitcnt lgkmcnt(8)
    ds_read_b64_tr_b16 a[104:105], v3 offset:12288
    ds_read_b64_tr_b16 a[106:107], v3 offset:13312
    v_mfma_f32_16x16x32_bf16 v[80:83], a[112:115], v[180:183], v[80:83]
    s_waitcnt vmcnt(7)
    v_cmp_ne_u32 vcc, 1, v19
    s_nop 1
    s_cbranch_vccnz L_retry1
L_cont1:
    v_mfma_f32_16x16x32_bf16 v[68:71], a[116:119], v[176:179], v[68:71]
    s_waitcnt lgkmcnt(8)
    ds_read_b64_tr_b16 a[108:109], v4 offset:12288
    ds_read_b64_tr_b16 a[110:111], v4 offset:13312
    v_mfma_f32_16x16x32_bf16 v[84:87], a[116:119], v[180:183], v[84:87]
    v_lshl_add_u32 v0, s54, 6, v1
    v_and_b32 v22, 7, v1
    v_lshlrev_b32 v9, 2, v22
    v_mfma_f32_16x16x32_bf16 v[72:75], a[120:123], v[176:179], v[72:75]
    s_waitcnt lgkmcnt(8)
    ds_read_b64_tr_b16 a[112:113], v5 offset:4096
    ds_read_b64_tr_b16 a[114:115], v5 offset:5120
    v_mfma_f32_16x16x32_bf16 v[88:91], a[120:123], v[180:183], v[88:91]
    v_and_b32 v22, 15, v1
    v_lshrrev_b32 v23, 4, v1
    v_lshlrev_b32 v22, 4, v22
    v_mfma_f32_16x16x32_bf16 v[76:79], a[124:127], v[176:179], v[76:79]
    s_waitcnt lgkmcnt(8)
    ds_read_b64_tr_b16 a[116:117], v6 offset:4096
    ds_read_b64_tr_b16 a[118:119], v6 offset:5120
    v_mfma_f32_16x16x32_bf16 v[92:95], a[124:127], v[180:183], v[92:95]
    v_lshl_add_u32 v22, v23, 10, v22
    v_add_u32 v14, s15, v22
    v_xor_b32 v15, 256, v14
    v_mfma_f32_16x16x32_bf16 v[32:35], a[96:99], v[184:187], v[32:35]
    s_waitcnt lgkmcnt(8)
    ds_read_b64_tr_b16 a[120:121], v5 offset:12288
    ds_read_b64_tr_b16 a[122:123], v5 offset:13312
    v_mfma_f32_16x16x32_bf16 v[48:51], a[96:99], v[188:191], v[48:51]
    v_xor_b32 v16, 512, v14
    v_xor_b32 v17, 768, v14
    v_and_b32 v22, 31, v1
    v_mfma_f32_16x16x32_bf16 v[36:39], a[100:103], v[184:187], v[36:39]
    s_waitcnt lgkmcnt(8)
    ds_read_b64_tr_b16 a[124:125], v6 offset:12288
    ds_read_b64_tr_b16 a[126:127], v6 offset:13312
    v_mfma_f32_16x16x32_bf16 v[52:55], a[100:103], v[188:191], v[52:55]
    s_add_u32 m0, s60, 16384
    v_lshrrev_b32 v23, 5, v1
    v_accvgpr_write_b32 a94, v214
    v_accvgpr_write_b32 a95, v215
    v_mfma_f32_16x16x32_bf16 v[40:43], a[104:107], v[184:187], v[40:43]
    s_waitcnt lgkmcnt(8)
    s_waitcnt vmcnt(2)
    s_barrier
    ds_read_b64_tr_b16 a[96:97], v3 offset:16384
    ds_read_b64_tr_b16 a[98:99], v3 offset:17408
    v_mfma_f32_16x16x32_bf16 v[56:59], a[104:107], v[188:191], v[56:59]
    s_lshl_b32 s56, s54, 9
    v_mfma_f32_16x16x32_bf16 v[44:47], a[108:111], v[184:187], v[44:47]
    s_waitcnt lgkmcnt(8)
    ds_read_b64_tr_b16 a[100:101], v4 offset:16384
    ds_read_b64_tr_b16 a[102:103], v4 offset:17408
    v_mfma_f32_16x16x32_bf16 v[60:63], a[108:111], v[188:191], v[60:63]
    s_add_u32 s95, s101, 0
    buffer_load_dwordx4 v10, s[44:47], s95 offen offset:0 sc1 lds
    v_mfma_f32_16x16x32_bf16 v[64:67], a[112:115], v[184:187], v[64:67]
    s_waitcnt lgkmcnt(8)
    ds_read_b64_tr_b16 a[104:105], v3 offset:24576
    ds_read_b64_tr_b16 a[106:107], v3 offset:25600
    v_mfma_f32_16x16x32_bf16 v[80:83], a[112:115], v[188:191], v[80:83]
    s_add_u32 s61, s101, 0
    buffer_load_dwordx4 v10, s[44:47], s61 offen offset:1024 sc1 lds
    v_mfma_f32_16x16x32_bf16 v[68:71], a[116:119], v[184:187], v[68:71]
    s_waitcnt lgkmcnt(8)
    ds_read_b64_tr_b16 a[108:109], v4 offset:24576
    ds_read_b64_tr_b16 a[110:111], v4 offset:25600
    v_mfma_f32_16x16x32_bf16 v[84:87], a[116:119], v[188:191], v[84:87]
    s_add_u32 s95, s101, 2048
    buffer_load_dwordx4 v10, s[44:47], s95 offen offset:2048 sc1 lds
    v_mfma_f32_16x16x32_bf16 v[72:75], a[120:123], v[184:187], v[72:75]
    s_waitcnt lgkmcnt(8)
    ds_read_b64_tr_b16 a[112:113], v5 offset:16384
    ds_read_b64_tr_b16 a[114:115], v5 offset:17408
    v_mfma_f32_16x16x32_bf16 v[88:91], a[120:123], v[188:191], v[88:91]
    s_add_u32 s61, s101, 2048
    v_lshlrev_b32 v22, 4, v22
    v_lshl_add_u32 v7, v23, 11, v22
    v_mfma_f32_16x16x32_bf16 v[76:79], a[124:127], v[184:187], v[76:79]
    s_waitcnt lgkmcnt(8)
    ds_read_b64_tr_b16 a[116:117], v6 offset:16384
    ds_read_b64_tr_b16 a[118:119], v6 offset:17408
    v_mfma_f32_16x16x32_bf16 v[92:95], a[124:127], v[188:191], v[92:95]
    buffer_load_dwordx4 v10, s[44:47], s61 offen offset:3072 sc1 lds
    v_mfma_f32_16x16x32_bf16 v[32:35], a[96:99], v[192:195], v[32:35]
    s_waitcnt lgkmcnt(8)
    ds_read_b64_tr_b16 a[120:121], v5 offset:24576
    ds_read_b64_tr_b16 a[122:123], v5 offset:25600
    v_mfma_f32_16x16x32_bf16 v[48:51], a[96:99], v[196:199], v[48:51]
    s_add_u32 m0, s60, 32768
    v_add_u32 v22, s56, v22
    v_mul_u32_u24 v24, 6144, v23
    v_mfma_f32_16x16x32_bf16 v[36:39], a[100:103], v[192:195], v[36:39]
    s_waitcnt lgkmcnt(8)
    ds_read_b64_tr_b16 a[124:125], v6 offset:24576
    ds_read_b64_tr_b16 a[126:127], v6 offset:25600
    v_mfma_f32_16x16x32_bf16 v[52:55], a[100:103], v[196:199], v[52:55]
    s_add_u32 s95, s101, 32768
    buffer_load_dwordx4 v10, s[44:47], s95 offen offset:0 sc1 lds
    v_mfma_f32_16x16x32_bf16 v[40:43], a[104:107], v[192:195], v[40:43]
    s_waitcnt lgkmcnt(8)
    ds_read_b64_tr_b16 a[96:97], v3 offset:20480
    ds_read_b64_tr_b16 a[98:99], v3 offset:21504
    v_mfma_f32_16x16x32_bf16 v[56:59], a[104:107], v[196:199], v[56:59]
    s_add_u32 s61, s101, 32768
    v_add_u32 v2, v22, v24
    v_add_u32 v2, 98304, v2
    v_mfma_f32_16x16x32_bf16 v[44:47], a[108:111], v[192:195], v[44:47]
    s_waitcnt lgkmcnt(8)
    ds_read_b64_tr_b16 a[100:101], v4 offset:20480
    ds_read_b64_tr_b16 a[102:103], v4 offset:21504
    v_mfma_f32_16x16x32_bf16 v[60:63], a[108:111], v[196:199], v[60:63]
    buffer_load_dwordx4 v10, s[44:47], s61 offen offset:1024 sc1 lds
    v_mfma_f32_16x16x32_bf16 v[64:67], a[112:115], v[192:195], v[64:67]
    s_waitcnt lgkmcnt(8)
    ds_read_b64_tr_b16 a[104:105], v3 offset:28672
    ds_read_b64_tr_b16 a[106:107], v3 offset:29696
    v_mfma_f32_16x16x32_bf16 v[80:83], a[112:115], v[196:199], v[80:83]
    s_add_u32 s95, s101, 34816
    v_mov_b32 v24, 110592
    v_mov_b32 v25, 82112
    v_mfma_f32_16x16x32_bf16 v[68:71], a[116:119], v[192:195], v[68:71]
    s_waitcnt lgkmcnt(8)
    ds_read_b64_tr_b16 a[108:109], v4 offset:28672
    ds_read_b64_tr_b16 a[110:111], v4 offset:29696
    v_mfma_f32_16x16x32_bf16 v[84:87], a[116:119], v[196:199], v[84:87]
    buffer_load_dwordx4 v10, s[44:47], s95 offen offset:2048 sc1 lds
    v_mfma_f32_16x16x32_bf16 v[72:75], a[120:123], v[192:195], v[72:75]
    s_waitcnt lgkmcnt(8)
    ds_read_b64_tr_b16 a[112:113], v5 offset:20480
    ds_read_b64_tr_b16 a[114:115], v5 offset:21504
    v_mfma_f32_16x16x32_bf16 v[88:91], a[120:123], v[196:199], v[88:91]
    s_add_u32 s61, s101, 34816
    buffer_load_dwordx4 v10, s[44:47], s61 offen offset:3072 sc1 lds
    v_mfma_f32_16x16x32_bf16 v[76:79], a[124:127], v[192:195], v[76:79]
    s_waitcnt lgkmcnt(8)
    ds_read_b64_tr_b16 a[116:117], v6 offset:20480
    ds_read_b64_tr_b16 a[118:119], v6 offset:21504
    v_mfma_f32_16x16x32_bf16 v[92:95], a[124:127], v[196:199], v[92:95]
    s_waitcnt vmcnt(8)
    s_mov_b64 exec, 1
    buffer_store_dword v30, off, s[44:47], s4 sc1
    s_mov_b64 exec, -1
    v_mfma_f32_16x16x32_bf16 v[32:35], a[96:99], v[200:203], v[32:35]
    s_waitcnt lgkmcnt(8)
    ds_read_b64_tr_b16 a[120:121], v5 offset:28672
    ds_read_b64_tr_b16 a[122:123], v5 offset:29696
    v_mfma_f32_16x16x32_bf16 v[48:51], a[96:99], v[204:207], v[48:51]
    s_add_u32 m0, s60, 49152
    v_cndmask_b32 v24, v24, v25, s[66:67]
    v_add_u32 v21, v22, v24
    v_mfma_f32_16x16x32_bf16 v[36:39], a[100:103], v[200:203], v[36:39]
    s_waitcnt lgkmcnt(8)
    ds_read_b64_tr_b16 a[124:125], v6 offset:28672
    ds_read_b64_tr_b16 a[126:127], v6 offset:29696
    v_mfma_f32_16x16x32_bf16 v[52:55], a[100:103], v[204:207], v[52:55]
    s_add_u32 s95, s101, 65536
    buffer_load_dwordx4 v10, s[44:47], s95 offen offset:0 sc1 lds
    v_mfma_f32_16x16x32_bf16 v[40:43], a[104:107], v[200:203], v[40:43]
    s_waitcnt lgkmcnt(8)
    ds_read_b64_tr_b16 a[96:97], v3 offset:32768
    ds_read_b64_tr_b16 a[98:99], v3 offset:33792
    v_mfma_f32_16x16x32_bf16 v[56:59], a[104:107], v[204:207], v[56:59]
    s_add_u32 s61, s101, 65536
    buffer_load_dwordx4 v10, s[44:47], s61 offen offset:1024 sc1 lds
    v_mfma_f32_16x16x32_bf16 v[44:47], a[108:111], v[200:203], v[44:47]
    s_waitcnt lgkmcnt(8)
    ds_read_b64_tr_b16 a[100:101], v4 offset:32768
    ds_read_b64_tr_b16 a[102:103], v4 offset:33792
    v_mfma_f32_16x16x32_bf16 v[60:63], a[108:111], v[204:207], v[60:63]
    s_add_u32 s95, s101, 67584
    v_bfe_u32 v22, v1, 2, 2
    v_lshl_add_u32 v22, v23, 2, v22
    v_mfma_f32_16x16x32_bf16 v[64:67], a[112:115], v[200:203], v[64:67]
    s_waitcnt lgkmcnt(8)
    ds_read_b64_tr_b16 a[104:105], v3 offset:40960
    ds_read_b64_tr_b16 a[106:107], v3 offset:41984
    v_mfma_f32_16x16x32_bf16 v[80:83], a[112:115], v[204:207], v[80:83]
    buffer_load_dwordx4 v10, s[44:47], s95 offen offset:2048 sc1 lds
    v_mfma_f32_16x16x32_bf16 v[68:71], a[116:119], v[200:203], v[68:71]
    s_waitcnt lgkmcnt(8)
    ds_read_b64_tr_b16 a[108:109], v4 offset:40960
    ds_read_b64_tr_b16 a[110:111], v4 offset:41984
    v_mfma_f32_16x16x32_bf16 v[84:87], a[116:119], v[204:207], v[84:87]
    s_add_u32 s61, s101, 67584
    v_lshl_add_u32 v22, v22, 4, s56
    v_mov_b32 v26, v25
    v_mfma_f32_16x16x32_bf16 v[72:75], a[120:123], v[200:203], v[72:75]
    s_waitcnt lgkmcnt(8)
    ds_read_b64_tr_b16 a[112:113], v5 offset:32768
    ds_read_b64_tr_b16 a[114:115], v5 offset:33792
    v_mfma_f32_16x16x32_bf16 v[88:91], a[120:123], v[204:207], v[88:91]
    buffer_load_dwordx4 v10, s[44:47], s61 offen offset:3072 sc1 lds
    v_mfma_f32_16x16x32_bf16 v[76:79], a[124:127], v[200:203], v[76:79]
    s_waitcnt lgkmcnt(8)
    ds_read_b64_tr_b16 a[116:117], v6 offset:32768
    ds_read_b64_tr_b16 a[118:119], v6 offset:33792
    v_mfma_f32_16x16x32_bf16 v[92:95], a[124:127], v[204:207], v[92:95]
    s_add_u32 m0, s60, 65536
    v_mov_b32 v27, v25
    v_mfma_f32_16x16x32_bf16 v[32:35], a[96:99], v[208:211], v[32:35]
    s_waitcnt lgkmcnt(8)
    ds_read_b64_tr_b16 a[120:121], v5 offset:40960
    ds_read_b64_tr_b16 a[122:123], v5 offset:41984
    v_mfma_f32_16x16x32_bf16 v[48:51], a[96:99], v[212:215], v[48:51]
    s_mov_b32 s68, 0x1111
    s_mov_b32 s69, 0x1111
    s_add_u32 s95, s101, 98304
    buffer_load_dwordx4 v10, s[44:47], s95 offen offset:0 sc1 lds
    v_mfma_f32_16x16x32_bf16 v[36:39], a[100:103], v[208:211], v[36:39]
    s_waitcnt lgkmcnt(8)
    ds_read_b64_tr_b16 a[124:125], v6 offset:40960
    ds_read_b64_tr_b16 a[126:127], v6 offset:41984
    v_mfma_f32_16x16x32_bf16 v[52:55], a[100:103], v[212:215], v[52:55]
    s_add_u32 s61, s101, 98304
    v_mov_b32 v23, 129024
    v_cndmask_b32 v26, v26, v23, s[68:69]
    v_mfma_f32_16x16x32_bf16 v[40:43], a[104:107], v[208:211], v[40:43]
    s_waitcnt lgkmcnt(8)
    ds_read_b64_tr_b16 a[96:97], v3 offset:36864
    ds_read_b64_tr_b16 a[98:99], v3 offset:37888
    v_mfma_f32_16x16x32_bf16 v[56:59], a[104:107], v[212:215], v[56:59]
    buffer_load_dwordx4 v10, s[44:47], s61 offen offset:1024 sc1 lds
    v_mfma_f32_16x16x32_bf16 v[44:47], a[108:111], v[208:211], v[44:47]
    s_waitcnt lgkmcnt(8)
    ds_read_b64_tr_b16 a[100:101], v4 offset:36864
    ds_read_b64_tr_b16 a[102:103], v4 offset:37888
    v_mfma_f32_16x16x32_bf16 v[60:63], a[108:111], v[212:215], v[60:63]
    s_add_u32 s95, s101, 100352
    v_mov_b32 v24, 148224
    v_cndmask_b32 v27, v27, v24, s[68:69]
    v_mfma_f32_16x16x32_bf16 v[64:67], a[112:115], v[208:211], v[64:67]
    s_waitcnt lgkmcnt(8)
    ds_read_b64_tr_b16 a[104:105], v3 offset:45056
    ds_read_b64_tr_b16 a[106:107], v3 offset:46080
    v_mfma_f32_16x16x32_bf16 v[80:83], a[112:115], v[212:215], v[80:83]
    s_mov_b32 s70, 0x2222
    s_mov_b32 s71, 0x2222
    v_mov_b32 v23, 135488
    v_mfma_f32_16x16x32_bf16 v[68:71], a[116:119], v[208:211], v[68:71]
    s_waitcnt lgkmcnt(8)
    ds_read_b64_tr_b16 a[108:109], v4 offset:45056
    ds_read_b64_tr_b16 a[110:111], v4 offset:46080
    v_mfma_f32_16x16x32_bf16 v[84:87], a[116:119], v[212:215], v[84:87]
    buffer_load_dwordx4 v10, s[44:47], s95 offen offset:2048 sc1 lds
    v_mfma_f32_16x16x32_bf16 v[72:75], a[120:123], v[208:211], v[72:75]
    s_waitcnt lgkmcnt(8)
    ds_read_b64_tr_b16 a[112:113], v5 offset:36864
    ds_read_b64_tr_b16 a[114:115], v5 offset:37888
    v_mfma_f32_16x16x32_bf16 v[88:91], a[120:123], v[212:215], v[88:91]
    v_cndmask_b32 v26, v26, v23, s[70:71]
    v_mov_b32 v24, 154688
    v_mfma_f32_16x16x32_bf16 v[76:79], a[124:127], v[208:211], v[76:79]
    s_waitcnt lgkmcnt(8)
    ds_read_b64_tr_b16 a[116:117], v6 offset:36864
    ds_read_b64_tr_b16 a[118:119], v6 offset:37888
    v_mfma_f32_16x16x32_bf16 v[92:95], a[124:127], v[212:215], v[92:95]
    s_add_u32 s61, s101, 100352
    v_cndmask_b32 v27, v27, v24, s[70:71]
    v_mfma_f32_16x16x32_bf16 v[32:35], a[96:99], v[216:219], v[32:35]
    s_waitcnt lgkmcnt(8)
    ds_read_b64_tr_b16 a[120:121], v5 offset:45056
    ds_read_b64_tr_b16 a[122:123], v5 offset:46080
    v_mfma_f32_16x16x32_bf16 v[48:51], a[96:99], v[220:223], v[48:51]
    s_mov_b32 s68, 0x4444
    s_mov_b32 s69, 0x4444
    buffer_load_dwordx4 v10, s[44:47], s61 offen offset:3072 sc1 lds
    v_mfma_f32_16x16x32_bf16 v[36:39], a[100:103], v[216:219], v[36:39]
    s_waitcnt lgkmcnt(8)
    ds_read_b64_tr_b16 a[124:125], v6 offset:45056
    ds_read_b64_tr_b16 a[126:127], v6 offset:46080
    v_mfma_f32_16x16x32_bf16 v[52:55], a[100:103], v[220:223], v[52:55]
    s_add_u32 s59, s91, 0
    v_mov_b32 v23, 129032
    v_cndmask_b32 v26, v26, v23, s[68:69]
    v_mfma_f32_16x16x32_bf16 v[40:43], a[104:107], v[216:219], v[40:43]
    s_waitcnt lgkmcnt(8)
    ds_read_b64_tr_b16 a[96:97], v3 offset:49152
    ds_read_b64_tr_b16 a[98:99], v3 offset:50176
    v_mfma_f32_16x16x32_bf16 v[56:59], a[104:107], v[220:223], v[56:59]
    buffer_load_dwordx4 a[128:131], v10, s[44:47], s59 offen offset:0 sc1
    v_mfma_f32_16x16x32_bf16 v[44:47], a[108:111], v[216:219], v[44:47]
    s_waitcnt lgkmcnt(8)
    ds_read_b64_tr_b16 a[100:101], v4 offset:49152
    ds_read_b64_tr_b16 a[102:103], v4 offset:50176
    v_mfma_f32_16x16x32_bf16 v[60:63], a[108:111], v[220:223], v[60:63]
    v_mov_b32 v24, 148232
    v_cndmask_b32 v27, v27, v24, s[68:69]
    v_mfma_f32_16x16x32_bf16 v[64:67], a[112:115], v[216:219], v[64:67]
    s_waitcnt lgkmcnt(8)
    ds_read_b64_tr_b16 a[104:105], v3 offset:57344
    ds_read_b64_tr_b16 a[106:107], v3 offset:58368
    v_mfma_f32_16x16x32_bf16 v[80:83], a[112:115], v[220:223], v[80:83]
    s_mov_b32 s70, 0x8888
    s_mov_b32 s71, 0x8888
    v_mov_b32 v23, 135496
    v_mfma_f32_16x16x32_bf16 v[68:71], a[116:119], v[216:219], v[68:71]
    s_waitcnt lgkmcnt(8)
    ds_read_b64_tr_b16 a[108:109], v4 offset:57344
    ds_read_b64_tr_b16 a[110:111], v4 offset:58368
    v_mfma_f32_16x16x32_bf16 v[84:87], a[116:119], v[220:223], v[84:87]
    buffer_load_dwordx4 a[132:135], v10, s[44:47], s59 offen offset:1024 sc1
    v_mfma_f32_16x16x32_bf16 v[72:75], a[120:123], v[216:219], v[72:75]
    s_waitcnt lgkmcnt(8)
    ds_read_b64_tr_b16 a[112:113], v5 offset:49152
    ds_read_b64_tr_b16 a[114:115], v5 offset:50176
    v_mfma_f32_16x16x32_bf16 v[88:91], a[120:123], v[220:223], v[88:91]
    v_cndmask_b32 v26, v26, v23, s[70:71]
    v_mov_b32 v24, 154696
    v_mfma_f32_16x16x32_bf16 v[76:79], a[124:127], v[216:219], v[76:79]
    s_waitcnt lgkmcnt(8)
    ds_read_b64_tr_b16 a[116:117], v6 offset:49152
    ds_read_b64_tr_b16 a[118:119], v6 offset:50176
    v_mfma_f32_16x16x32_bf16 v[92:95], a[124:127], v[220:223], v[92:95]
    buffer_load_dwordx4 a[136:139], v10, s[44:47], s59 offen offset:2048 sc1
    v_mfma_f32_16x16x32_bf16 v[32:35], a[96:99], v[224:227], v[32:35]
    s_waitcnt lgkmcnt(8)
    ds_read_b64_tr_b16 a[120:121], v5 offset:57344
    ds_read_b64_tr_b16 a[122:123], v5 offset:58368
    v_mfma_f32_16x16x32_bf16 v[48:51], a[96:99], v[228:231], v[48:51]
    v_cndmask_b32 v27, v27, v24, s[70:71]
    v_mfma_f32_16x16x32_bf16 v[36:39], a[100:103], v[224:227], v[36:39]
    s_waitcnt lgkmcnt(8)
    ds_read_b64_tr_b16 a[124:125], v6 offset:57344
    ds_read_b64_tr_b16 a[126:127], v6 offset:58368
    v_mfma_f32_16x16x32_bf16 v[52:55], a[100:103], v[228:231], v[52:55]
    s_mov_b32 s68, 0x11110000
    s_mov_b32 s69, 0x11110000
    v_mov_b32 v23, 141952
    v_mfma_f32_16x16x32_bf16 v[40:43], a[104:107], v[224:227], v[40:43]
    s_waitcnt lgkmcnt(8)
    ds_read_b64_tr_b16 a[96:97], v3 offset:53248
    ds_read_b64_tr_b16 a[98:99], v3 offset:54272
    v_mfma_f32_16x16x32_bf16 v[56:59], a[104:107], v[228:231], v[56:59]
    buffer_load_dwordx4 a[140:143], v10, s[44:47], s59 offen offset:3072 sc1
    v_mfma_f32_16x16x32_bf16 v[44:47], a[108:111], v[224:227], v[44:47]
    s_waitcnt lgkmcnt(8)
    ds_read_b64_tr_b16 a[100:101], v4 offset:53248
    ds_read_b64_tr_b16 a[102:103], v4 offset:54272
    v_mfma_f32_16x16x32_bf16 v[60:63], a[108:111], v[228:231], v[60:63]
    v_cndmask_b32 v26, v26, v23, s[68:69]
    v_mov_b32 v24, 141960
    v_mfma_f32_16x16x32_bf16 v[64:67], a[112:115], v[224:227], v[64:67]
    s_waitcnt lgkmcnt(8)
    ds_read_b64_tr_b16 a[104:105], v3 offset:61440
    ds_read_b64_tr_b16 a[106:107], v3 offset:62464
    v_mfma_f32_16x16x32_bf16 v[80:83], a[112:115], v[228:231], v[80:83]
    buffer_load_dwordx4 a[144:147], v11, s[44:47], s59 offen offset:0 sc1
    v_mfma_f32_16x16x32_bf16 v[68:71], a[116:119], v[224:227], v[68:71]
    s_waitcnt lgkmcnt(8)
    ds_read_b64_tr_b16 a[108:109], v4 offset:61440
    ds_read_b64_tr_b16 a[110:111], v4 offset:62464
    v_mfma_f32_16x16x32_bf16 v[84:87], a[116:119], v[228:231], v[84:87]
    v_cndmask_b32 v27, v27, v24, s[68:69]
    v_add_u32 v26, v26, v22
    v_mfma_f32_16x16x32_bf16 v[72:75], a[120:123], v[224:227], v[72:75]
    s_waitcnt lgkmcnt(8)
    ds_read_b64_tr_b16 a[112:113], v5 offset:53248
    ds_read_b64_tr_b16 a[114:115], v5 offset:54272
    v_mfma_f32_16x16x32_bf16 v[88:91], a[120:123], v[228:231], v[88:91]
    s_add_u32 s57, s91, 40960
    v_add_u32 v27, v27, v22
    v_lshlrev_b32 v24, 4, v0
    v_mfma_f32_16x16x32_bf16 v[76:79], a[124:127], v[224:227], v[76:79]
    s_waitcnt lgkmcnt(8)
    ds_read_b64_tr_b16 a[116:117], v6 offset:53248
    ds_read_b64_tr_b16 a[118:119], v6 offset:54272
    v_mfma_f32_16x16x32_bf16 v[92:95], a[124:127], v[228:231], v[92:95]
    buffer_load_dwordx4 a[148:151], v10, s[44:47], s57 offen offset:0 sc1
    v_mfma_f32_16x16x32_bf16 v[32:35], a[96:99], v[232:235], v[32:35]
    s_waitcnt lgkmcnt(8)
    ds_read_b64_tr_b16 a[120:121], v5 offset:61440
    ds_read_b64_tr_b16 a[122:123], v5 offset:62464
    v_mfma_f32_16x16x32_bf16 v[48:51], a[96:99], v[236:239], v[48:51]
    v_and_b32 v25, 2047, v24
    v_add_u32 v24, 82112, v24
    v_mfma_f32_16x16x32_bf16 v[36:39], a[100:103], v[232:235], v[36:39]
    s_waitcnt lgkmcnt(8)
    ds_read_b64_tr_b16 a[124:125], v6 offset:61440
    ds_read_b64_tr_b16 a[126:127], v6 offset:62464
    v_mfma_f32_16x16x32_bf16 v[52:55], a[100:103], v[236:239], v[52:55]
    buffer_load_dwordx4 a[152:155], v10, s[44:47], s57 offen offset:1024 sc1
    v_subrev_u32 v3, 81920, v3
    v_mfma_f32_16x16x32_bf16 v[40:43], a[104:107], v[232:235], v[40:43]
    s_waitcnt lgkmcnt(8)
    ds_read_b64_tr_b16 a[96:97], v3 offset:0
    ds_read_b64_tr_b16 a[98:99], v3 offset:1024
    v_mfma_f32_16x16x32_bf16 v[56:59], a[104:107], v[236:239], v[56:59]
    v_add_u32 v25, 86208, v25
    v_subrev_u32 v4, 81920, v4
    v_mfma_f32_16x16x32_bf16 v[44:47], a[108:111], v[232:235], v[44:47]
    s_waitcnt lgkmcnt(8)
    ds_read_b64_tr_b16 a[100:101], v4 offset:0
    ds_read_b64_tr_b16 a[102:103], v4 offset:1024
    v_mfma_f32_16x16x32_bf16 v[60:63], a[108:111], v[236:239], v[60:63]
    buffer_load_dword v19, v20, s[44:47], 0 offen offset:1024 sc1
    v_mfma_f32_16x16x32_bf16 v[64:67], a[112:115], v[232:235], v[64:67]
    s_waitcnt lgkmcnt(8)
    ds_read_b64_tr_b16 a[104:105], v3 offset:8192
    ds_read_b64_tr_b16 a[106:107], v3 offset:9216
    v_mfma_f32_16x16x32_bf16 v[80:83], a[112:115], v[236:239], v[80:83]
    v_subrev_u32 v5, 81920, v5
    v_mfma_f32_16x16x32_bf16 v[68:71], a[116:119], v[232:235], v[68:71]
    s_waitcnt lgkmcnt(8)
    ds_read_b64_tr_b16 a[108:109], v4 offset:8192
    ds_read_b64_tr_b16 a[110:111], v4 offset:9216
    v_mfma_f32_16x16x32_bf16 v[84:87], a[116:119], v[236:239], v[84:87]
    buffer_load_dwordx4 a[156:159], v10, s[44:47], s57 offen offset:2048 sc1
    v_mfma_f32_16x16x32_bf16 v[72:75], a[120:123], v[232:235], v[72:75]
    s_waitcnt lgkmcnt(8)
    ds_read_b64_tr_b16 a[112:113], v5 offset:0
    ds_read_b64_tr_b16 a[114:115], v5 offset:1024
    v_mfma_f32_16x16x32_bf16 v[88:91], a[120:123], v[236:239], v[88:91]
    v_subrev_u32 v6, 81920, v6
    v_mfma_f32_16x16x32_bf16 v[76:79], a[124:127], v[232:235], v[76:79]
    s_waitcnt lgkmcnt(8)
    ds_read_b64_tr_b16 a[116:117], v6 offset:0
    ds_read_b64_tr_b16 a[118:119], v6 offset:1024
    v_mfma_f32_16x16x32_bf16 v[92:95], a[124:127], v[236:239], v[92:95]
    buffer_load_dwordx4 a[160:163], v10, s[44:47], s57 offen offset:3072 sc1
    v_mfma_f32_16x16x32_bf16 v[32:35], a[96:99], v[240:243], v[32:35]
    s_waitcnt lgkmcnt(8)
    ds_read_b64_tr_b16 a[120:121], v5 offset:8192
    ds_read_b64_tr_b16 a[122:123], v5 offset:9216
    v_mfma_f32_16x16x32_bf16 v[48:51], a[96:99], v[244:247], v[48:51]
    v_mfma_f32_16x16x32_bf16 v[36:39], a[100:103], v[240:243], v[36:39]
    s_waitcnt lgkmcnt(8)
    ds_read_b64_tr_b16 a[124:125], v6 offset:8192
    ds_read_b64_tr_b16 a[126:127], v6 offset:9216
    v_mfma_f32_16x16x32_bf16 v[52:55], a[100:103], v[244:247], v[52:55]
    v_mfma_f32_16x16x32_bf16 v[40:43], a[104:107], v[240:243], v[40:43]
    s_waitcnt lgkmcnt(8)
    ds_read_b64_tr_b16 a[96:97], v3 offset:4096
    ds_read_b64_tr_b16 a[98:99], v3 offset:5120
    v_mfma_f32_16x16x32_bf16 v[56:59], a[104:107], v[244:247], v[56:59]
    buffer_load_dwordx4 a[164:167], v11, s[44:47], s57 offen offset:0 sc1
    v_mfma_f32_16x16x32_bf16 v[44:47], a[108:111], v[240:243], v[44:47]
    s_waitcnt lgkmcnt(8)
    ds_read_b64_tr_b16 a[100:101], v4 offset:4096
    ds_read_b64_tr_b16 a[102:103], v4 offset:5120
    v_mfma_f32_16x16x32_bf16 v[60:63], a[108:111], v[244:247], v[60:63]
    s_add_u32 s59, s91, 163840
    v_mfma_f32_16x16x32_bf16 v[64:67], a[112:115], v[240:243], v[64:67]
    s_waitcnt lgkmcnt(8)
    ds_read_b64_tr_b16 a[104:105], v3 offset:12288
    ds_read_b64_tr_b16 a[106:107], v3 offset:13312
    v_mfma_f32_16x16x32_bf16 v[80:83], a[112:115], v[244:247], v[80:83]
    buffer_load_dwordx4 a[168:171], v10, s[44:47], s59 offen offset:0 sc1
    v_mfma_f32_16x16x32_bf16 v[68:71], a[116:119], v[240:243], v[68:71]
    s_waitcnt lgkmcnt(8)
    ds_read_b64_tr_b16 a[108:109], v4 offset:12288
    ds_read_b64_tr_b16 a[110:111], v4 offset:13312
    v_mfma_f32_16x16x32_bf16 v[84:87], a[116:119], v[244:247], v[84:87]
    v_mfma_f32_16x16x32_bf16 v[72:75], a[120:123], v[240:243], v[72:75]
    s_waitcnt lgkmcnt(8)
    ds_read_b64_tr_b16 a[112:113], v5 offset:4096
    ds_read_b64_tr_b16 a[114:115], v5 offset:5120
    v_mfma_f32_16x16x32_bf16 v[88:91], a[120:123], v[244:247], v[88:91]
    v_mfma_f32_16x16x32_bf16 v[76:79], a[124:127], v[240:243], v[76:79]
    s_waitcnt lgkmcnt(8)
    ds_read_b64_tr_b16 a[116:117], v6 offset:4096
    ds_read_b64_tr_b16 a[118:119], v6 offset:5120
    v_mfma_f32_16x16x32_bf16 v[92:95], a[124:127], v[244:247], v[92:95]
    buffer_load_dwordx4 a[172:175], v10, s[44:47], s59 offen offset:1024 sc1
    v_mfma_f32_16x16x32_bf16 v[32:35], a[96:99], v[248:251], v[32:35]
    s_waitcnt lgkmcnt(8)
    ds_read_b64_tr_b16 a[120:121], v5 offset:12288
    ds_read_b64_tr_b16 a[122:123], v5 offset:13312
    v_mfma_f32_16x16x32_bf16 v[48:51], a[96:99], v[252:255], v[48:51]
    v_mfma_f32_16x16x32_bf16 v[36:39], a[100:103], v[248:251], v[36:39]
    s_waitcnt lgkmcnt(8)
    ds_read_b64_tr_b16 a[124:125], v6 offset:12288
    ds_read_b64_tr_b16 a[126:127], v6 offset:13312
    v_mfma_f32_16x16x32_bf16 v[52:55], a[100:103], v[252:255], v[52:55]
    buffer_load_dwordx4 a[176:179], v10, s[44:47], s59 offen offset:2048 sc1
    v_mfma_f32_16x16x32_bf16 v[40:43], a[104:107], v[248:251], v[40:43]
    s_waitcnt lgkmcnt(8)
    s_waitcnt vmcnt(27)
    s_barrier
    ds_read_b128 a[96:99], v18 offset:16384
    v_mfma_f32_16x16x32_bf16 v[56:59], a[104:107], v[252:255], v[56:59]
    v_mfma_f32_16x16x32_bf16 v[44:47], a[108:111], v[248:251], v[44:47]
    s_waitcnt lgkmcnt(7)
    ds_read_b128 a[100:103], v18 offset:17408
    v_mfma_f32_16x16x32_bf16 v[60:63], a[108:111], v[252:255], v[60:63]
    v_mfma_f32_16x16x32_bf16 v[64:67], a[112:115], v[248:251], v[64:67]
    s_waitcnt lgkmcnt(6)
    ds_read_b128 a[104:107], v18 offset:18432
    v_mfma_f32_16x16x32_bf16 v[80:83], a[112:115], v[252:255], v[80:83]
    buffer_load_dwordx4 a[180:183], v10, s[44:47], s59 offen offset:3072 sc1
    v_mfma_f32_16x16x32_bf16 v[68:71], a[116:119], v[248:251], v[68:71]
    s_waitcnt lgkmcnt(5)
    ds_read_b128 a[108:111], v18 offset:19456
    v_mfma_f32_16x16x32_bf16 v[84:87], a[116:119], v[252:255], v[84:87]
    v_mfma_f32_16x16x32_bf16 v[72:75], a[120:123], v[248:251], v[72:75]
    s_waitcnt lgkmcnt(4)
    ds_read_b128 a[112:115], v18 offset:20480
    v_mfma_f32_16x16x32_bf16 v[88:91], a[120:123], v[252:255], v[88:91]
    v_mfma_f32_16x16x32_bf16 v[76:79], a[124:127], v[248:251], v[76:79]
    s_waitcnt lgkmcnt(4)
    ds_read_b128 a[116:119], v18 offset:21504
    v_mfma_f32_16x16x32_bf16 v[92:95], a[124:127], v[252:255], v[92:95]
    buffer_load_dwordx4 a[184:187], v11, s[44:47], s59 offen offset:0 sc1
    v_mfma_f32_16x16x32_bf16 v[184:187], a[96:99], v[96:99], 0
    s_waitcnt lgkmcnt(4)
    ds_read_b128 a[120:123], v18 offset:22528
    v_mfma_f32_16x16x32_bf16 v[200:203], a[96:99], v[100:103], 0
    s_add_u32 s57, s91, 204800
    v_mfma_f32_16x16x32_bf16 v[188:191], a[100:103], v[96:99], 0
    s_waitcnt lgkmcnt(4)
    ds_read_b128 a[124:127], v18 offset:23552
    v_mfma_f32_16x16x32_bf16 v[204:207], a[100:103], v[100:103], 0
    buffer_load_dwordx4 a[188:191], v10, s[44:47], s57 offen offset:0 sc1
    v_mfma_f32_16x16x32_bf16 v[192:195], a[104:107], v[96:99], 0
    s_waitcnt lgkmcnt(4)
    ds_read_b128 a[96:99], v18 offset:24576
    v_and_b32 v22, 95, v0
    v_mfma_f32_16x16x32_bf16 v[208:211], a[104:107], v[100:103], 0
    v_and_b32 v23, 32, v0
    v_lshrrev_b32 v5, 1, v22
    v_and_b32 v5, 32, v5
    v_mfma_f32_16x16x32_bf16 v[196:199], a[108:111], v[96:99], 0
    s_waitcnt lgkmcnt(4)
    ds_read_b128 a[100:103], v18 offset:25600
    v_and_or_b32 v22, v22, 31, v5
    v_mfma_f32_16x16x32_bf16 v[212:215], a[108:111], v[100:103], 0
    buffer_load_dwordx4 a[192:195], v10, s[44:47], s57 offen offset:1024 sc1
    v_lshl_add_u32 v22, v23, 1, v22
    v_mfma_f32_16x16x32_bf16 v[184:187], a[112:115], v[104:107], v[184:187]
    s_waitcnt lgkmcnt(4)
    ds_read_b128 a[104:107], v18 offset:26624
    v_lshlrev_b32 v5, 4, v22
    v_mfma_f32_16x16x32_bf16 v[200:203], a[112:115], v[108:111], v[200:203]
    v_mul_f32 v22, v28, v32
L_page4:
    s_cbranch_execz L_tret1
    v_mul_f32 v23, v28, v33
    v_mfma_f32_16x16x32_bf16 v[188:191], a[116:119], v[104:107], v[188:191]
    s_waitcnt lgkmcnt(4)
    ds_read_b128 a[108:111], v18 offset:27648
    v_mfma_f32_16x16x32_bf16 v[204:207], a[116:119], v[108:111], v[204:207]
    buffer_load_dwordx4 a[196:199], v10, s[44:47], s57 offen offset:2048 sc1
    v_exp_f32 v22, v22
    v_mfma_f32_16x16x32_bf16 v[192:195], a[120:123], v[104:107], v[192:195]
    s_waitcnt lgkmcnt(4)
    ds_read_b128 a[112:115], v18 offset:28672
    v_mul_f32 v40, v32, v40
    v_mfma_f32_16x16x32_bf16 v[208:211], a[120:123], v[108:111], v[208:211]
    v_exp_f32 v23, v23
    v_mul_f32 v41, v33, v41
    v_mfma_f32_16x16x32_bf16 v[196:199], a[124:127], v[104:107], v[196:199]
    s_waitcnt lgkmcnt(4)
    ds_read_b128 a[116:119], v18 offset:29696
    v_fma_f32 v22, v22, v12, v12
    v_mfma_f32_16x16x32_bf16 v[212:215], a[124:127], v[108:111], v[212:215]
    buffer_load_dwordx4 a[200:203], v10, s[44:47], s57 offen offset:3072 sc1
    v_fma_f32 v23, v23, v12, v12
    v_mfma_f32_16x16x32_bf16 v[184:187], a[96:99], v[112:115], v[184:187]
    s_waitcnt lgkmcnt(4)
    ds_read_b128 a[120:123], v18 offset:30720
    v_mfma_f32_16x16x32_bf16 v[200:203], a[96:99], v[116:119], v[200:203]
    s_waitcnt vmcnt(12)
    v_cmp_ne_u32 vcc, 1, v19
    s_nop 1
    s_cbranch_vccnz L_retry2
L_cont2:
    v_mfma_f32_16x16x32_bf16 v[188:191], a[100:103], v[112:115], v[188:191]
    s_waitcnt lgkmcnt(4)
    ds_read_b128 a[124:127], v18 offset:31744
    v_add_u32 v20, 8192, v10
    v_mfma_f32_16x16x32_bf16 v[204:207], a[100:103], v[116:119], v[204:207]
    s_add_u32 m0, s84, 0
    v_rcp_f32 v22, v22
    v_mfma_f32_16x16x32_bf16 v[192:195], a[104:107], v[112:115], v[192:195]
    s_waitcnt lgkmcnt(4)
    s_barrier
    ds_read_b128 a[96:99], v18 offset:32768
    v_mfma_f32_16x16x32_bf16 v[208:211], a[104:107], v[116:119], v[208:211]
    buffer_load_dwordx4 v10, s[44:47], s78 offen offset:0 sc1 lds
    v_mfma_f32_16x16x32_bf16 v[196:199], a[108:111], v[112:115], v[196:199]
    s_waitcnt lgkmcnt(4)
    ds_read_b128 a[100:103], v18 offset:33792
    v_mfma_f32_16x16x32_bf16 v[212:215], a[108:111], v[116:119], v[212:215]
    s_add_u32 m0, s60, 0
    v_rcp_f32 v23, v23
    v_mul_f32 v40, v40, v22
    v_mul_f32 v41, v41, v23
    v_mfma_f32_16x16x32_bf16 v[184:187], a[112:115], v[120:123], v[184:187]
    s_waitcnt lgkmcnt(4)
    ds_read_b128 a[104:107], v18 offset:34816
    v_cvt_pk_bf16_f32 v32, v40, v41
    v_mfma_f32_16x16x32_bf16 v[200:203], a[112:115], v[124:127], v[200:203]
    s_add_u32 s95, s101, 131072
    buffer_load_dwordx4 v10, s[44:47], s95 offen offset:0 sc1 lds
    v_mfma_f32_16x16x32_bf16 v[188:191], a[116:119], v[120:123], v[188:191]
    s_waitcnt lgkmcnt(4)
    ds_read_b128 a[108:111], v18 offset:35840
    v_mul_f32 v22, v28, v34
    v_mfma_f32_16x16x32_bf16 v[204:207], a[116:119], v[124:127], v[204:207]
    s_add_u32 s61, s101, 131072
    v_mul_f32 v23, v28, v35
    v_exp_f32 v22, v22
    v_mfma_f32_16x16x32_bf16 v[192:195], a[120:123], v[120:123], v[192:195]
    s_waitcnt lgkmcnt(4)
    ds_read_b128 a[112:115], v18 offset:36864
    v_mul_f32 v42, v34, v42
    v_mfma_f32_16x16x32_bf16 v[208:211], a[120:123], v[124:127], v[208:211]
    buffer_load_dwordx4 v10, s[44:47], s61 offen offset:1024 sc1 lds
    v_mfma_f32_16x16x32_bf16 v[196:199], a[124:127], v[120:123], v[196:199]
    s_waitcnt lgkmcnt(4)
    ds_read_b128 a[116:119], v18 offset:37888
    v_mfma_f32_16x16x32_bf16 v[212:215], a[124:127], v[124:127], v[212:215]
    s_add_u32 s95, s101, 133120
    v_exp_f32 v23, v23
    v_mul_f32 v43, v35, v43
    v_fma_f32 v22, v22, v12, v12
    v_mfma_f32_16x16x32_bf16 v[184:187], a[96:99], v[128:131], v[184:187]
    s_waitcnt lgkmcnt(4)
    ds_read_b128 a[120:123], v18 offset:38912
    v_fma_f32 v23, v23, v12, v12
    v_mfma_f32_16x16x32_bf16 v[200:203], a[96:99], v[132:135], v[200:203]
    buffer_load_dwordx4 v10, s[44:47], s95 offen offset:2048 sc1 lds
    v_mfma_f32_16x16x32_bf16 v[188:191], a[100:103], v[128:131], v[188:191]
    s_waitcnt lgkmcnt(4)
    ds_read_b128 a[124:127], v18 offset:39936
    v_mfma_f32_16x16x32_bf16 v[204:207], a[100:103], v[132:135], v[204:207]
    s_add_u32 s61, s101, 133120
    v_rcp_f32 v22, v22
    v_rcp_f32 v23, v23
    v_mfma_f32_16x16x32_bf16 v[192:195], a[104:107], v[128:131], v[192:195]
    s_waitcnt lgkmcnt(4)
    ds_read_b128 a[96:99], v18 offset:40960
    v_mul_f32 v42, v42, v22
    v_mfma_f32_16x16x32_bf16 v[208:211], a[104:107], v[132:135], v[208:211]
    buffer_load_dwordx4 v10, s[44:47], s61 offen offset:3072 sc1 lds
    v_mul_f32 v43, v43, v23
    v_mfma_f32_16x16x32_bf16 v[196:199], a[108:111], v[128:131], v[196:199]
    s_waitcnt lgkmcnt(4)
    ds_read_b128 a[100:103], v18 offset:41984
    v_cvt_pk_bf16_f32 v33, v42, v43
    v_mfma_f32_16x16x32_bf16 v[212:215], a[108:111], v[132:135], v[212:215]
    s_sub_u32 m0, s85, 2048
    v_mul_f32 v22, v28, v36
    v_mul_f32 v23, v28, v37
    v_mfma_f32_16x16x32_bf16 v[184:187], a[112:115], v[136:139], v[184:187]
    s_waitcnt lgkmcnt(4)
    ds_read_b128 a[104:107], v18 offset:43008
    v_mfma_f32_16x16x32_bf16 v[200:203], a[112:115], v[140:143], v[200:203]
    buffer_load_dwordx4 v10, s[44:47], s78 offen offset:2048 sc1 lds
    v_exp_f32 v22, v22
    v_mfma_f32_16x16x32_bf16 v[188:191], a[116:119], v[136:139], v[188:191]
    s_waitcnt lgkmcnt(4)
    ds_read_b128 a[108:111], v18 offset:44032
    v_mul_f32 v44, v36, v44
    v_mfma_f32_16x16x32_bf16 v[204:207], a[116:119], v[140:143], v[204:207]
    s_add_u32 m0, s86, 0
    v_exp_f32 v23, v23
    v_mul_f32 v45, v37, v45
    v_mfma_f32_16x16x32_bf16 v[192:195], a[120:123], v[136:139], v[192:195]
    s_waitcnt lgkmcnt(4)
    ds_read_b128 a[112:115], v18 offset:45056
    v_fma_f32 v22, v22, v12, v12
    v_mfma_f32_16x16x32_bf16 v[208:211], a[120:123], v[140:143], v[208:211]
    buffer_load_dwordx4 v11, s[44:47], s78 offen offset:0 sc1 lds
    v_fma_f32 v23, v23, v12, v12
    v_mfma_f32_16x16x32_bf16 v[196:199], a[124:127], v[136:139], v[196:199]
    s_waitcnt lgkmcnt(4)
    ds_read_b128 a[116:119], v18 offset:46080
    v_mfma_f32_16x16x32_bf16 v[212:215], a[124:127], v[140:143], v[212:215]
    s_sub_u32 m0, s87, 2048
    v_rcp_f32 v22, v22
    v_rcp_f32 v23, v23
    v_mfma_f32_16x16x32_bf16 v[184:187], a[96:99], v[144:147], v[184:187]
    s_waitcnt lgkmcnt(4)
    ds_read_b128 a[120:123], v18 offset:47104
    v_mul_f32 v44, v44, v22
    v_mfma_f32_16x16x32_bf16 v[200:203], a[96:99], v[148:151], v[200:203]
    buffer_load_dwordx4 v11, s[44:47], s78 offen offset:2048 sc1 lds
    v_mul_f32 v45, v45, v23
    v_mfma_f32_16x16x32_bf16 v[188:191], a[100:103], v[144:147], v[188:191]
    s_waitcnt lgkmcnt(4)
    ds_read_b128 a[124:127], v18 offset:48128
    v_cvt_pk_bf16_f32 v34, v44, v45
    v_mfma_f32_16x16x32_bf16 v[204:207], a[100:103], v[148:151], v[204:207]
    s_add_u32 m0, s88, 0
    v_mul_f32 v22, v28, v38
    v_mul_f32 v23, v28, v39
    v_mfma_f32_16x16x32_bf16 v[192:195], a[104:107], v[144:147], v[192:195]
    s_waitcnt lgkmcnt(4)
    ds_read_b128 a[96:99], v18 offset:49152
    v_mfma_f32_16x16x32_bf16 v[208:211], a[104:107], v[148:151], v[208:211]
    buffer_load_dwordx4 v20, s[44:47], s78 offen offset:0 sc1 lds
    v_exp_f32 v22, v22
    v_mfma_f32_16x16x32_bf16 v[196:199], a[108:111], v[144:147], v[196:199]
    s_waitcnt lgkmcnt(4)
    ds_read_b128 a[100:103], v18 offset:50176
    v_mul_f32 v46, v38, v46
    v_mfma_f32_16x16x32_bf16 v[212:215], a[108:111], v[148:151], v[212:215]
    s_add_u32 m0, s84, 2048
    v_exp_f32 v23, v23
    v_mul_f32 v47, v39, v47
    v_mfma_f32_16x16x32_bf16 v[184:187], a[112:115], v[152:155], v[184:187]
    s_waitcnt lgkmcnt(4)
    ds_read_b128 a[104:107], v18 offset:51200
    v_fma_f32 v22, v22, v12, v12
    v_mfma_f32_16x16x32_bf16 v[200:203], a[112:115], v[156:159], v[200:203]
    buffer_load_dwordx4 v10, s[44:47], s79 offen offset:0 sc1 lds
    v_fma_f32 v23, v23, v12, v12
    v_mfma_f32_16x16x32_bf16 v[188:191], a[116:119], v[152:155], v[188:191]
    s_waitcnt lgkmcnt(4)
    ds_read_b128 a[108:111], v18 offset:52224
    v_mfma_f32_16x16x32_bf16 v[204:207], a[116:119], v[156:159], v[204:207]
    s_add_u32 m0, s85, 0
    v_rcp_f32 v22, v22
    v_rcp_f32 v23, v23
    v_mfma_f32_16x16x32_bf16 v[192:195], a[120:123], v[152:155], v[192:195]
    s_waitcnt lgkmcnt(4)
    ds_read_b128 a[112:115], v18 offset:53248
    v_mul_f32 v46, v46, v22
    v_mfma_f32_16x16x32_bf16 v[208:211], a[120:123], v[156:159], v[208:211]
    buffer_load_dwordx4 v10, s[44:47], s79 offen offset:2048 sc1 lds
    v_mul_f32 v47, v47, v23
    v_mfma_f32_16x16x32_bf16 v[196:199], a[124:127], v[152:155], v[196:199]
    s_waitcnt lgkmcnt(4)
    ds_read_b128 a[116:119], v18 offset:54272
    v_cvt_pk_bf16_f32 v35, v46, v47
    v_mfma_f32_16x16x32_bf16 v[212:215], a[124:127], v[156:159], v[212:215]
    v_permlane16_swap_b32 v32, v34
    v_permlane16_swap_b32 v33, v35
    v_mfma_f32_16x16x32_bf16 v[184:187], a[96:99], v[160:163], v[184:187]
    s_waitcnt lgkmcnt(4)
    ds_read_b128 a[120:123], v18 offset:55296
    v_mfma_f32_16x16x32_bf16 v[200:203], a[96:99], v[164:167], v[200:203]
    buffer_store_dwordx4 v[32:35], v8, s[44:47], s8 offen offset:0 sc1
    v_cmp_gt_i32 s[68:69], s16, v0
    v_mul_f32 v22, v29, v48
    v_mfma_f32_16x16x32_bf16 v[188:191], a[100:103], v[160:163], v[188:191]
    s_waitcnt lgkmcnt(4)
    ds_read_b128 a[124:127], v18 offset:56320
    v_mov_b32 v150, 0x3f800000
    v_mfma_f32_16x16x32_bf16 v[204:207], a[100:103], v[164:167], v[204:207]
    v_mul_f32 v23, v29, v49
    v_exp_f32 v22, v22
    v_mfma_f32_16x16x32_bf16 v[192:195], a[104:107], v[160:163], v[192:195]
    s_waitcnt lgkmcnt(4)
    ds_read_b128 a[96:99], v18 offset:57344
    v_mov_b32 v149, 0x3f80
    v_mfma_f32_16x16x32_bf16 v[208:211], a[104:107], v[164:167], v[208:211]
    v_mul_f32 v56, v48, v56
    v_exp_f32 v23, v23
    v_mfma_f32_16x16x32_bf16 v[196:199], a[108:111], v[160:163], v[196:199]
    s_waitcnt lgkmcnt(4)
    ds_read_b128 a[100:103], v18 offset:58368
    v_mov_b32 v148, 0x3f80f180
    v_mfma_f32_16x16x32_bf16 v[212:215], a[108:111], v[164:167], v[212:215]
    v_mul_f32 v57, v49, v57
    v_fma_f32 v22, v22, v13, v13
    v_fma_f32 v23, v23, v13, v13
    v_mfma_f32_16x16x32_bf16 v[184:187], a[112:115], v[168:171], v[184:187]
    s_waitcnt lgkmcnt(4)
    ds_read_b128 a[104:107], v18 offset:59392
    v_cndmask_b32 v148, v150, v148, s[68:69]
    v_mfma_f32_16x16x32_bf16 v[200:203], a[112:115], v[172:175], v[200:203]
    v_rcp_f32 v22, v22
    v_mfma_f32_16x16x32_bf16 v[188:191], a[116:119], v[168:171], v[188:191]
    s_waitcnt lgkmcnt(4)
    ds_read_b128 a[108:111], v18 offset:60416
    v_mov_b32 v151, v149
    v_mfma_f32_16x16x32_bf16 v[204:207], a[116:119], v[172:175], v[204:207]
    v_rcp_f32 v23, v23
    v_mul_f32 v56, v56, v22
    v_mfma_f32_16x16x32_bf16 v[192:195], a[120:123], v[168:171], v[192:195]
    s_waitcnt lgkmcnt(4)
    ds_read_b128 a[112:115], v18 offset:61440
    v_mfma_f32_16x16x32_bf16 v[208:211], a[120:123], v[172:175], v[208:211]
    s_add_u32 m0, s86, 2048
    ds_write2_b64 v24, v[148:149], v[148:149] offset0:0 offset1:1
    v_mul_f32 v57, v57, v23
    v_cvt_pk_bf16_f32 v48, v56, v57
    v_mfma_f32_16x16x32_bf16 v[196:199], a[124:127], v[168:171], v[196:199]
    s_waitcnt lgkmcnt(5)
    ds_read_b128 a[116:119], v18 offset:62464
    v_mfma_f32_16x16x32_bf16 v[212:215], a[124:127], v[172:175], v[212:215]
    s_mov_b32 s68, 0xffffffff
    ds_write2_b64 v25, v[150:151], v[150:151] offset0:0 offset1:1
    v_mov_b32 v152, 0xf1800000
    v_mul_f32 v22, v29, v50
    v_mfma_f32_16x16x32_bf16 v[184:187], a[96:99], v[176:179], v[184:187]
    s_waitcnt lgkmcnt(6)
    ds_read_b128 a[120:123], v18 offset:63488
    v_mul_f32 v23, v29, v51
    v_mfma_f32_16x16x32_bf16 v[200:203], a[96:99], v[180:183], v[200:203]
    s_mov_b32 s69, 0xfffffff0
    buffer_load_dwordx4 v11, s[44:47], s79 offen offset:0 sc1 lds
    v_mfma_f32_16x16x32_bf16 v[188:191], a[100:103], v[176:179], v[188:191]
    s_waitcnt lgkmcnt(6)
    ds_read_b128 a[124:127], v18 offset:64512
    v_cndmask_b32 v96, 0, v152, s[68:69]
    v_mfma_f32_16x16x32_bf16 v[204:207], a[100:103], v[180:183], v[204:207]
    s_mov_b32 s70, 0xfffffffe
    s_add_u32 m0, s87, 0
    s_nop 0
    buffer_load_dwordx4 v11, s[44:47], s79 offen offset:2048 sc1 lds
    v_add_u32 v18, 65536, v18
    v_mfma_f32_16x16x32_bf16 v[192:195], a[104:107], v[176:179], v[192:195]
    s_waitcnt lgkmcnt(6)
    ds_read_b128 a[96:99], v18 offset:0
    v_cndmask_b32 v112, v152, 0, s[68:69]
    v_mfma_f32_16x16x32_bf16 v[208:211], a[104:107], v[180:183], v[208:211]
    s_mov_b32 s71, 0xffffffe0
    s_add_u32 m0, s88, 2048
    s_nop 0
    buffer_load_dwordx4 v20, s[44:47], s79 offen offset:0 sc1 lds
    v_mfma_f32_16x16x32_bf16 v[196:199], a[108:111], v[176:179], v[196:199]
    s_waitcnt lgkmcnt(6)
    ds_read_b128 a[100:103], v18 offset:1024
    v_cndmask_b32 v97, 0, v152, s[70:71]
    v_mfma_f32_16x16x32_bf16 v[212:215], a[108:111], v[180:183], v[212:215]
    s_mov_b32 s68, 0xfffffffc
    v_exp_f32 v22, v22
    v_mul_f32 v58, v50, v58
    v_mfma_f32_16x16x32_bf16 v[184:187], a[112:115], a[64:67], v[184:187]
    s_waitcnt lgkmcnt(5)
    ds_read_b128 a[104:107], v18 offset:2048
    v_cndmask_b32 v113, v152, 0, s[70:71]
    v_mfma_f32_16x16x32_bf16 v[200:203], a[112:115], a[68:71], v[200:203]
    s_mov_b32 s69, 0xffffffc0
    s_add_u32 m0, s84, 4096
    s_nop 0
    buffer_load_dwordx4 v10, s[44:47], s80 offen offset:0 sc1 lds
    v_mfma_f32_16x16x32_bf16 v[188:191], a[116:119], a[64:67], v[188:191]
    s_waitcnt lgkmcnt(4)
    ds_read_b128 a[108:111], v18 offset:3072
    v_cndmask_b32 v98, 0, v152, s[68:69]
    v_mfma_f32_16x16x32_bf16 v[204:207], a[116:119], a[68:71], v[204:207]
    s_mov_b32 s70, 0xfffffff8
    s_add_u32 m0, s85, 2048
    s_nop 0
    buffer_load_dwordx4 v10, s[44:47], s80 offen offset:2048 sc1 lds
    v_mfma_f32_16x16x32_bf16 v[192:195], a[120:123], a[64:67], v[192:195]
    s_waitcnt lgkmcnt(4)
    ds_read_b128 a[112:115], v18 offset:4096
    v_cndmask_b32 v114, v152, 0, s[68:69]
    v_mfma_f32_16x16x32_bf16 v[208:211], a[120:123], a[68:71], v[208:211]
    s_mov_b32 s71, 0xffffff80
    v_exp_f32 v23, v23
    v_mul_f32 v59, v51, v59
    v_mfma_f32_16x16x32_bf16 v[196:199], a[124:127], a[64:67], v[196:199]
    s_waitcnt lgkmcnt(4)
    ds_read_b128 a[116:119], v18 offset:5120
    v_cndmask_b32 v99, 0, v152, s[70:71]
    v_mfma_f32_16x16x32_bf16 v[212:215], a[124:127], a[68:71], v[212:215]
    s_mov_b32 s68, 0xffffff00
    s_add_u32 m0, s86, 4096
    s_nop 0
    buffer_load_dwordx4 v11, s[44:47], s80 offen offset:0 sc1 lds
    v_mfma_f32_16x16x32_bf16 v[184:187], a[96:99], a[72:75], v[184:187]
    s_waitcnt lgkmcnt(4)
    ds_read_b128 a[120:123], v18 offset:6144
    v_cndmask_b32 v115, v152, 0, s[70:71]
    v_mfma_f32_16x16x32_bf16 v[200:203], a[96:99], a[76:79], v[200:203]
    s_mov_b32 s69, 0xfffff000
    v_fma_f32 v22, v22, v13, v13
    v_fma_f32 v23, v23, v13, v13
    v_mfma_f32_16x16x32_bf16 v[188:191], a[100:103], a[72:75], v[188:191]
    s_waitcnt lgkmcnt(4)
    ds_read_b128 a[124:127], v18 offset:7168
    v_cndmask_b32 v100, 0, v152, s[68:69]
    v_mfma_f32_16x16x32_bf16 v[204:207], a[100:103], a[76:79], v[204:207]
    s_mov_b32 s70, 0xfffffe00
    s_add_u32 m0, s87, 2048
    s_nop 0
    buffer_load_dwordx4 v11, s[44:47], s80 offen offset:2048 sc1 lds
    v_mfma_f32_16x16x32_bf16 v[192:195], a[104:107], a[72:75], v[192:195]
    s_waitcnt lgkmcnt(4)
    ds_read_b128 a[96:99], v18 offset:8192
    v_cndmask_b32 v116, v152, 0, s[68:69]
    v_mfma_f32_16x16x32_bf16 v[208:211], a[104:107], a[76:79], v[208:211]
    s_mov_b32 s71, 0xffffe000
    v_rcp_f32 v22, v22
    v_mfma_f32_16x16x32_bf16 v[196:199], a[108:111], a[72:75], v[196:199]
    s_waitcnt lgkmcnt(4)
    ds_read_b128 a[100:103], v18 offset:9216
    v_cndmask_b32 v101, 0, v152, s[70:71]
    v_mfma_f32_16x16x32_bf16 v[212:215], a[108:111], a[76:79], v[212:215]
    s_mov_b32 s68, 0xfffffc00
    s_add_u32 m0, s88, 4096
    s_nop 0
    buffer_load_dwordx4 v20, s[44:47], s80 offen offset:0 sc1 lds
    v_mfma_f32_16x16x32_bf16 v[184:187], a[112:115], a[80:83], v[184:187]
    s_waitcnt lgkmcnt(4)
    ds_read_b128 a[104:107], v18 offset:10240
    v_cndmask_b32 v117, v152, 0, s[70:71]
    v_mfma_f32_16x16x32_bf16 v[200:203], a[112:115], a[84:87], v[200:203]
    s_mov_b32 s69, 0xffffc000
    v_rcp_f32 v23, v23
    v_mul_f32 v58, v58, v22
    v_mfma_f32_16x16x32_bf16 v[188:191], a[116:119], a[80:83], v[188:191]
    s_waitcnt lgkmcnt(4)
    ds_read_b128 a[108:111], v18 offset:11264
    v_mfma_f32_16x16x32_bf16 v[204:207], a[116:119], a[84:87], v[204:207]
    s_mov_b32 s70, 0xfffff800
    buffer_load_dwordx4 v[128:131], v7, s[44:47], s93 offen sc1
    s_add_u32 s93, s93, 4096
    v_cndmask_b32 v102, 0, v152, s[68:69]
    v_mfma_f32_16x16x32_bf16 v[192:195], a[120:123], a[80:83], v[192:195]
    s_waitcnt lgkmcnt(4)
    ds_read_b128 a[112:115], v18 offset:12288
    v_cndmask_b32 v118, v152, 0, s[68:69]
    v_mfma_f32_16x16x32_bf16 v[208:211], a[120:123], a[84:87], v[208:211]
    s_mov_b32 s71, 0xffff8000
    v_mul_f32 v59, v59, v23
    v_cvt_pk_bf16_f32 v49, v58, v59
    v_mul_f32 v22, v29, v52
    v_mfma_f32_16x16x32_bf16 v[196:199], a[124:127], a[80:83], v[196:199]
    s_waitcnt lgkmcnt(4)
    ds_read_b128 a[116:119], v18 offset:13312
    v_cndmask_b32 v103, 0, v152, s[70:71]
    v_mfma_f32_16x16x32_bf16 v[212:215], a[124:127], a[84:87], v[212:215]
    s_mov_b32 s68, 0xffff0000
    buffer_load_dwordx4 v[136:139], v7, s[44:47], s93 offen sc1
    v_mfma_f32_16x16x32_bf16 v[184:187], a[96:99], a[88:91], v[184:187]
    s_waitcnt lgkmcnt(4)
    ds_read_b128 a[120:123], v18 offset:14336
    v_cndmask_b32 v119, v152, 0, s[70:71]
    v_mfma_f32_16x16x32_bf16 v[200:203], a[96:99], a[92:95], v[200:203]
    s_mov_b32 s69, 0xfff00000
    v_mul_f32 v23, v29, v53
    v_exp_f32 v22, v22
    v_mfma_f32_16x16x32_bf16 v[188:191], a[100:103], a[88:91], v[188:191]
    s_waitcnt lgkmcnt(4)
    ds_read_b128 a[124:127], v18 offset:15360
    v_cndmask_b32 v104, 0, v152, s[68:69]
    v_mfma_f32_16x16x32_bf16 v[204:207], a[100:103], a[92:95], v[204:207]
    s_mov_b32 s70, 0xfffe0000
    buffer_load_dwordx4 v[132:135], v7, s[44:47], s93 offen offset:2048 sc1
    v_subrev_u32 v18, 65536, v18
    v_mfma_f32_16x16x32_bf16 v[192:195], a[104:107], a[88:91], v[192:195]
    s_waitcnt lgkmcnt(4)
    s_waitcnt vmcnt(18)
    s_barrier
    ds_read_b128 a[96:99], v18 offset:0
    v_cndmask_b32 v120, v152, 0, s[68:69]
    v_mfma_f32_16x16x32_bf16 v[208:211], a[104:107], a[92:95], v[208:211]
    s_mov_b32 s71, 0xffe00000
    v_mul_f32 v60, v52, v60
    v_mfma_f32_16x16x32_bf16 v[196:199], a[108:111], a[88:91], v[196:199]
    s_waitcnt lgkmcnt(4)
    ds_read_b128 a[100:103], v18 offset:1024
    v_cndmask_b32 v105, 0, v152, s[70:71]
    v_mfma_f32_16x16x32_bf16 v[212:215], a[108:111], a[92:95], v[212:215]
    s_mov_b32 s68, 0xfffc0000
    buffer_load_dwordx4 a[204:207], v11, s[44:47], s57 offen offset:0 sc1
    v_mfma_f32_16x16x32_bf16 v[184:187], a[112:115], v[216:219], v[184:187]
    s_waitcnt lgkmcnt(4)
    ds_read_b128 a[104:107], v18 offset:2048
    v_cndmask_b32 v121, v152, 0, s[70:71]
    v_mfma_f32_16x16x32_bf16 v[200:203], a[112:115], v[220:223], v[200:203]
    s_mov_b32 s69, 0xffc00000
    v_exp_f32 v23, v23
    v_mul_f32 v61, v53, v61
    v_mfma_f32_16x16x32_bf16 v[188:191], a[116:119], v[216:219], v[188:191]
    s_waitcnt lgkmcnt(4)
    ds_read_b128 a[108:111], v18 offset:3072
    v_cndmask_b32 v106, 0, v152, s[68:69]
    v_mfma_f32_16x16x32_bf16 v[204:207], a[116:119], v[220:223], v[204:207]
    s_mov_b32 s70, 0xfff80000
    s_add_u32 s59, s91, 245760
    buffer_load_dwordx4 a[208:211], v10, s[44:47], s59 offen offset:0 sc1
    v_mfma_f32_16x16x32_bf16 v[192:195], a[120:123], v[216:219], v[192:195]
    s_waitcnt lgkmcnt(4)
    ds_read_b128 a[112:115], v18 offset:4096
    v_cndmask_b32 v122, v152, 0, s[68:69]
    v_mfma_f32_16x16x32_bf16 v[208:211], a[120:123], v[220:223], v[208:211]
    s_mov_b32 s71, 0xff800000
    v_fma_f32 v22, v22, v13, v13
    v_fma_f32 v23, v23, v13, v13
    v_mfma_f32_16x16x32_bf16 v[196:199], a[124:127], v[216:219], v[196:199]
    s_waitcnt lgkmcnt(4)
    ds_read_b128 a[116:119], v18 offset:5120
    v_cndmask_b32 v107, 0, v152, s[70:71]
    v_mfma_f32_16x16x32_bf16 v[212:215], a[124:127], v[220:223], v[212:215]
    s_mov_b32 s68, 0xff000000
    buffer_load_dwordx4 a[212:215], v10, s[44:47], s59 offen offset:1024 sc1
    v_mfma_f32_16x16x32_bf16 v[184:187], a[96:99], v[224:227], v[184:187]
    s_waitcnt lgkmcnt(4)
    ds_read_b128 a[120:123], v18 offset:6144
    v_cndmask_b32 v123, v152, 0, s[70:71]
    v_mfma_f32_16x16x32_bf16 v[200:203], a[96:99], v[228:231], v[200:203]
    s_mov_b32 s69, 0xf0000000
    v_rcp_f32 v22, v22
    v_mfma_f32_16x16x32_bf16 v[188:191], a[100:103], v[224:227], v[188:191]
    s_waitcnt lgkmcnt(4)
    ds_read_b128 a[124:127], v18 offset:7168
    v_cndmask_b32 v108, 0, v152, s[68:69]
    v_mfma_f32_16x16x32_bf16 v[204:207], a[100:103], v[228:231], v[204:207]
    s_mov_b32 s70, 0xfe000000
    buffer_load_dwordx4 a[216:219], v10, s[44:47], s59 offen offset:2048 sc1
    v_mfma_f32_16x16x32_bf16 v[192:195], a[104:107], v[224:227], v[192:195]
    s_waitcnt lgkmcnt(4)
    ds_read_b128 a[96:99], v18 offset:8192
    v_cndmask_b32 v124, v152, 0, s[68:69]
    v_mfma_f32_16x16x32_bf16 v[208:211], a[104:107], v[228:231], v[208:211]
    s_mov_b32 s71, 0xe0000000
    v_rcp_f32 v23, v23
    v_mul_f32 v60, v60, v22
    v_mfma_f32_16x16x32_bf16 v[196:199], a[108:111], v[224:227], v[196:199]
    s_waitcnt lgkmcnt(4)
    ds_read_b128 a[100:103], v18 offset:9216
    v_cndmask_b32 v109, 0, v152, s[70:71]
    v_mfma_f32_16x16x32_bf16 v[212:215], a[108:111], v[228:231], v[212:215]
    s_mov_b32 s68, 0xfc000000
    buffer_load_dwordx4 a[220:223], v10, s[44:47], s59 offen offset:3072 sc1
    v_mfma_f32_16x16x32_bf16 v[184:187], a[112:115], v[232:235], v[184:187]
    s_waitcnt lgkmcnt(4)
    ds_read_b128 a[104:107], v18 offset:10240
    v_cndmask_b32 v125, v152, 0, s[70:71]
    v_mfma_f32_16x16x32_bf16 v[200:203], a[112:115], v[236:239], v[200:203]
    s_mov_b32 s69, 0xc0000000
    v_mul_f32 v61, v61, v23
    v_cvt_pk_bf16_f32 v50, v60, v61
    v_mul_f32 v22, v29, v54
    v_mfma_f32_16x16x32_bf16 v[188:191], a[116:119], v[232:235], v[188:191]
    s_waitcnt lgkmcnt(4)
    ds_read_b128 a[108:111], v18 offset:11264
    v_cndmask_b32 v110, 0, v152, s[68:69]
    v_mfma_f32_16x16x32_bf16 v[204:207], a[116:119], v[236:239], v[204:207]
    s_mov_b32 s70, 0xf8000000
    buffer_load_dwordx4 a[224:227], v11, s[44:47], s59 offen offset:0 sc1
    v_mfma_f32_16x16x32_bf16 v[192:195], a[120:123], v[232:235], v[192:195]
    s_waitcnt lgkmcnt(4)
    ds_read_b128 a[112:115], v18 offset:12288
    v_cndmask_b32 v126, v152, 0, s[68:69]
    v_mfma_f32_16x16x32_bf16 v[208:211], a[120:123], v[236:239], v[208:211]
    s_mov_b32 s71, 0x80000000
    v_mul_f32 v23, v29, v55
    v_exp_f32 v22, v22
    v_mfma_f32_16x16x32_bf16 v[196:199], a[124:127], v[232:235], v[196:199]
    s_waitcnt lgkmcnt(4)
    ds_read_b128 a[116:119], v18 offset:13312
    v_cndmask_b32 v111, 0, v152, s[70:71]
    v_mfma_f32_16x16x32_bf16 v[212:215], a[124:127], v[236:239], v[212:215]
    s_add_u32 s57, s91, 286720
    buffer_load_dwordx4 a[0:3], v10, s[44:47], s57 offen offset:0 sc1
    v_mfma_f32_16x16x32_bf16 v[184:187], a[96:99], v[240:243], v[184:187]
    s_waitcnt lgkmcnt(4)
    ds_read_b128 a[120:123], v18 offset:14336
    v_cndmask_b32 v127, v152, 0, s[70:71]
    v_mfma_f32_16x16x32_bf16 v[200:203], a[96:99], v[244:247], v[200:203]
    v_mul_f32 v62, v54, v62
    v_exp_f32 v23, v23
    v_mfma_f32_16x16x32_bf16 v[188:191], a[100:103], v[240:243], v[188:191]
    s_waitcnt lgkmcnt(4)
    ds_read_b128 a[124:127], v18 offset:15360
    v_mul_f32 v63, v55, v63
    v_mfma_f32_16x16x32_bf16 v[204:207], a[100:103], v[244:247], v[204:207]
    buffer_load_dwordx4 a[4:7], v10, s[44:47], s57 offen offset:1024 sc1
    v_fma_f32 v22, v22, v13, v13
    v_mfma_f32_16x16x32_bf16 v[192:195], a[104:107], v[240:243], v[192:195]
    s_waitcnt lgkmcnt(4)
    v_fma_f32 v23, v23, v13, v13
    v_mfma_f32_16x16x32_bf16 v[208:211], a[104:107], v[244:247], v[208:211]
    v_rcp_f32 v22, v22
    v_mfma_f32_16x16x32_bf16 v[196:199], a[108:111], v[240:243], v[196:199]
    s_waitcnt lgkmcnt(3)
    v_mfma_f32_16x16x32_bf16 v[212:215], a[108:111], v[244:247], v[212:215]
    buffer_load_dwordx4 a[8:11], v10, s[44:47], s57 offen offset:2048 sc1
    v_rcp_f32 v23, v23
    v_mfma_f32_16x16x32_bf16 v[184:187], a[112:115], v[248:251], v[184:187]
    s_waitcnt lgkmcnt(2)
    v_mul_f32 v62, v62, v22
    v_mul_f32 v63, v63, v23
    v_mfma_f32_16x16x32_bf16 v[200:203], a[112:115], v[252:255], v[200:203]
    v_cvt_pk_bf16_f32 v51, v62, v63
    v_permlane16_swap_b32 v48, v50
    v_mfma_f32_16x16x32_bf16 v[188:191], a[116:119], v[248:251], v[188:191]
    s_waitcnt lgkmcnt(1)
    v_permlane16_swap_b32 v49, v51
    v_mfma_f32_16x16x32_bf16 v[204:207], a[116:119], v[252:255], v[204:207]
    buffer_load_dwordx4 a[12:15], v10, s[44:47], s57 offen offset:3072 sc1
    v_mfma_f32_16x16x32_bf16 v[192:195], a[120:123], v[248:251], v[192:195]
    s_waitcnt lgkmcnt(0)
    v_mfma_f32_16x16x32_bf16 v[208:211], a[120:123], v[252:255], v[208:211]
    buffer_store_dwordx4 v[48:51], v8, s[44:47], s8 offen offset:256 sc1
    s_add_u32 s8, s8, 4096
    v_mfma_f32_16x16x32_bf16 v[196:199], a[124:127], v[248:251], v[196:199]
    v_mfma_f32_16x16x32_bf16 v[212:215], a[124:127], v[252:255], v[212:215]
    v_pk_mul_f32 v[22:23], v[64:65], v[28:29] op_sel:[0,0] op_sel_hi:[1,0]
    v_pk_mul_f32 v[24:25], v[66:67], v[28:29] op_sel:[0,0] op_sel_hi:[1,0]
    v_exp_f32 v22, v22
    v_exp_f32 v23, v23
    v_exp_f32 v24, v24
    v_exp_f32 v25, v25
    v_pk_mul_f32 v[72:73], v[64:65], v[72:73]
    v_pk_mul_f32 v[74:75], v[66:67], v[74:75]
    v_pk_fma_f32 v[22:23], v[22:23], v[12:13], v[12:13] op_sel:[0,0,0] op_sel_hi:[1,0,0]
    v_pk_fma_f32 v[24:25], v[24:25], v[12:13], v[12:13] op_sel:[0,0,0] op_sel_hi:[1,0,0]
    v_rcp_f32 v22, v22
    v_rcp_f32 v23, v23
    v_rcp_f32 v24, v24
    v_rcp_f32 v25, v25
    v_pk_mul_f32 v[72:73], v[72:73], v[22:23]
    v_pk_mul_f32 v[74:75], v[74:75], v[24:25]
    v_cvt_pk_bf16_f32 v64, v72, v73
    v_cvt_pk_bf16_f32 v65, v74, v75
    v_pk_mul_f32 v[22:23], v[68:69], v[28:29] op_sel:[0,0] op_sel_hi:[1,0]
    v_pk_mul_f32 v[24:25], v[70:71], v[28:29] op_sel:[0,0] op_sel_hi:[1,0]
    v_exp_f32 v22, v22
    v_exp_f32 v23, v23
    v_exp_f32 v24, v24
    v_exp_f32 v25, v25
    v_pk_mul_f32 v[76:77], v[68:69], v[76:77]
    v_pk_mul_f32 v[78:79], v[70:71], v[78:79]
    v_pk_fma_f32 v[22:23], v[22:23], v[12:13], v[12:13] op_sel:[0,0,0] op_sel_hi:[1,0,0]
    v_pk_fma_f32 v[24:25], v[24:25], v[12:13], v[12:13] op_sel:[0,0,0] op_sel_hi:[1,0,0]
    v_rcp_f32 v22, v22
    v_rcp_f32 v23, v23
    v_rcp_f32 v24, v24
    v_rcp_f32 v25, v25
    v_pk_mul_f32 v[76:77], v[76:77], v[22:23]
    v_pk_mul_f32 v[78:79], v[78:79], v[24:25]
    v_cvt_pk_bf16_f32 v66, v76, v77
    v_cvt_pk_bf16_f32 v67, v78, v79
    s_nop 0
    v_permlane16_swap_b32 v64, v66
    v_permlane16_swap_b32 v65, v67
    buffer_store_dwordx4 v[64:67], v8, s[44:47], s8 offen offset:0 sc1
    v_pk_mul_f32 v[22:23], v[80:81], v[28:29] op_sel:[0,1] op_sel_hi:[1,1]
    v_pk_mul_f32 v[24:25], v[82:83], v[28:29] op_sel:[0,1] op_sel_hi:[1,1]
    v_exp_f32 v22, v22
    v_exp_f32 v23, v23
    v_exp_f32 v24, v24
    v_exp_f32 v25, v25
    v_pk_mul_f32 v[88:89], v[80:81], v[88:89]
    v_pk_mul_f32 v[90:91], v[82:83], v[90:91]
    v_pk_fma_f32 v[22:23], v[22:23], v[12:13], v[12:13] op_sel:[0,1,1] op_sel_hi:[1,1,1]
    v_pk_fma_f32 v[24:25], v[24:25], v[12:13], v[12:13] op_sel:[0,1,1] op_sel_hi:[1,1,1]
    v_rcp_f32 v22, v22
    v_rcp_f32 v23, v23
    v_rcp_f32 v24, v24
    v_rcp_f32 v25, v25
    v_pk_mul_f32 v[88:89], v[88:89], v[22:23]
    v_pk_mul_f32 v[90:91], v[90:91], v[24:25]
    v_cvt_pk_bf16_f32 v80, v88, v89
    v_cvt_pk_bf16_f32 v81, v90, v91
    v_pk_mul_f32 v[22:23], v[84:85], v[28:29] op_sel:[0,1] op_sel_hi:[1,1]
    v_pk_mul_f32 v[24:25], v[86:87], v[28:29] op_sel:[0,1] op_sel_hi:[1,1]
    v_exp_f32 v22, v22
    v_exp_f32 v23, v23
    v_exp_f32 v24, v24
    v_exp_f32 v25, v25
    v_pk_mul_f32 v[92:93], v[84:85], v[92:93]
    v_pk_mul_f32 v[94:95], v[86:87], v[94:95]
    v_pk_fma_f32 v[22:23], v[22:23], v[12:13], v[12:13] op_sel:[0,1,1] op_sel_hi:[1,1,1]
    v_pk_fma_f32 v[24:25], v[24:25], v[12:13], v[12:13] op_sel:[0,1,1] op_sel_hi:[1,1,1]
    v_rcp_f32 v22, v22
    v_rcp_f32 v23, v23
    v_rcp_f32 v24, v24
L_page5:
    s_cbranch_execz L_tret1
    v_rcp_f32 v25, v25
    v_pk_mul_f32 v[92:93], v[92:93], v[22:23]
    v_pk_mul_f32 v[94:95], v[94:95], v[24:25]
    v_cvt_pk_bf16_f32 v82, v92, v93
    v_cvt_pk_bf16_f32 v83, v94, v95
    s_nop 0
    v_permlane16_swap_b32 v80, v82
    v_permlane16_swap_b32 v81, v83
    buffer_store_dwordx4 v[80:83], v8, s[44:47], s8 offen offset:256 sc1
    v_pk_mul_f32 v[22:23], v[184:185], v[28:29] op_sel:[0,0] op_sel_hi:[1,0]
    v_pk_mul_f32 v[24:25], v[186:187], v[28:29] op_sel:[0,0] op_sel_hi:[1,0]
    v_exp_f32 v22, v22
    v_exp_f32 v23, v23
    v_exp_f32 v24, v24
    v_exp_f32 v25, v25
    v_pk_mul_f32 v[192:193], v[184:185], v[192:193]
    v_pk_mul_f32 v[194:195], v[186:187], v[194:195]
    v_pk_fma_f32 v[22:23], v[22:23], v[12:13], v[12:13] op_sel:[0,0,0] op_sel_hi:[1,0,0]
    v_pk_fma_f32 v[24:25], v[24:25], v[12:13], v[12:13] op_sel:[0,0,0] op_sel_hi:[1,0,0]
    v_rcp_f32 v22, v22
    v_rcp_f32 v23, v23
    v_rcp_f32 v24, v24
    v_rcp_f32 v25, v25
    v_pk_mul_f32 v[192:193], v[192:193], v[22:23]
    v_pk_mul_f32 v[194:195], v[194:195], v[24:25]
    v_cvt_pk_bf16_f32 v184, v192, v193
    v_cvt_pk_bf16_f32 v185, v194, v195
    s_waitcnt vmcnt(16)
    s_barrier
    ds_read_b128 v[216:219], v2 offset:4096
    ds_read_b128 v[224:227], v21 offset:4096
    ds_read_b128 v[220:223], v2 offset:22528
    v_pk_mul_f32 v[22:23], v[188:189], v[28:29] op_sel:[0,0] op_sel_hi:[1,0]
    v_pk_mul_f32 v[24:25], v[190:191], v[28:29] op_sel:[0,0] op_sel_hi:[1,0]
    v_exp_f32 v22, v22
    v_exp_f32 v23, v23
    v_exp_f32 v24, v24
    v_exp_f32 v25, v25
    v_pk_mul_f32 v[196:197], v[188:189], v[196:197]
    v_pk_mul_f32 v[198:199], v[190:191], v[198:199]
    v_pk_fma_f32 v[22:23], v[22:23], v[12:13], v[12:13] op_sel:[0,0,0] op_sel_hi:[1,0,0]
    v_pk_fma_f32 v[24:25], v[24:25], v[12:13], v[12:13] op_sel:[0,0,0] op_sel_hi:[1,0,0]
    v_rcp_f32 v22, v22
    v_rcp_f32 v23, v23
    v_rcp_f32 v24, v24
    v_rcp_f32 v25, v25
    v_pk_mul_f32 v[196:197], v[196:197], v[22:23]
    v_pk_mul_f32 v[198:199], v[198:199], v[24:25]
    v_cvt_pk_bf16_f32 v186, v196, v197
    v_cvt_pk_bf16_f32 v187, v198, v199
    s_nop 0
    v_permlane16_swap_b32 v184, v186
    v_permlane16_swap_b32 v185, v187
    buffer_store_dwordx4 v[184:187], v8, s[44:47], s9 offen offset:0 sc1
    v_pk_mul_f32 v[22:23], v[200:201], v[28:29] op_sel:[0,1] op_sel_hi:[1,1]
    v_pk_mul_f32 v[24:25], v[202:203], v[28:29] op_sel:[0,1] op_sel_hi:[1,1]
    v_exp_f32 v22, v22
    v_exp_f32 v23, v23
    v_exp_f32 v24, v24
    v_exp_f32 v25, v25
    v_pk_mul_f32 v[208:209], v[200:201], v[208:209]
    v_pk_mul_f32 v[210:211], v[202:203], v[210:211]
    v_pk_fma_f32 v[22:23], v[22:23], v[12:13], v[12:13] op_sel:[0,1,1] op_sel_hi:[1,1,1]
    v_pk_fma_f32 v[24:25], v[24:25], v[12:13], v[12:13] op_sel:[0,1,1] op_sel_hi:[1,1,1]
    v_rcp_f32 v22, v22
    v_rcp_f32 v23, v23
    v_rcp_f32 v24, v24
    v_rcp_f32 v25, v25
    v_pk_mul_f32 v[208:209], v[208:209], v[22:23]
    v_pk_mul_f32 v[210:211], v[210:211], v[24:25]
    v_cvt_pk_bf16_f32 v200, v208, v209
    v_cvt_pk_bf16_f32 v201, v210, v211
    v_pk_mul_f32 v[22:23], v[204:205], v[28:29] op_sel:[0,1] op_sel_hi:[1,1]
    v_pk_mul_f32 v[24:25], v[206:207], v[28:29] op_sel:[0,1] op_sel_hi:[1,1]
    v_exp_f32 v22, v22
    v_exp_f32 v23, v23
    v_exp_f32 v24, v24
    v_exp_f32 v25, v25
    v_pk_mul_f32 v[212:213], v[204:205], v[212:213]
    v_pk_mul_f32 v[214:215], v[206:207], v[214:215]
    v_pk_fma_f32 v[22:23], v[22:23], v[12:13], v[12:13] op_sel:[0,1,1] op_sel_hi:[1,1,1]
    v_pk_fma_f32 v[24:25], v[24:25], v[12:13], v[12:13] op_sel:[0,1,1] op_sel_hi:[1,1,1]
    v_rcp_f32 v22, v22
    v_rcp_f32 v23, v23
    v_rcp_f32 v24, v24
    v_rcp_f32 v25, v25
    v_pk_mul_f32 v[212:213], v[212:213], v[22:23]
    v_pk_mul_f32 v[214:215], v[214:215], v[24:25]
    v_cvt_pk_bf16_f32 v202, v212, v213
    v_cvt_pk_bf16_f32 v203, v214, v215
    s_nop 0
    v_permlane16_swap_b32 v200, v202
    v_permlane16_swap_b32 v201, v203
    buffer_store_dwordx4 v[200:203], v8, s[44:47], s9 offen offset:256 sc1
    v_mov_b32 v22, 0x3f80
    s_waitcnt vmcnt(16)
    v_cndmask_b32 v140, v136, v22, s[66:67]
    v_cndmask_b32 v141, v137, 0, s[66:67]
    v_mov_b32 v142, 0
    v_mov_b32 v143, 0
    v_cndmask_b32 v144, 0, v22, s[66:67]
    v_mov_b32 v145, 0
    v_cndmask_b32 v146, v138, 0, s[66:67]
    v_cndmask_b32 v147, v139, 0, s[66:67]
    s_mov_b32 s70, 0x30800000
    s_mov_b32 s71, 0x53800000
L_stream:
    s_waitcnt lgkmcnt(2)
    v_mfma_f32_32x32x16_bf16 v[32:47], v[216:219], v[128:131], v[112:127]
    ds_read_b128 v[228:231], v2 offset:0
    ds_read_b128 v[236:239], v21 offset:0
    ds_read_b128 v[232:235], v2 offset:18432
    s_waitcnt lgkmcnt(4)
    v_mfma_f32_32x32x16_bf16 v[32:47], v[224:227], v[140:143], v[32:47]
    s_add_u32 s59, s91, 286720
    ds_read_b64_tr_b16 v[80:81], v26 offset:4096
    ds_read_b64_tr_b16 v[82:83], v26 offset:4224
    ds_read_b64_tr_b16 v[84:85], v26 offset:4352
    ds_read_b64_tr_b16 v[86:87], v26 offset:4480
    buffer_load_dwordx4 a[16:19], v11, s[44:47], s59 offen offset:0 sc1
    s_waitcnt vmcnt(16) lgkmcnt(7)
    v_mfma_f32_32x32x16_bf16 v[48:63], v[220:223], v[132:135], v[112:127]
    s_add_u32 s57, s91, 409600
    s_nop 2
    v_exp_f32 v32, v32
    v_exp_f32 v33, v33
    v_exp_f32 v34, v34
    v_exp_f32 v35, v35
    v_exp_f32 v36, v36
    v_mfma_f32_32x32x16_bf16 v[48:63], v[224:227], v[144:147], v[48:63]
    buffer_load_dwordx4 a[20:23], v10, s[44:47], s57 offen offset:0 sc1
    v_exp_f32 v37, v37
    v_exp_f32 v38, v38
    v_exp_f32 v39, v39
    v_exp_f32 v40, v40
    v_exp_f32 v41, v41
    v_exp_f32 v42, v42
    v_exp_f32 v43, v43
    v_exp_f32 v44, v44
    v_cvt_pk_bf16_f32 v64, v32, v33
    v_cvt_pk_bf16_f32 v65, v34, v35
    s_waitcnt lgkmcnt(0)
    ds_read_b64_tr_b16 v[88:89], v27 offset:4096
    ds_read_b64_tr_b16 v[90:91], v27 offset:4224
    ds_read_b64_tr_b16 v[92:93], v27 offset:4352
    ds_read_b64_tr_b16 v[94:95], v27 offset:4480
    v_cvt_pk_bf16_f32 v66, v36, v37
    v_cvt_pk_bf16_f32 v67, v38, v39
    v_exp_f32 v45, v45
    v_exp_f32 v46, v46
    v_exp_f32 v47, v47
    v_cvt_pk_bf16_f32 v68, v40, v41
    v_cvt_pk_bf16_f32 v69, v42, v43
    v_cvt_pk_bf16_f32 v70, v44, v45
    v_cvt_pk_bf16_f32 v71, v46, v47
    v_mfma_f32_32x32x16_bf16 v[32:47], v[228:231], v[128:131], v[96:111]
    buffer_load_dwordx4 a[24:27], v10, s[44:47], s57 offen offset:1024 sc1
    v_exp_f32 v48, v48
    v_exp_f32 v49, v49
    v_exp_f32 v50, v50
    v_exp_f32 v51, v51
    v_exp_f32 v52, v52
    v_mfma_f32_32x32x16_bf16 v[32:47], v[236:239], v[140:143], v[32:47]
    buffer_load_dwordx4 a[28:31], v10, s[44:47], s57 offen offset:2048 sc1
    v_exp_f32 v53, v53
    v_exp_f32 v54, v54
    v_exp_f32 v55, v55
    v_exp_f32 v56, v56
    v_mfma_f32_32x32x16_bf16 v[184:199], v[80:83], v[64:67], 0
    buffer_load_dwordx4 a[32:35], v10, s[44:47], s57 offen offset:3072 sc1
    v_exp_f32 v57, v57
    v_exp_f32 v58, v58
    v_exp_f32 v59, v59
    v_exp_f32 v60, v60
    v_cvt_pk_bf16_f32 v72, v48, v49
    v_cvt_pk_bf16_f32 v73, v50, v51
    v_mfma_f32_32x32x16_bf16 v[184:199], v[84:87], v[68:71], v[184:199]
    s_waitcnt lgkmcnt(0)
    ds_read_b64_tr_b16 v[80:81], v26 offset:0
    ds_read_b64_tr_b16 v[82:83], v26 offset:128
    ds_read_b64_tr_b16 v[84:85], v26 offset:256
    ds_read_b64_tr_b16 v[86:87], v26 offset:384
    s_waitcnt vmcnt(7)
    s_mov_b64 exec, 1
    buffer_store_dword v30, off, s[44:47], s5 sc1
    s_mov_b64 exec, -1
    v_cvt_pk_bf16_f32 v74, v52, v53
    v_cvt_pk_bf16_f32 v75, v54, v55
    v_exp_f32 v61, v61
    v_exp_f32 v62, v62
    v_exp_f32 v63, v63
    v_cvt_pk_bf16_f32 v76, v56, v57
    v_cvt_pk_bf16_f32 v77, v58, v59
    v_cvt_pk_bf16_f32 v78, v60, v61
    v_cvt_pk_bf16_f32 v79, v62, v63
    v_mfma_f32_32x32x16_bf16 v[48:63], v[232:235], v[132:135], v[96:111]
    buffer_load_dwordx4 a[36:39], v11, s[44:47], s57 offen offset:0 sc1
    v_exp_f32 v32, v32
    v_exp_f32 v33, v33
    v_exp_f32 v34, v34
    v_exp_f32 v35, v35
    v_exp_f32 v36, v36
    v_mfma_f32_32x32x16_bf16 v[48:63], v[236:239], v[144:147], v[48:63]
    s_add_u32 s59, s91, 450560
    ds_read_b128 v[216:219], v2 offset:512
    ds_read_b128 v[224:227], v21 offset:512
    ds_read_b128 v[220:223], v2 offset:18944
    buffer_load_dwordx4 a[40:43], v10, s[44:47], s59 offen offset:0 sc1
    v_exp_f32 v37, v37
    v_exp_f32 v38, v38
    v_exp_f32 v39, v39
    v_exp_f32 v40, v40
    v_mfma_f32_32x32x16_bf16 v[200:215], v[88:91], v[72:75], 0
    buffer_load_dwordx4 a[44:47], v10, s[44:47], s59 offen offset:1024 sc1
    v_exp_f32 v41, v41
    v_exp_f32 v42, v42
    v_exp_f32 v43, v43
    v_exp_f32 v44, v44
    v_cvt_pk_bf16_f32 v64, v32, v33
    v_cvt_pk_bf16_f32 v65, v34, v35
    v_mfma_f32_32x32x16_bf16 v[200:215], v[92:95], v[76:79], v[200:215]
    s_waitcnt lgkmcnt(0)
    ds_read_b64_tr_b16 v[88:89], v27 offset:0
    ds_read_b64_tr_b16 v[90:91], v27 offset:128
    ds_read_b64_tr_b16 v[92:93], v27 offset:256
    ds_read_b64_tr_b16 v[94:95], v27 offset:384
    buffer_load_dwordx4 a[48:51], v10, s[44:47], s59 offen offset:2048 sc1
    v_cvt_pk_bf16_f32 v66, v36, v37
    v_cvt_pk_bf16_f32 v67, v38, v39
    v_exp_f32 v45, v45
    v_exp_f32 v46, v46
    v_exp_f32 v47, v47
    v_cvt_pk_bf16_f32 v68, v40, v41
    v_cvt_pk_bf16_f32 v69, v42, v43
    v_cvt_pk_bf16_f32 v70, v44, v45
    v_cvt_pk_bf16_f32 v71, v46, v47
    v_mfma_f32_32x32x16_bf16 v[32:47], v[216:219], v[128:131], 0
    buffer_load_dwordx4 a[52:55], v10, s[44:47], s59 offen offset:3072 sc1
    v_exp_f32 v48, v48
    v_exp_f32 v49, v49
    v_exp_f32 v50, v50
    v_exp_f32 v51, v51
    v_exp_f32 v52, v52
    v_mfma_f32_32x32x16_bf16 v[32:47], v[224:227], v[140:143], v[32:47]
    buffer_load_dwordx4 a[56:59], v11, s[44:47], s59 offen offset:0 sc1
    v_exp_f32 v53, v53
    v_exp_f32 v54, v54
    v_exp_f32 v55, v55
    v_exp_f32 v56, v56
    v_mfma_f32_32x32x16_bf16 v[184:199], v[80:83], v[64:67], v[184:199]
    s_waitcnt vmcnt(12)
    s_mov_b64 exec, 1
    buffer_store_dword v30, off, s[44:47], s6 sc1
    s_mov_b64 exec, -1
    v_exp_f32 v57, v57
    v_exp_f32 v58, v58
    v_exp_f32 v59, v59
    v_exp_f32 v60, v60
    v_cvt_pk_bf16_f32 v72, v48, v49
    v_cvt_pk_bf16_f32 v73, v50, v51
    v_mfma_f32_32x32x16_bf16 v[184:199], v[84:87], v[68:71], v[184:199]
    s_add_u32 s57, s91, 81920
    s_waitcnt lgkmcnt(0)
    ds_read_b64_tr_b16 v[80:81], v26 offset:512
    ds_read_b64_tr_b16 v[82:83], v26 offset:640
    ds_read_b64_tr_b16 v[84:85], v26 offset:768
    ds_read_b64_tr_b16 v[86:87], v26 offset:896
    buffer_load_dwordx4 a[228:231], v10, s[44:47], s57 offen offset:0 sc1
    v_cvt_pk_bf16_f32 v74, v52, v53
    v_cvt_pk_bf16_f32 v75, v54, v55
    v_exp_f32 v61, v61
    v_exp_f32 v62, v62
    v_exp_f32 v63, v63
    v_cvt_pk_bf16_f32 v76, v56, v57
    v_cvt_pk_bf16_f32 v77, v58, v59
    v_cvt_pk_bf16_f32 v78, v60, v61
    v_cvt_pk_bf16_f32 v79, v62, v63
    v_mfma_f32_32x32x16_bf16 v[48:63], v[220:223], v[132:135], 0
    buffer_load_dwordx4 a[232:235], v10, s[44:47], s57 offen offset:1024 sc1
    v_exp_f32 v32, v32
    v_exp_f32 v33, v33
    v_exp_f32 v34, v34
    v_exp_f32 v35, v35
    v_exp_f32 v36, v36
    v_mfma_f32_32x32x16_bf16 v[48:63], v[224:227], v[144:147], v[48:63]
    ds_read_b128 v[228:231], v2 offset:1024
    ds_read_b128 v[236:239], v21 offset:1024
    ds_read_b128 v[232:235], v2 offset:19456
    buffer_load_dwordx4 a[236:239], v10, s[44:47], s57 offen offset:2048 sc1
    v_exp_f32 v37, v37
    v_exp_f32 v38, v38
    v_exp_f32 v39, v39
    v_exp_f32 v40, v40
    v_mfma_f32_32x32x16_bf16 v[200:215], v[88:91], v[72:75], v[200:215]
    buffer_load_dwordx4 a[240:243], v10, s[44:47], s57 offen offset:3072 sc1
    v_exp_f32 v41, v41
    v_exp_f32 v42, v42
    v_exp_f32 v43, v43
    v_exp_f32 v44, v44
    v_cvt_pk_bf16_f32 v64, v32, v33
    v_cvt_pk_bf16_f32 v65, v34, v35
    v_mfma_f32_32x32x16_bf16 v[200:215], v[92:95], v[76:79], v[200:215]
    s_waitcnt lgkmcnt(0)
    ds_read_b64_tr_b16 v[88:89], v27 offset:512
    ds_read_b64_tr_b16 v[90:91], v27 offset:640
    ds_read_b64_tr_b16 v[92:93], v27 offset:768
    ds_read_b64_tr_b16 v[94:95], v27 offset:896
    buffer_load_dwordx4 a[244:247], v11, s[44:47], s57 offen offset:0 sc1
    v_cvt_pk_bf16_f32 v66, v36, v37
    v_cvt_pk_bf16_f32 v67, v38, v39
    v_exp_f32 v45, v45
    v_exp_f32 v46, v46
    v_exp_f32 v47, v47
    v_cvt_pk_bf16_f32 v68, v40, v41
    v_cvt_pk_bf16_f32 v69, v42, v43
    v_cvt_pk_bf16_f32 v70, v44, v45
    v_cvt_pk_bf16_f32 v71, v46, v47
    v_mfma_f32_32x32x16_bf16 v[32:47], v[228:231], v[128:131], 0
    s_add_u32 s59, s91, 122880
    buffer_load_dwordx4 a[60:63], v10, s[44:47], s59 offen offset:0 sc1
    v_exp_f32 v48, v48
    v_exp_f32 v49, v49
    v_exp_f32 v50, v50
    v_exp_f32 v51, v51
    v_exp_f32 v52, v52
    v_mfma_f32_32x32x16_bf16 v[32:47], v[236:239], v[140:143], v[32:47]
    buffer_load_dwordx4 a[64:67], v10, s[44:47], s59 offen offset:1024 sc1
    v_exp_f32 v53, v53
    v_exp_f32 v54, v54
    v_exp_f32 v55, v55
    v_exp_f32 v56, v56
    v_mfma_f32_32x32x16_bf16 v[184:199], v[80:83], v[64:67], v[184:199]
    buffer_load_dwordx4 a[68:71], v10, s[44:47], s59 offen offset:2048 sc1
    v_exp_f32 v57, v57
    v_exp_f32 v58, v58
    v_exp_f32 v59, v59
    v_exp_f32 v60, v60
    v_cvt_pk_bf16_f32 v72, v48, v49
    v_cvt_pk_bf16_f32 v73, v50, v51
    v_mfma_f32_32x32x16_bf16 v[184:199], v[84:87], v[68:71], v[184:199]
    s_waitcnt lgkmcnt(0)
    ds_read_b64_tr_b16 v[80:81], v26 offset:1024
    ds_read_b64_tr_b16 v[82:83], v26 offset:1152
    ds_read_b64_tr_b16 v[84:85], v26 offset:1280
    ds_read_b64_tr_b16 v[86:87], v26 offset:1408
    buffer_load_dwordx4 a[72:75], v10, s[44:47], s59 offen offset:3072 sc1
    v_cvt_pk_bf16_f32 v74, v52, v53
    v_cvt_pk_bf16_f32 v75, v54, v55
    v_exp_f32 v61, v61
    v_exp_f32 v62, v62
    v_exp_f32 v63, v63
    v_cvt_pk_bf16_f32 v76, v56, v57
    v_cvt_pk_bf16_f32 v77, v58, v59
    v_cvt_pk_bf16_f32 v78, v60, v61
    v_cvt_pk_bf16_f32 v79, v62, v63
    v_mfma_f32_32x32x16_bf16 v[48:63], v[232:235], v[132:135], 0
    buffer_load_dwordx4 a[76:79], v11, s[44:47], s59 offen offset:0 sc1
    v_exp_f32 v32, v32
    v_exp_f32 v33, v33
    v_exp_f32 v34, v34
    v_exp_f32 v35, v35
    v_exp_f32 v36, v36
    v_mfma_f32_32x32x16_bf16 v[48:63], v[236:239], v[144:147], v[48:63]
    s_add_u32 s57, s91, 327680
    ds_read_b128 v[216:219], v2 offset:1536
    ds_read_b128 v[224:227], v21 offset:1536
    ds_read_b128 v[220:223], v2 offset:19968
    buffer_load_dwordx4 a[80:83], v10, s[44:47], s57 offen offset:0 sc1
    v_exp_f32 v37, v37
    v_exp_f32 v38, v38
    v_exp_f32 v39, v39
    v_exp_f32 v40, v40
    v_mfma_f32_32x32x16_bf16 v[200:215], v[88:91], v[72:75], v[200:215]
    buffer_load_dwordx4 a[84:87], v10, s[44:47], s57 offen offset:1024 sc1
    v_exp_f32 v41, v41
    v_exp_f32 v42, v42
    v_exp_f32 v43, v43
    v_exp_f32 v44, v44
    v_cvt_pk_bf16_f32 v64, v32, v33
    v_cvt_pk_bf16_f32 v65, v34, v35
    v_mfma_f32_32x32x16_bf16 v[200:215], v[92:95], v[76:79], v[200:215]
    s_waitcnt lgkmcnt(0)
    ds_read_b64_tr_b16 v[88:89], v27 offset:1024
    ds_read_b64_tr_b16 v[90:91], v27 offset:1152
    ds_read_b64_tr_b16 v[92:93], v27 offset:1280
    ds_read_b64_tr_b16 v[94:95], v27 offset:1408
    buffer_load_dwordx4 a[88:91], v10, s[44:47], s57 offen offset:2048 sc1
    v_cvt_pk_bf16_f32 v66, v36, v37
    v_cvt_pk_bf16_f32 v67, v38, v39
    v_exp_f32 v45, v45
    v_exp_f32 v46, v46
    v_exp_f32 v47, v47
    v_cvt_pk_bf16_f32 v68, v40, v41
    v_cvt_pk_bf16_f32 v69, v42, v43
    v_cvt_pk_bf16_f32 v70, v44, v45
    v_cvt_pk_bf16_f32 v71, v46, v47
    v_mfma_f32_32x32x16_bf16 v[32:47], v[216:219], v[128:131], 0
    buffer_load_dwordx4 a[92:95], v10, s[44:47], s57 offen offset:3072 sc1
    v_exp_f32 v48, v48
    v_exp_f32 v49, v49
    v_exp_f32 v50, v50
    v_exp_f32 v51, v51
    v_exp_f32 v52, v52
    v_mfma_f32_32x32x16_bf16 v[32:47], v[224:227], v[140:143], v[32:47]
    buffer_load_dwordx4 a[96:99], v11, s[44:47], s57 offen offset:0 sc1
    v_exp_f32 v53, v53
    v_exp_f32 v54, v54
    v_exp_f32 v55, v55
    v_exp_f32 v56, v56
    v_mfma_f32_32x32x16_bf16 v[184:199], v[80:83], v[64:67], v[184:199]
    s_add_u32 s59, s91, 368640
    buffer_load_dwordx4 a[100:103], v10, s[44:47], s59 offen offset:0 sc1
    v_exp_f32 v57, v57
    v_exp_f32 v58, v58
    v_exp_f32 v59, v59
    v_exp_f32 v60, v60
    v_cvt_pk_bf16_f32 v72, v48, v49
    v_cvt_pk_bf16_f32 v73, v50, v51
    v_mfma_f32_32x32x16_bf16 v[184:199], v[84:87], v[68:71], v[184:199]
    s_waitcnt lgkmcnt(0)
    ds_read_b64_tr_b16 v[80:81], v26 offset:1536
    ds_read_b64_tr_b16 v[82:83], v26 offset:1664
    ds_read_b64_tr_b16 v[84:85], v26 offset:1792
    ds_read_b64_tr_b16 v[86:87], v26 offset:1920
    buffer_load_dword v19, v9, s[44:47], s11 offen sc1
    v_cvt_pk_bf16_f32 v74, v52, v53
    v_cvt_pk_bf16_f32 v75, v54, v55
    v_exp_f32 v61, v61
    v_exp_f32 v62, v62
    v_exp_f32 v63, v63
    v_cvt_pk_bf16_f32 v76, v56, v57
    v_cvt_pk_bf16_f32 v77, v58, v59
    v_cvt_pk_bf16_f32 v78, v60, v61
    v_cvt_pk_bf16_f32 v79, v62, v63
    v_mfma_f32_32x32x16_bf16 v[48:63], v[220:223], v[132:135], 0
    buffer_load_dwordx4 a[104:107], v10, s[44:47], s59 offen offset:1024 sc1
    v_exp_f32 v32, v32
    v_exp_f32 v33, v33
    v_exp_f32 v34, v34
    v_exp_f32 v35, v35
    v_exp_f32 v36, v36
    v_mfma_f32_32x32x16_bf16 v[48:63], v[224:227], v[144:147], v[48:63]
    ds_read_b128 v[228:231], v2 offset:2048
    ds_read_b128 v[236:239], v21 offset:2048
    ds_read_b128 v[232:235], v2 offset:20480
    buffer_load_dwordx4 a[108:111], v10, s[44:47], s59 offen offset:2048 sc1
    v_exp_f32 v37, v37
    v_exp_f32 v38, v38
    v_exp_f32 v39, v39
    v_exp_f32 v40, v40
    v_mfma_f32_32x32x16_bf16 v[200:215], v[88:91], v[72:75], v[200:215]
    buffer_load_dwordx4 a[112:115], v10, s[44:47], s59 offen offset:3072 sc1
    v_exp_f32 v41, v41
    v_exp_f32 v42, v42
    v_exp_f32 v43, v43
    v_exp_f32 v44, v44
    v_cvt_pk_bf16_f32 v64, v32, v33
    v_cvt_pk_bf16_f32 v65, v34, v35
    v_mfma_f32_32x32x16_bf16 v[200:215], v[92:95], v[76:79], v[200:215]
    s_waitcnt lgkmcnt(0)
    ds_read_b64_tr_b16 v[88:89], v27 offset:1536
    ds_read_b64_tr_b16 v[90:91], v27 offset:1664
    ds_read_b64_tr_b16 v[92:93], v27 offset:1792
    ds_read_b64_tr_b16 v[94:95], v27 offset:1920
    buffer_load_dwordx4 a[116:119], v11, s[44:47], s59 offen offset:0 sc1
    v_cvt_pk_bf16_f32 v66, v36, v37
    v_cvt_pk_bf16_f32 v67, v38, v39
    v_exp_f32 v45, v45
    v_exp_f32 v46, v46
    v_exp_f32 v47, v47
    v_cvt_pk_bf16_f32 v68, v40, v41
    v_cvt_pk_bf16_f32 v69, v42, v43
    v_cvt_pk_bf16_f32 v70, v44, v45
    v_cvt_pk_bf16_f32 v71, v46, v47
    v_mfma_f32_32x32x16_bf16 v[32:47], v[228:231], v[128:131], 0
    v_exp_f32 v48, v48
    v_exp_f32 v49, v49
    v_exp_f32 v50, v50
    v_exp_f32 v51, v51
    v_exp_f32 v52, v52
    v_mfma_f32_32x32x16_bf16 v[32:47], v[236:239], v[140:143], v[32:47]
    v_exp_f32 v53, v53
    v_exp_f32 v54, v54
    v_exp_f32 v55, v55
    v_exp_f32 v56, v56
    v_mfma_f32_32x32x16_bf16 v[184:199], v[80:83], v[64:67], v[184:199]
    v_exp_f32 v57, v57
    v_exp_f32 v58, v58
    v_exp_f32 v59, v59
    v_exp_f32 v60, v60
    v_cvt_pk_bf16_f32 v72, v48, v49
    v_cvt_pk_bf16_f32 v73, v50, v51
    v_mfma_f32_32x32x16_bf16 v[184:199], v[84:87], v[68:71], v[184:199]
    s_waitcnt lgkmcnt(0)
    ds_read_b64_tr_b16 v[80:81], v26 offset:2048
    ds_read_b64_tr_b16 v[82:83], v26 offset:2176
    ds_read_b64_tr_b16 v[84:85], v26 offset:2304
    ds_read_b64_tr_b16 v[86:87], v26 offset:2432
    v_cvt_pk_bf16_f32 v74, v52, v53
    v_cvt_pk_bf16_f32 v75, v54, v55
    v_exp_f32 v61, v61
    v_exp_f32 v62, v62
    v_exp_f32 v63, v63
    v_cvt_pk_bf16_f32 v76, v56, v57
    v_cvt_pk_bf16_f32 v77, v58, v59
    v_cvt_pk_bf16_f32 v78, v60, v61
    v_cvt_pk_bf16_f32 v79, v62, v63
    v_mfma_f32_32x32x16_bf16 v[48:63], v[232:235], v[132:135], 0
    v_exp_f32 v32, v32
    v_exp_f32 v33, v33
    v_exp_f32 v34, v34
    v_exp_f32 v35, v35
    v_exp_f32 v36, v36
    v_mfma_f32_32x32x16_bf16 v[48:63], v[236:239], v[144:147], v[48:63]
    ds_read_b128 v[216:219], v2 offset:2560
    ds_read_b128 v[224:227], v21 offset:2560
    ds_read_b128 v[220:223], v2 offset:20992
    v_exp_f32 v37, v37
    v_exp_f32 v38, v38
    v_exp_f32 v39, v39
    v_exp_f32 v40, v40
    v_mfma_f32_32x32x16_bf16 v[200:215], v[88:91], v[72:75], v[200:215]
    v_exp_f32 v41, v41
    v_exp_f32 v42, v42
    v_exp_f32 v43, v43
    v_exp_f32 v44, v44
    v_cvt_pk_bf16_f32 v64, v32, v33
    v_cvt_pk_bf16_f32 v65, v34, v35
    v_mfma_f32_32x32x16_bf16 v[200:215], v[92:95], v[76:79], v[200:215]
    s_waitcnt lgkmcnt(0)
    ds_read_b64_tr_b16 v[88:89], v27 offset:2048
    ds_read_b64_tr_b16 v[90:91], v27 offset:2176
    ds_read_b64_tr_b16 v[92:93], v27 offset:2304
    ds_read_b64_tr_b16 v[94:95], v27 offset:2432
    v_cvt_pk_bf16_f32 v66, v36, v37
    v_cvt_pk_bf16_f32 v67, v38, v39
    v_exp_f32 v45, v45
    v_exp_f32 v46, v46
    v_exp_f32 v47, v47
    v_cvt_pk_bf16_f32 v68, v40, v41
    v_cvt_pk_bf16_f32 v69, v42, v43
    v_cvt_pk_bf16_f32 v70, v44, v45
    v_cvt_pk_bf16_f32 v71, v46, v47
    v_mfma_f32_32x32x16_bf16 v[32:47], v[216:219], v[128:131], 0
    v_exp_f32 v48, v48
    v_exp_f32 v49, v49
    v_exp_f32 v50, v50
    v_exp_f32 v51, v51
    v_exp_f32 v52, v52
    v_mfma_f32_32x32x16_bf16 v[32:47], v[224:227], v[140:143], v[32:47]
    v_exp_f32 v53, v53
    v_exp_f32 v54, v54
    v_exp_f32 v55, v55
    v_exp_f32 v56, v56
    v_mfma_f32_32x32x16_bf16 v[184:199], v[80:83], v[64:67], v[184:199]
    v_exp_f32 v57, v57
    v_exp_f32 v58, v58
    v_exp_f32 v59, v59
    v_exp_f32 v60, v60
    v_cvt_pk_bf16_f32 v72, v48, v49
    v_cvt_pk_bf16_f32 v73, v50, v51
    v_mfma_f32_32x32x16_bf16 v[184:199], v[84:87], v[68:71], v[184:199]
    s_waitcnt lgkmcnt(0)
    ds_read_b64_tr_b16 v[80:81], v26 offset:2560
    ds_read_b64_tr_b16 v[82:83], v26 offset:2688
    ds_read_b64_tr_b16 v[84:85], v26 offset:2816
    ds_read_b64_tr_b16 v[86:87], v26 offset:2944
    v_cvt_pk_bf16_f32 v74, v52, v53
    v_cvt_pk_bf16_f32 v75, v54, v55
    v_exp_f32 v61, v61
    v_exp_f32 v62, v62
    v_exp_f32 v63, v63
    v_cvt_pk_bf16_f32 v76, v56, v57
    v_cvt_pk_bf16_f32 v77, v58, v59
    v_cvt_pk_bf16_f32 v78, v60, v61
    v_cvt_pk_bf16_f32 v79, v62, v63
    v_mfma_f32_32x32x16_bf16 v[48:63], v[220:223], v[132:135], 0
    v_exp_f32 v32, v32
    v_exp_f32 v33, v33
    v_exp_f32 v34, v34
    v_exp_f32 v35, v35
    v_exp_f32 v36, v36
    s_waitcnt vmcnt(4)
    v_cmp_ne_u32 vcc, 1, v19
    s_nop 1
    s_cbranch_vccnz L_retry3
L_cont3:
    v_mfma_f32_32x32x16_bf16 v[48:63], v[224:227], v[144:147], v[48:63]
    ds_read_b128 v[228:231], v2 offset:3072
    ds_read_b128 v[236:239], v21 offset:3072
    ds_read_b128 v[232:235], v2 offset:21504
    buffer_load_dword v19, v9, s[44:47], s12 offen sc1
    v_exp_f32 v37, v37
    v_exp_f32 v38, v38
    v_exp_f32 v39, v39
    v_exp_f32 v40, v40
    v_mfma_f32_32x32x16_bf16 v[200:215], v[88:91], v[72:75], v[200:215]
    s_add_u32 s64, s89, 0
    buffer_load_dwordx4 v[148:151], v14, s[44:47], s64 offen sc1
    v_exp_f32 v41, v41
    v_exp_f32 v42, v42
    v_exp_f32 v43, v43
    v_exp_f32 v44, v44
    v_cvt_pk_bf16_f32 v64, v32, v33
    v_cvt_pk_bf16_f32 v65, v34, v35
    v_mfma_f32_32x32x16_bf16 v[200:215], v[92:95], v[76:79], v[200:215]
    s_waitcnt lgkmcnt(0)
    ds_read_b64_tr_b16 v[88:89], v27 offset:2560
    ds_read_b64_tr_b16 v[90:91], v27 offset:2688
    ds_read_b64_tr_b16 v[92:93], v27 offset:2816
    ds_read_b64_tr_b16 v[94:95], v27 offset:2944
    buffer_load_dwordx4 v[152:155], v15, s[44:47], s64 offen sc1
    v_cvt_pk_bf16_f32 v66, v36, v37
    v_cvt_pk_bf16_f32 v67, v38, v39
    v_exp_f32 v45, v45
    v_exp_f32 v46, v46
    v_exp_f32 v47, v47
    v_cvt_pk_bf16_f32 v68, v40, v41
    v_cvt_pk_bf16_f32 v69, v42, v43
    v_cvt_pk_bf16_f32 v70, v44, v45
    v_cvt_pk_bf16_f32 v71, v46, v47
    v_mfma_f32_32x32x16_bf16 v[32:47], v[228:231], v[128:131], 0
    buffer_load_dwordx4 v[156:159], v16, s[44:47], s64 offen sc1
    v_exp_f32 v48, v48
    v_exp_f32 v49, v49
    v_exp_f32 v50, v50
    v_exp_f32 v51, v51
    v_exp_f32 v52, v52
    v_mfma_f32_32x32x16_bf16 v[32:47], v[236:239], v[140:143], v[32:47]
    buffer_load_dwordx4 v[160:163], v17, s[44:47], s64 offen sc1
    v_exp_f32 v53, v53
    v_exp_f32 v54, v54
    v_exp_f32 v55, v55
    v_exp_f32 v56, v56
    v_mfma_f32_32x32x16_bf16 v[184:199], v[80:83], v[64:67], v[184:199]
    s_add_u32 s58, s89, 4096
    buffer_load_dwordx4 v[164:167], v14, s[44:47], s58 offen sc1
    v_exp_f32 v57, v57
    v_exp_f32 v58, v58
    v_exp_f32 v59, v59
    v_exp_f32 v60, v60
    v_cvt_pk_bf16_f32 v72, v48, v49
    v_cvt_pk_bf16_f32 v73, v50, v51
    v_mfma_f32_32x32x16_bf16 v[184:199], v[84:87], v[68:71], v[184:199]
    s_waitcnt lgkmcnt(0)
    ds_read_b64_tr_b16 v[80:81], v26 offset:3072
    ds_read_b64_tr_b16 v[82:83], v26 offset:3200
    ds_read_b64_tr_b16 v[84:85], v26 offset:3328
    ds_read_b64_tr_b16 v[86:87], v26 offset:3456
    buffer_load_dwordx4 v[168:171], v15, s[44:47], s58 offen sc1
    v_cvt_pk_bf16_f32 v74, v52, v53
    v_cvt_pk_bf16_f32 v75, v54, v55
    v_exp_f32 v61, v61
    v_exp_f32 v62, v62
    v_exp_f32 v63, v63
    v_cvt_pk_bf16_f32 v76, v56, v57
    v_cvt_pk_bf16_f32 v77, v58, v59
    v_cvt_pk_bf16_f32 v78, v60, v61
    v_cvt_pk_bf16_f32 v79, v62, v63
    v_mfma_f32_32x32x16_bf16 v[48:63], v[232:235], v[132:135], 0
    buffer_load_dwordx4 v[172:175], v16, s[44:47], s58 offen sc1
    v_exp_f32 v32, v32
    v_exp_f32 v33, v33
    v_exp_f32 v34, v34
    v_exp_f32 v35, v35
    v_exp_f32 v36, v36
    v_mfma_f32_32x32x16_bf16 v[48:63], v[236:239], v[144:147], v[48:63]
L_page6:
    s_cbranch_execz L_tret1
    ds_read_b128 v[216:219], v2 offset:3584
    ds_read_b128 v[224:227], v21 offset:3584
    ds_read_b128 v[220:223], v2 offset:22016
    buffer_load_dwordx4 v[176:179], v17, s[44:47], s58 offen sc1
    v_exp_f32 v37, v37
    v_exp_f32 v38, v38
    v_exp_f32 v39, v39
    v_exp_f32 v40, v40
    v_mfma_f32_32x32x16_bf16 v[200:215], v[88:91], v[72:75], v[200:215]
    s_add_u32 s64, s89, 16384
    buffer_load_dwordx4 v[240:243], v14, s[44:47], s64 offen sc1
    v_exp_f32 v41, v41
    v_exp_f32 v42, v42
    v_exp_f32 v43, v43
    v_exp_f32 v44, v44
    v_cvt_pk_bf16_f32 v64, v32, v33
    v_cvt_pk_bf16_f32 v65, v34, v35
    v_mfma_f32_32x32x16_bf16 v[200:215], v[92:95], v[76:79], v[200:215]
    s_waitcnt lgkmcnt(0)
    ds_read_b64_tr_b16 v[88:89], v27 offset:3072
    ds_read_b64_tr_b16 v[90:91], v27 offset:3200
    ds_read_b64_tr_b16 v[92:93], v27 offset:3328
    ds_read_b64_tr_b16 v[94:95], v27 offset:3456
    buffer_load_dwordx4 v[244:247], v15, s[44:47], s64 offen sc1
    v_cvt_pk_bf16_f32 v66, v36, v37
    v_cvt_pk_bf16_f32 v67, v38, v39
    v_exp_f32 v45, v45
    v_exp_f32 v46, v46
    v_exp_f32 v47, v47
    v_cvt_pk_bf16_f32 v68, v40, v41
    v_cvt_pk_bf16_f32 v69, v42, v43
    v_cvt_pk_bf16_f32 v70, v44, v45
    v_cvt_pk_bf16_f32 v71, v46, v47
    v_mfma_f32_32x32x16_bf16 v[32:47], v[216:219], v[128:131], 0
    buffer_load_dwordx4 v[248:251], v16, s[44:47], s64 offen sc1
    v_exp_f32 v48, v48
    v_exp_f32 v49, v49
    v_exp_f32 v50, v50
    v_exp_f32 v51, v51
    v_exp_f32 v52, v52
    v_mfma_f32_32x32x16_bf16 v[32:47], v[224:227], v[140:143], v[32:47]
    buffer_load_dwordx4 v[252:255], v17, s[44:47], s64 offen sc1
    v_exp_f32 v53, v53
    v_exp_f32 v54, v54
    v_exp_f32 v55, v55
    v_exp_f32 v56, v56
    v_mfma_f32_32x32x16_bf16 v[184:199], v[80:83], v[64:67], v[184:199]
    s_add_u32 s58, s89, 20480
    buffer_load_dwordx4 v[112:115], v14, s[44:47], s58 offen sc1
    v_exp_f32 v57, v57
    v_exp_f32 v58, v58
    v_exp_f32 v59, v59
    v_exp_f32 v60, v60
    v_cvt_pk_bf16_f32 v72, v48, v49
    v_cvt_pk_bf16_f32 v73, v50, v51
    v_mfma_f32_32x32x16_bf16 v[184:199], v[84:87], v[68:71], v[184:199]
    s_waitcnt lgkmcnt(0)
    ds_read_b64_tr_b16 v[80:81], v26 offset:3584
    ds_read_b64_tr_b16 v[82:83], v26 offset:3712
    ds_read_b64_tr_b16 v[84:85], v26 offset:3840
    ds_read_b64_tr_b16 v[86:87], v26 offset:3968
    buffer_load_dwordx4 v[116:119], v15, s[44:47], s58 offen sc1
    v_cvt_pk_bf16_f32 v74, v52, v53
    v_cvt_pk_bf16_f32 v75, v54, v55
    v_exp_f32 v61, v61
    v_exp_f32 v62, v62
    v_exp_f32 v63, v63
    v_cvt_pk_bf16_f32 v76, v56, v57
    v_cvt_pk_bf16_f32 v77, v58, v59
    v_cvt_pk_bf16_f32 v78, v60, v61
    v_cvt_pk_bf16_f32 v79, v62, v63
    v_mfma_f32_32x32x16_bf16 v[48:63], v[220:223], v[132:135], 0
    buffer_load_dwordx4 v[120:123], v16, s[44:47], s58 offen sc1
    v_exp_f32 v32, v32
    v_exp_f32 v33, v33
    v_exp_f32 v34, v34
    v_exp_f32 v35, v35
    v_exp_f32 v36, v36
    v_mfma_f32_32x32x16_bf16 v[48:63], v[224:227], v[144:147], v[48:63]
    buffer_load_dwordx4 v[124:127], v17, s[44:47], s58 offen sc1
    v_exp_f32 v37, v37
    v_exp_f32 v38, v38
    v_exp_f32 v39, v39
    v_exp_f32 v40, v40
    s_waitcnt vmcnt(16)
    v_cmp_ne_u32 vcc, 1, v19
    s_nop 1
    s_cbranch_vccnz L_retry4
L_cont4:
    v_mfma_f32_32x32x16_bf16 v[200:215], v[88:91], v[72:75], v[200:215]
    s_add_u32 s64, s89, 24576
    buffer_load_dwordx4 v[96:99], v14, s[44:47], s64 offen sc1
    v_exp_f32 v41, v41
    v_exp_f32 v42, v42
    v_exp_f32 v43, v43
    v_exp_f32 v44, v44
    v_cvt_pk_bf16_f32 v64, v32, v33
    v_cvt_pk_bf16_f32 v65, v34, v35
    v_mfma_f32_32x32x16_bf16 v[200:215], v[92:95], v[76:79], v[200:215]
    ds_read_b64_tr_b16 v[88:89], v27 offset:3584
    ds_read_b64_tr_b16 v[90:91], v27 offset:3712
    ds_read_b64_tr_b16 v[92:93], v27 offset:3840
    ds_read_b64_tr_b16 v[94:95], v27 offset:3968
    buffer_load_dwordx4 v[100:103], v15, s[44:47], s64 offen sc1
    v_cvt_pk_bf16_f32 v66, v36, v37
    v_cvt_pk_bf16_f32 v67, v38, v39
    v_exp_f32 v45, v45
    v_exp_f32 v46, v46
    v_exp_f32 v47, v47
    v_cvt_pk_bf16_f32 v68, v40, v41
    v_cvt_pk_bf16_f32 v69, v42, v43
    v_cvt_pk_bf16_f32 v70, v44, v45
    v_cvt_pk_bf16_f32 v71, v46, v47
    v_exp_f32 v48, v48
    v_exp_f32 v49, v49
    v_exp_f32 v50, v50
    v_exp_f32 v51, v51
    v_exp_f32 v52, v52
    v_exp_f32 v53, v53
    v_exp_f32 v54, v54
    v_exp_f32 v55, v55
    v_exp_f32 v56, v56
    s_waitcnt lgkmcnt(6)
    v_mfma_f32_32x32x16_bf16 v[184:199], v[80:83], v[64:67], v[184:199]
    buffer_load_dwordx4 v[104:107], v16, s[44:47], s64 offen sc1
    v_exp_f32 v57, v57
    v_exp_f32 v58, v58
    v_exp_f32 v59, v59
    v_exp_f32 v60, v60
    v_cvt_pk_bf16_f32 v72, v48, v49
    v_cvt_pk_bf16_f32 v73, v50, v51
    s_waitcnt lgkmcnt(4)
    v_mfma_f32_32x32x16_bf16 v[184:199], v[84:87], v[68:71], v[184:199]
    buffer_load_dwordx4 v[108:111], v17, s[44:47], s64 offen sc1
    v_cvt_pk_bf16_f32 v74, v52, v53
    v_cvt_pk_bf16_f32 v75, v54, v55
    v_exp_f32 v61, v61
    v_exp_f32 v62, v62
    v_exp_f32 v63, v63
    v_cvt_pk_bf16_f32 v76, v56, v57
    v_cvt_pk_bf16_f32 v77, v58, v59
    v_cvt_pk_bf16_f32 v78, v60, v61
    v_cvt_pk_bf16_f32 v79, v62, v63
    s_waitcnt lgkmcnt(2)
    v_mfma_f32_32x32x16_bf16 v[200:215], v[88:91], v[72:75], v[200:215]
    s_add_u32 s58, s89, 28672
    buffer_load_dwordx4 a[248:251], v14, s[44:47], s58 offen sc1
    v_rcp_f32 v22, v197
    s_nop 0
    v_mul_f32 v184, v184, v22
    v_mul_f32 v185, v185, v22
    v_mul_f32 v186, v186, v22
    v_mul_f32 v187, v187, v22
    s_waitcnt lgkmcnt(0)
    v_mfma_f32_32x32x16_bf16 v[200:215], v[92:95], v[76:79], v[200:215]
    buffer_load_dwordx4 a[252:255], v15, s[44:47], s58 offen sc1
    v_mul_f32 v188, v188, v22
    v_mul_f32 v189, v189, v22
    v_mul_f32 v190, v190, v22
    v_mul_f32 v191, v191, v22
    v_mul_f32 v192, v192, v22
    v_mul_f32 v193, v193, v22
    v_mul_f32 v194, v194, v22
    v_mul_f32 v195, v195, v22
    v_cvt_pk_bf16_f32 v184, v184, v185
    v_cvt_pk_bf16_f32 v185, v186, v187
    v_cvt_pk_bf16_f32 v186, v188, v189
    v_cvt_pk_bf16_f32 v187, v190, v191
    v_cvt_pk_bf16_f32 v180, v192, v193
    v_cvt_pk_bf16_f32 v181, v194, v195
    v_min_f32 v3, v197, v213
    v_add_f32 v4, v197, v213
    v_cmp_ngt_f32 s[68:69], v3, s70
    v_cmp_ngt_f32 vcc, s71, v4
    s_nop 1
    s_or_b64 vcc, vcc, s[68:69]
    s_cbranch_vccnz L_redo
L_ok:
    buffer_store_dwordx4 v[184:187], v5, s[44:47], s10 offen sc1
    v_rcp_f32 v23, v213
    s_nop 0
    v_mul_f32 v200, v200, v23
    v_mul_f32 v201, v201, v23
    v_mul_f32 v202, v202, v23
    v_mul_f32 v203, v203, v23
    v_mul_f32 v204, v204, v23
    v_mul_f32 v205, v205, v23
    v_mul_f32 v206, v206, v23
    v_mul_f32 v207, v207, v23
    v_mul_f32 v208, v208, v23
    v_mul_f32 v209, v209, v23
    v_mul_f32 v210, v210, v23
    v_mul_f32 v211, v211, v23
    v_cvt_pk_bf16_f32 v200, v200, v201
    v_cvt_pk_bf16_f32 v201, v202, v203
    v_cvt_pk_bf16_f32 v202, v204, v205
    v_cvt_pk_bf16_f32 v203, v206, v207
    v_cvt_pk_bf16_f32 v182, v208, v209
    v_cvt_pk_bf16_f32 v183, v210, v211
    buffer_store_dwordx4 v[200:203], v5, s[44:47], s10 offen offset:3072 sc1
    s_mov_b32 exec_hi, 0
    buffer_store_dwordx4 v[180:183], v5, s[44:47], s10 offen offset:2048 sc1
    s_mov_b32 exec_hi, -1
    s_waitcnt vmcnt(24)
    v_mfma_f32_16x16x32_bf16 v[32:35], a[128:131], v[148:151], 0
    s_waitcnt vmcnt(23)
    v_mfma_f32_16x16x32_bf16 v[36:39], a[128:131], v[152:155], 0
    v_add_u32 v5, s17, v10
    v_add_u32 v6, s18, v10
    s_waitcnt vmcnt(22)
    v_mfma_f32_16x16x32_bf16 v[40:43], a[128:131], v[156:159], 0
    v_add_u32 v7, s19, v10
    v_add_u32 v20, s20, v10
    s_waitcnt vmcnt(21)
    v_mfma_f32_16x16x32_bf16 v[44:47], a[128:131], v[160:163], 0
    v_add_u32 v22, 0, v1
    v_mul_u32_u24 v23, 205, v22
    v_mfma_f32_16x16x32_bf16 v[48:51], a[132:135], v[148:151], 0
    v_lshrrev_b32 v23, 11, v23
    v_add_u32 v24, v22, v23
    v_mfma_f32_16x16x32_bf16 v[52:55], a[132:135], v[152:155], 0
    buffer_load_dwordx4 a[120:123], v16, s[44:47], s58 offen sc1
    v_mfma_f32_16x16x32_bf16 v[56:59], a[132:135], v[156:159], 0
    v_lshl_add_u32 v28, v24, 4, s75
    v_mul_u32_u24 v23, 1120, v23
    v_mfma_f32_16x16x32_bf16 v[60:63], a[132:135], v[160:163], 0
    v_lshl_add_u32 v2, v22, 4, v23
    v_add_u32 v22, 64, v1
    v_mfma_f32_16x16x32_bf16 v[64:67], a[136:139], v[148:151], 0
    v_mul_u32_u24 v23, 205, v22
    v_lshrrev_b32 v23, 11, v23
    v_mfma_f32_16x16x32_bf16 v[68:71], a[136:139], v[152:155], 0
    v_add_u32 v24, v22, v23
    v_lshl_add_u32 v29, v24, 4, s75
    v_mfma_f32_16x16x32_bf16 v[72:75], a[136:139], v[156:159], 0
    buffer_load_dwordx4 a[124:127], v17, s[44:47], s58 offen sc1
    v_mfma_f32_16x16x32_bf16 v[76:79], a[136:139], v[160:163], 0
    v_mul_u32_u24 v23, 1120, v23
    v_lshl_add_u32 v21, v22, 4, v23
    v_mfma_f32_16x16x32_bf16 v[80:83], a[140:143], v[148:151], 0
    v_add_u32 v22, 128, v1
    v_mul_u32_u24 v23, 205, v22
    v_mfma_f32_16x16x32_bf16 v[84:87], a[140:143], v[152:155], 0
    v_lshrrev_b32 v23, 11, v23
    v_add_u32 v24, v22, v23
    v_mfma_f32_16x16x32_bf16 v[88:91], a[140:143], v[156:159], 0
    s_add_u32 s64, s89, 40960
    v_lshl_add_u32 v12, v24, 4, s75
    v_mul_u32_u24 v23, 1120, v23
    v_mfma_f32_16x16x32_bf16 v[92:95], a[140:143], v[160:163], 0
    buffer_load_dwordx4 v[128:131], v14, s[44:47], s64 offen sc1
    v_mfma_f32_16x16x32_bf16 v[216:219], a[144:147], v[148:151], 0
    v_lshl_add_u32 v26, v22, 4, v23
    v_mov_b32 v22, 2146435072
    v_mfma_f32_16x16x32_bf16 v[220:223], a[144:147], v[152:155], 0
    v_cndmask_b32 v26, v26, v22, s[66:67]
    v_and_b32 v24, 15, v1
    v_mfma_f32_16x16x32_bf16 v[224:227], a[144:147], v[156:159], 0
    v_lshrrev_b32 v23, 4, v1
    v_mul_u32_u24 v22, 160, v24
    v_mfma_f32_16x16x32_bf16 v[228:231], a[144:147], v[160:163], 0
    buffer_load_dwordx4 v[132:135], v15, s[44:47], s64 offen sc1
    s_waitcnt vmcnt(24)
    v_mfma_f32_16x16x32_bf16 v[32:35], a[148:151], v[164:167], v[32:35]
    v_lshl_add_u32 v22, v23, 3, v22
    v_add_u32 v27, s75, v22
    s_waitcnt vmcnt(23)
    v_mfma_f32_16x16x32_bf16 v[36:39], a[148:151], v[168:171], v[36:39]
    v_lshl_add_u32 v8, v24, 4, v27
    s_waitcnt vmcnt(22)
    v_mfma_f32_16x16x32_bf16 v[40:43], a[148:151], v[172:175], v[40:43]
    s_waitcnt vmcnt(21)
    v_mfma_f32_16x16x32_bf16 v[44:47], a[148:151], v[176:179], v[44:47]
    v_mfma_f32_16x16x32_bf16 v[48:51], a[152:155], v[164:167], v[48:51]
    buffer_load_dwordx4 v[136:139], v16, s[44:47], s64 offen sc1
    v_mfma_f32_16x16x32_bf16 v[52:55], a[152:155], v[168:171], v[52:55]
    v_mfma_f32_16x16x32_bf16 v[56:59], a[152:155], v[172:175], v[56:59]
    v_mfma_f32_16x16x32_bf16 v[60:63], a[152:155], v[176:179], v[60:63]
    v_mfma_f32_16x16x32_bf16 v[64:67], a[156:159], v[164:167], v[64:67]
    buffer_load_dwordx4 v[140:143], v17, s[44:47], s64 offen sc1
    v_mfma_f32_16x16x32_bf16 v[68:71], a[156:159], v[168:171], v[68:71]
    v_mfma_f32_16x16x32_bf16 v[72:75], a[156:159], v[172:175], v[72:75]
    v_mfma_f32_16x16x32_bf16 v[76:79], a[156:159], v[176:179], v[76:79]
    v_mfma_f32_16x16x32_bf16 v[80:83], a[160:163], v[164:167], v[80:83]
    s_add_u32 s58, s89, 45056
    v_mfma_f32_16x16x32_bf16 v[84:87], a[160:163], v[168:171], v[84:87]
    buffer_load_dwordx4 v[184:187], v14, s[44:47], s58 offen sc1
    v_mfma_f32_16x16x32_bf16 v[88:91], a[160:163], v[172:175], v[88:91]
    v_mfma_f32_16x16x32_bf16 v[92:95], a[160:163], v[176:179], v[92:95]
    v_mfma_f32_16x16x32_bf16 v[216:219], a[164:167], v[164:167], v[216:219]
    v_mfma_f32_16x16x32_bf16 v[220:223], a[164:167], v[168:171], v[220:223]
    buffer_load_dwordx4 v[188:191], v15, s[44:47], s58 offen sc1
    v_mfma_f32_16x16x32_bf16 v[224:227], a[164:167], v[172:175], v[224:227]
    v_mfma_f32_16x16x32_bf16 v[228:231], a[164:167], v[176:179], v[228:231]
    s_waitcnt vmcnt(24)
    v_mfma_f32_16x16x32_bf16 v[32:35], a[168:171], v[240:243], v[32:35]
    s_waitcnt vmcnt(23)
    v_mfma_f32_16x16x32_bf16 v[36:39], a[168:171], v[244:247], v[36:39]
    s_waitcnt vmcnt(22)
    v_mfma_f32_16x16x32_bf16 v[40:43], a[168:171], v[248:251], v[40:43]
    buffer_load_dwordx4 v[192:195], v16, s[44:47], s58 offen sc1
    s_waitcnt vmcnt(22)
    v_mfma_f32_16x16x32_bf16 v[44:47], a[168:171], v[252:255], v[44:47]
    v_mfma_f32_16x16x32_bf16 v[48:51], a[172:175], v[240:243], v[48:51]
    v_mfma_f32_16x16x32_bf16 v[52:55], a[172:175], v[244:247], v[52:55]
    v_mfma_f32_16x16x32_bf16 v[56:59], a[172:175], v[248:251], v[56:59]
    buffer_load_dwordx4 v[196:199], v17, s[44:47], s58 offen sc1
    v_mfma_f32_16x16x32_bf16 v[60:63], a[172:175], v[252:255], v[60:63]
    v_mfma_f32_16x16x32_bf16 v[64:67], a[176:179], v[240:243], v[64:67]
    v_mfma_f32_16x16x32_bf16 v[68:71], a[176:179], v[244:247], v[68:71]
    v_mfma_f32_16x16x32_bf16 v[72:75], a[176:179], v[248:251], v[72:75]
    s_add_u32 s64, s89, 8192
    v_mfma_f32_16x16x32_bf16 v[76:79], a[176:179], v[252:255], v[76:79]
    buffer_load_dwordx4 v[200:203], v14, s[44:47], s64 offen sc1
    v_mfma_f32_16x16x32_bf16 v[80:83], a[180:183], v[240:243], v[80:83]
    v_mfma_f32_16x16x32_bf16 v[84:87], a[180:183], v[244:247], v[84:87]
    v_mfma_f32_16x16x32_bf16 v[88:91], a[180:183], v[248:251], v[88:91]
    v_mfma_f32_16x16x32_bf16 v[92:95], a[180:183], v[252:255], v[92:95]
    s_waitcnt vmcnt(11)
    s_mov_b64 exec, 1
    buffer_store_dword v30, off, s[44:47], s7 sc1
    s_mov_b64 exec, -1
    v_mfma_f32_16x16x32_bf16 v[216:219], a[184:187], v[240:243], v[216:219]
    buffer_load_dwordx4 v[204:207], v15, s[44:47], s64 offen sc1
    v_mfma_f32_16x16x32_bf16 v[220:223], a[184:187], v[244:247], v[220:223]
    v_mfma_f32_16x16x32_bf16 v[224:227], a[184:187], v[248:251], v[224:227]
    v_mfma_f32_16x16x32_bf16 v[228:231], a[184:187], v[252:255], v[228:231]
    v_mfma_f32_16x16x32_bf16 v[32:35], a[188:191], v[112:115], v[32:35]
    buffer_load_dwordx4 v[208:211], v16, s[44:47], s64 offen sc1
    v_mfma_f32_16x16x32_bf16 v[36:39], a[188:191], v[116:119], v[36:39]
    v_mfma_f32_16x16x32_bf16 v[40:43], a[188:191], v[120:123], v[40:43]
    v_mfma_f32_16x16x32_bf16 v[44:47], a[188:191], v[124:127], v[44:47]
    v_mfma_f32_16x16x32_bf16 v[48:51], a[192:195], v[112:115], v[48:51]
    v_mfma_f32_16x16x32_bf16 v[52:55], a[192:195], v[116:119], v[52:55]
    buffer_load_dwordx4 v[212:215], v17, s[44:47], s64 offen sc1
    v_mfma_f32_16x16x32_bf16 v[56:59], a[192:195], v[120:123], v[56:59]
    v_mfma_f32_16x16x32_bf16 v[60:63], a[192:195], v[124:127], v[60:63]
    v_mfma_f32_16x16x32_bf16 v[64:67], a[196:199], v[112:115], v[64:67]
    s_add_u32 s58, s89, 12288
    v_mfma_f32_16x16x32_bf16 v[68:71], a[196:199], v[116:119], v[68:71]
    buffer_load_dwordx4 v[148:151], v14, s[44:47], s58 offen sc1
    v_mfma_f32_16x16x32_bf16 v[72:75], a[196:199], v[120:123], v[72:75]
    v_mfma_f32_16x16x32_bf16 v[76:79], a[196:199], v[124:127], v[76:79]
    v_mfma_f32_16x16x32_bf16 v[80:83], a[200:203], v[112:115], v[80:83]
    v_mfma_f32_16x16x32_bf16 v[84:87], a[200:203], v[116:119], v[84:87]
    v_mfma_f32_16x16x32_bf16 v[88:91], a[200:203], v[120:123], v[88:91]
    buffer_load_dwordx4 v[152:155], v15, s[44:47], s58 offen sc1
    v_mfma_f32_16x16x32_bf16 v[92:95], a[200:203], v[124:127], v[92:95]
    v_mfma_f32_16x16x32_bf16 v[216:219], a[204:207], v[112:115], v[216:219]
    v_mfma_f32_16x16x32_bf16 v[220:223], a[204:207], v[116:119], v[220:223]
    v_mfma_f32_16x16x32_bf16 v[224:227], a[204:207], v[120:123], v[224:227]
    buffer_load_dwordx4 v[156:159], v16, s[44:47], s58 offen sc1
    v_mfma_f32_16x16x32_bf16 v[228:231], a[204:207], v[124:127], v[228:231]
    v_mfma_f32_16x16x32_bf16 v[32:35], a[208:211], v[96:99], v[32:35]
    v_mfma_f32_16x16x32_bf16 v[36:39], a[208:211], v[100:103], v[36:39]
    v_mfma_f32_16x16x32_bf16 v[40:43], a[208:211], v[104:107], v[40:43]
    v_mfma_f32_16x16x32_bf16 v[44:47], a[208:211], v[108:111], v[44:47]
    buffer_load_dwordx4 v[160:163], v17, s[44:47], s58 offen sc1
    v_mfma_f32_16x16x32_bf16 v[48:51], a[212:215], v[96:99], v[48:51]
    v_mfma_f32_16x16x32_bf16 v[52:55], a[212:215], v[100:103], v[52:55]
    v_mfma_f32_16x16x32_bf16 v[56:59], a[212:215], v[104:107], v[56:59]
    s_add_u32 s64, s89, 32768
    v_mfma_f32_16x16x32_bf16 v[60:63], a[212:215], v[108:111], v[60:63]
    buffer_load_dwordx4 v[164:167], v14, s[44:47], s64 offen sc1
    v_mfma_f32_16x16x32_bf16 v[64:67], a[216:219], v[96:99], v[64:67]
    v_mfma_f32_16x16x32_bf16 v[68:71], a[216:219], v[100:103], v[68:71]
    v_mfma_f32_16x16x32_bf16 v[72:75], a[216:219], v[104:107], v[72:75]
    v_mfma_f32_16x16x32_bf16 v[76:79], a[216:219], v[108:111], v[76:79]
    v_mfma_f32_16x16x32_bf16 v[80:83], a[220:223], v[96:99], v[80:83]
    buffer_load_dwordx4 v[168:171], v15, s[44:47], s64 offen sc1
    v_mfma_f32_16x16x32_bf16 v[84:87], a[220:223], v[100:103], v[84:87]
    v_mfma_f32_16x16x32_bf16 v[88:91], a[220:223], v[104:107], v[88:91]
    v_mfma_f32_16x16x32_bf16 v[92:95], a[220:223], v[108:111], v[92:95]
    v_mfma_f32_16x16x32_bf16 v[216:219], a[224:227], v[96:99], v[216:219]
    v_mfma_f32_16x16x32_bf16 v[220:223], a[224:227], v[100:103], v[220:223]
    buffer_load_dwordx4 v[172:175], v16, s[44:47], s64 offen sc1
    v_mfma_f32_16x16x32_bf16 v[224:227], a[224:227], v[104:107], v[224:227]
    v_mfma_f32_16x16x32_bf16 v[228:231], a[224:227], v[108:111], v[228:231]
    v_mfma_f32_16x16x32_bf16 v[32:35], a[0:3], a[248:251], v[32:35]
    v_mfma_f32_16x16x32_bf16 v[36:39], a[0:3], a[252:255], v[36:39]
    buffer_load_dwordx4 v[176:179], v17, s[44:47], s64 offen sc1
    s_waitcnt vmcnt(22)
    v_mfma_f32_16x16x32_bf16 v[40:43], a[0:3], a[120:123], v[40:43]
    s_waitcnt vmcnt(21)
    v_mfma_f32_16x16x32_bf16 v[44:47], a[0:3], a[124:127], v[44:47]
    v_mfma_f32_16x16x32_bf16 v[48:51], a[4:7], a[248:251], v[48:51]
    v_mfma_f32_16x16x32_bf16 v[52:55], a[4:7], a[252:255], v[52:55]
    s_add_u32 s58, s89, 36864
    v_mfma_f32_16x16x32_bf16 v[56:59], a[4:7], a[120:123], v[56:59]
    buffer_load_dwordx4 v[240:243], v14, s[44:47], s58 offen sc1
    v_mfma_f32_16x16x32_bf16 v[60:63], a[4:7], a[124:127], v[60:63]
    v_mfma_f32_16x16x32_bf16 v[64:67], a[8:11], a[248:251], v[64:67]
    v_mfma_f32_16x16x32_bf16 v[68:71], a[8:11], a[252:255], v[68:71]
    v_mfma_f32_16x16x32_bf16 v[72:75], a[8:11], a[120:123], v[72:75]
    buffer_load_dwordx4 v[244:247], v15, s[44:47], s58 offen sc1
    v_mfma_f32_16x16x32_bf16 v[76:79], a[8:11], a[124:127], v[76:79]
    v_mfma_f32_16x16x32_bf16 v[80:83], a[12:15], a[248:251], v[80:83]
    v_mfma_f32_16x16x32_bf16 v[84:87], a[12:15], a[252:255], v[84:87]
    v_mfma_f32_16x16x32_bf16 v[88:91], a[12:15], a[120:123], v[88:91]
    s_add_u32 s22, s92, 0
    v_mfma_f32_16x16x32_bf16 v[92:95], a[12:15], a[124:127], v[92:95]
    buffer_load_dwordx4 a[128:131], v10, s[44:47], s22 offen offset:0 sc1
    v_mfma_f32_16x16x32_bf16 v[216:219], a[16:19], a[248:251], v[216:219]
    v_mfma_f32_16x16x32_bf16 v[220:223], a[16:19], a[252:255], v[220:223]
    v_mfma_f32_16x16x32_bf16 v[224:227], a[16:19], a[120:123], v[224:227]
    v_mfma_f32_16x16x32_bf16 v[228:231], a[16:19], a[124:127], v[228:231]
    buffer_load_dwordx4 a[132:135], v10, s[44:47], s22 offen offset:1024 sc1
    s_waitcnt vmcnt(24)
    v_mfma_f32_16x16x32_bf16 v[32:35], a[20:23], v[128:131], v[32:35]
    s_waitcnt vmcnt(23)
    v_mfma_f32_16x16x32_bf16 v[36:39], a[20:23], v[132:135], v[36:39]
    s_waitcnt vmcnt(22)
    v_mfma_f32_16x16x32_bf16 v[40:43], a[20:23], v[136:139], v[40:43]
    s_waitcnt vmcnt(21)
    v_mfma_f32_16x16x32_bf16 v[44:47], a[20:23], v[140:143], v[44:47]
    v_mfma_f32_16x16x32_bf16 v[48:51], a[24:27], v[128:131], v[48:51]
    buffer_load_dwordx4 v[248:251], v16, s[44:47], s58 offen sc1
    v_mfma_f32_16x16x32_bf16 v[52:55], a[24:27], v[132:135], v[52:55]
    v_mfma_f32_16x16x32_bf16 v[56:59], a[24:27], v[136:139], v[56:59]
    v_mfma_f32_16x16x32_bf16 v[60:63], a[24:27], v[140:143], v[60:63]
    v_mfma_f32_16x16x32_bf16 v[64:67], a[28:31], v[128:131], v[64:67]
    buffer_load_dwordx4 a[136:139], v10, s[44:47], s22 offen offset:2048 sc1
    v_mfma_f32_16x16x32_bf16 v[68:71], a[28:31], v[132:135], v[68:71]
    v_mfma_f32_16x16x32_bf16 v[72:75], a[28:31], v[136:139], v[72:75]
    v_mfma_f32_16x16x32_bf16 v[76:79], a[28:31], v[140:143], v[76:79]
    v_mfma_f32_16x16x32_bf16 v[80:83], a[32:35], v[128:131], v[80:83]
    v_mfma_f32_16x16x32_bf16 v[84:87], a[32:35], v[132:135], v[84:87]
    buffer_load_dwordx4 a[140:143], v10, s[44:47], s22 offen offset:3072 sc1
    v_mfma_f32_16x16x32_bf16 v[88:91], a[32:35], v[136:139], v[88:91]
    v_mfma_f32_16x16x32_bf16 v[92:95], a[32:35], v[140:143], v[92:95]
    v_mfma_f32_16x16x32_bf16 v[216:219], a[36:39], v[128:131], v[216:219]
    buffer_load_dword v19, v9, s[44:47], s13 offen sc1
    v_mfma_f32_16x16x32_bf16 v[220:223], a[36:39], v[132:135], v[220:223]
    v_mfma_f32_16x16x32_bf16 v[224:227], a[36:39], v[136:139], v[224:227]
    buffer_load_dwordx4 a[144:147], v11, s[44:47], s22 offen offset:0 sc1
    v_mfma_f32_16x16x32_bf16 v[228:231], a[36:39], v[140:143], v[228:231]
    s_waitcnt vmcnt(25)
    v_mfma_f32_16x16x32_bf16 v[32:35], a[40:43], v[184:187], v[32:35]
    s_waitcnt vmcnt(24)
    v_mfma_f32_16x16x32_bf16 v[36:39], a[40:43], v[188:191], v[36:39]
    s_waitcnt vmcnt(23)
    v_mfma_f32_16x16x32_bf16 v[40:43], a[40:43], v[192:195], v[40:43]
    s_add_u32 s21, s92, 40960
    s_waitcnt vmcnt(22)
    v_mfma_f32_16x16x32_bf16 v[44:47], a[40:43], v[196:199], v[44:47]
    buffer_load_dwordx4 a[148:151], v10, s[44:47], s21 offen offset:0 sc1
    v_mfma_f32_16x16x32_bf16 v[48:51], a[44:47], v[184:187], v[48:51]
    v_mfma_f32_16x16x32_bf16 v[52:55], a[44:47], v[188:191], v[52:55]
    v_mfma_f32_16x16x32_bf16 v[56:59], a[44:47], v[192:195], v[56:59]
    v_mfma_f32_16x16x32_bf16 v[60:63], a[44:47], v[196:199], v[60:63]
    buffer_load_dwordx4 a[152:155], v10, s[44:47], s21 offen offset:1024 sc1
    v_mfma_f32_16x16x32_bf16 v[64:67], a[48:51], v[184:187], v[64:67]
    v_mfma_f32_16x16x32_bf16 v[68:71], a[48:51], v[188:191], v[68:71]
    v_mfma_f32_16x16x32_bf16 v[72:75], a[48:51], v[192:195], v[72:75]
    v_mfma_f32_16x16x32_bf16 v[76:79], a[48:51], v[196:199], v[76:79]
    v_mfma_f32_16x16x32_bf16 v[80:83], a[52:55], v[184:187], v[80:83]
    buffer_load_dwordx4 a[156:159], v10, s[44:47], s21 offen offset:2048 sc1
    v_mfma_f32_16x16x32_bf16 v[84:87], a[52:55], v[188:191], v[84:87]
    v_mfma_f32_16x16x32_bf16 v[88:91], a[52:55], v[192:195], v[88:91]
    v_mfma_f32_16x16x32_bf16 v[92:95], a[52:55], v[196:199], v[92:95]
    v_mfma_f32_16x16x32_bf16 v[216:219], a[56:59], v[184:187], v[216:219]
    v_mfma_f32_16x16x32_bf16 v[220:223], a[56:59], v[188:191], v[220:223]
    buffer_load_dwordx4 v[252:255], v17, s[44:47], s58 offen sc1
    v_mfma_f32_16x16x32_bf16 v[224:227], a[56:59], v[192:195], v[224:227]
    v_mfma_f32_16x16x32_bf16 v[228:231], a[56:59], v[196:199], v[228:231]
    s_waitcnt vmcnt(23)
    v_mfma_f32_16x16x32_bf16 v[36:39], a[228:231], v[204:207], v[36:39]
    s_mov_b32 s68, s72
    buffer_load_dwordx4 a[160:163], v10, s[44:47], s21 offen offset:3072 sc1
    s_waitcnt vmcnt(20)
    v_mfma_f32_16x16x32_bf16 v[36:39], a[60:63], v[152:155], v[36:39]
    s_mov_b32 s69, s72
    buffer_load_dwordx4 a[164:167], v11, s[44:47], s21 offen offset:0 sc1
    s_waitcnt vmcnt(17)
    v_mfma_f32_16x16x32_bf16 v[36:39], a[80:83], v[168:171], v[36:39]
    s_mov_b32 s70, 1.0
    s_waitcnt vmcnt(13)
    v_mfma_f32_16x16x32_bf16 v[36:39], a[100:103], v[244:247], v[36:39]
    s_mov_b32 s71, 1.0
    v_mfma_f32_16x16x32_bf16 v[52:55], a[232:235], v[204:207], v[52:55]
    s_add_u32 s22, s92, 81920
    buffer_load_dwordx4 a[168:171], v10, s[44:47], s22 offen offset:0 sc1
    v_mfma_f32_16x16x32_bf16 v[52:55], a[64:67], v[152:155], v[52:55]
    v_mfma_f32_16x16x32_bf16 v[52:55], a[84:87], v[168:171], v[52:55]
    v_mfma_f32_16x16x32_bf16 v[52:55], a[104:107], v[244:247], v[52:55]
    v_mfma_f32_16x16x32_bf16 v[68:71], a[236:239], v[204:207], v[68:71]
    buffer_load_dwordx4 a[172:175], v10, s[44:47], s22 offen offset:1024 sc1
    v_mfma_f32_16x16x32_bf16 v[68:71], a[68:71], v[152:155], v[68:71]
    ds_write_b128 v5, v[36:39] offset:0
    v_mfma_f32_16x16x32_bf16 v[68:71], a[88:91], v[168:171], v[68:71]
    v_mfma_f32_16x16x32_bf16 v[68:71], a[108:111], v[244:247], v[68:71]
    v_mfma_f32_16x16x32_bf16 v[84:87], a[240:243], v[204:207], v[84:87]
    buffer_load_dwordx4 a[176:179], v10, s[44:47], s22 offen offset:2048 sc1
    v_mfma_f32_16x16x32_bf16 v[84:87], a[72:75], v[152:155], v[84:87]
    ds_write_b128 v5, v[52:55] offset:1024
    v_mfma_f32_16x16x32_bf16 v[84:87], a[92:95], v[168:171], v[84:87]
    v_mfma_f32_16x16x32_bf16 v[84:87], a[112:115], v[244:247], v[84:87]
    v_mfma_f32_16x16x32_bf16 v[220:223], a[244:247], v[204:207], v[220:223]
    buffer_load_dwordx4 a[180:183], v10, s[44:47], s22 offen offset:3072 sc1
    v_mfma_f32_16x16x32_bf16 v[220:223], a[76:79], v[152:155], v[220:223]
    ds_write_b128 v5, v[68:71] offset:2048
    v_mfma_f32_16x16x32_bf16 v[220:223], a[96:99], v[168:171], v[220:223]
    v_mfma_f32_16x16x32_bf16 v[220:223], a[116:119], v[244:247], v[220:223]
    buffer_load_dwordx4 a[184:187], v11, s[44:47], s22 offen offset:0 sc1
    v_mfma_f32_16x16x32_bf16 v[40:43], a[228:231], v[208:211], v[40:43]
    v_mfma_f32_16x16x32_bf16 v[40:43], a[60:63], v[156:159], v[40:43]
    ds_write_b128 v5, v[84:87] offset:3072
    v_mfma_f32_16x16x32_bf16 v[40:43], a[80:83], v[172:175], v[40:43]
    s_add_u32 s21, s92, 122880
    s_waitcnt vmcnt(15)
    v_mfma_f32_16x16x32_bf16 v[40:43], a[100:103], v[248:251], v[40:43]
    buffer_load_dwordx4 a[188:191], v10, s[44:47], s21 offen offset:0 sc1
    v_mfma_f32_16x16x32_bf16 v[56:59], a[232:235], v[208:211], v[56:59]
    v_mfma_f32_16x16x32_bf16 v[56:59], a[64:67], v[156:159], v[56:59]
    ds_write_b128 v5, v[220:223] offset:4096
    v_mfma_f32_16x16x32_bf16 v[56:59], a[84:87], v[172:175], v[56:59]
    s_waitcnt vmcnt(13)
    v_cmp_ne_u32 vcc, 1, v19
    s_nop 1
    s_cbranch_vccnz L_retry5
L_cont5:
    v_mfma_f32_16x16x32_bf16 v[56:59], a[104:107], v[248:251], v[56:59]
    buffer_load_dwordx4 a[192:195], v10, s[44:47], s21 offen offset:1024 sc1
    v_mfma_f32_16x16x32_bf16 v[72:75], a[236:239], v[208:211], v[72:75]
    v_mfma_f32_16x16x32_bf16 v[72:75], a[68:71], v[156:159], v[72:75]
    ds_write_b128 v6, v[40:43] offset:0
    v_mfma_f32_16x16x32_bf16 v[72:75], a[88:91], v[172:175], v[72:75]
    v_mfma_f32_16x16x32_bf16 v[72:75], a[108:111], v[248:251], v[72:75]
    buffer_load_dwordx4 a[196:199], v10, s[44:47], s21 offen offset:2048 sc1
    v_mfma_f32_16x16x32_bf16 v[88:91], a[240:243], v[208:211], v[88:91]
    v_mfma_f32_16x16x32_bf16 v[88:91], a[72:75], v[156:159], v[88:91]
    ds_write_b128 v6, v[56:59] offset:1024
    v_mfma_f32_16x16x32_bf16 v[88:91], a[92:95], v[172:175], v[88:91]
    buffer_load_dwordx4 a[200:203], v10, s[44:47], s21 offen offset:3072 sc1
    v_mfma_f32_16x16x32_bf16 v[88:91], a[112:115], v[248:251], v[88:91]
    v_mfma_f32_16x16x32_bf16 v[224:227], a[244:247], v[208:211], v[224:227]
    v_mfma_f32_16x16x32_bf16 v[224:227], a[76:79], v[156:159], v[224:227]
    ds_write_b128 v6, v[72:75] offset:2048
    v_mfma_f32_16x16x32_bf16 v[224:227], a[96:99], v[172:175], v[224:227]
    buffer_load_dwordx4 a[204:207], v11, s[44:47], s21 offen offset:0 sc1
    v_mfma_f32_16x16x32_bf16 v[224:227], a[116:119], v[248:251], v[224:227]
    v_mfma_f32_16x16x32_bf16 v[44:47], a[228:231], v[212:215], v[44:47]
    v_mfma_f32_16x16x32_bf16 v[44:47], a[60:63], v[160:163], v[44:47]
    s_add_u32 s22, s92, 163840
    ds_write_b128 v6, v[88:91] offset:3072
    v_mfma_f32_16x16x32_bf16 v[44:47], a[80:83], v[176:179], v[44:47]
    buffer_load_dwordx4 a[208:211], v10, s[44:47], s22 offen offset:0 sc1
    s_waitcnt vmcnt(13)
    v_mfma_f32_16x16x32_bf16 v[44:47], a[100:103], v[252:255], v[44:47]
    v_mfma_f32_16x16x32_bf16 v[60:63], a[232:235], v[212:215], v[60:63]
    v_mfma_f32_16x16x32_bf16 v[60:63], a[64:67], v[160:163], v[60:63]
    ds_write_b128 v6, v[224:227] offset:4096
    v_mfma_f32_16x16x32_bf16 v[60:63], a[84:87], v[176:179], v[60:63]
    buffer_load_dwordx4 a[212:215], v10, s[44:47], s22 offen offset:1024 sc1
    v_mfma_f32_16x16x32_bf16 v[60:63], a[104:107], v[252:255], v[60:63]
    v_mfma_f32_16x16x32_bf16 v[76:79], a[236:239], v[212:215], v[76:79]
    v_mfma_f32_16x16x32_bf16 v[76:79], a[68:71], v[160:163], v[76:79]
    s_add_u32 s64, s90, 0
    ds_write_b128 v7, v[44:47] offset:0
    v_mfma_f32_16x16x32_bf16 v[76:79], a[88:91], v[176:179], v[76:79]
    buffer_load_dwordx4 v[112:115], v15, s[44:47], s64 offen sc1
    v_mfma_f32_16x16x32_bf16 v[76:79], a[108:111], v[252:255], v[76:79]
    v_mfma_f32_16x16x32_bf16 v[92:95], a[240:243], v[212:215], v[92:95]
    v_mfma_f32_16x16x32_bf16 v[92:95], a[72:75], v[160:163], v[92:95]
    ds_write_b128 v7, v[60:63] offset:1024
    v_mfma_f32_16x16x32_bf16 v[92:95], a[92:95], v[176:179], v[92:95]
    buffer_load_dwordx4 a[216:219], v10, s[44:47], s22 offen offset:2048 sc1
    v_mfma_f32_16x16x32_bf16 v[92:95], a[112:115], v[252:255], v[92:95]
    s_add_u32 s58, s90, 4096
    v_mfma_f32_16x16x32_bf16 v[228:231], a[244:247], v[212:215], v[228:231]
    buffer_load_dwordx4 v[116:119], v15, s[44:47], s58 offen sc1
    v_mfma_f32_16x16x32_bf16 v[228:231], a[76:79], v[160:163], v[228:231]
    ds_write_b128 v7, v[76:79] offset:2048
    v_mfma_f32_16x16x32_bf16 v[228:231], a[96:99], v[176:179], v[228:231]
    v_mfma_f32_16x16x32_bf16 v[228:231], a[116:119], v[252:255], v[228:231]
    buffer_load_dwordx4 a[220:223], v10, s[44:47], s22 offen offset:3072 sc1
    v_mfma_f32_16x16x32_bf16 v[32:35], a[228:231], v[200:203], v[32:35]
    v_mfma_f32_16x16x32_bf16 v[32:35], a[60:63], v[148:151], v[32:35]
    s_add_u32 s64, s90, 8192
    ds_write_b128 v7, v[92:95] offset:3072
    v_mfma_f32_16x16x32_bf16 v[32:35], a[80:83], v[164:167], v[32:35]
    buffer_load_dwordx4 v[120:123], v15, s[44:47], s64 offen sc1
    v_mfma_f32_16x16x32_bf16 v[32:35], a[100:103], v[240:243], v[32:35]
    v_mfma_f32_16x16x32_bf16 v[48:51], a[232:235], v[200:203], v[48:51]
    v_mfma_f32_16x16x32_bf16 v[48:51], a[64:67], v[148:151], v[48:51]
    ds_write_b128 v7, v[228:231] offset:4096
    v_mfma_f32_16x16x32_bf16 v[48:51], a[84:87], v[164:167], v[48:51]
    buffer_load_dwordx4 a[224:227], v11, s[44:47], s22 offen offset:0 sc1
    v_mfma_f32_16x16x32_bf16 v[48:51], a[104:107], v[240:243], v[48:51]
    s_add_u32 s58, s90, 12288
    v_mfma_f32_16x16x32_bf16 v[64:67], a[236:239], v[200:203], v[64:67]
    buffer_load_dwordx4 v[124:127], v15, s[44:47], s58 offen sc1
    v_mfma_f32_16x16x32_bf16 v[64:67], a[68:71], v[148:151], v[64:67]
    s_waitcnt lgkmcnt(0)
    s_barrier
    ds_read_b128 v[36:39], v20 offset:0
L_page7:
    s_cbranch_execz L_tret1
    ds_read_b128 v[40:43], v20 offset:5120
    v_mfma_f32_16x16x32_bf16 v[64:67], a[88:91], v[164:167], v[64:67]
    ds_read_b128 v[44:47], v20 offset:10240
    v_mfma_f32_16x16x32_bf16 v[64:67], a[108:111], v[240:243], v[64:67]
    ds_read_b128 v[52:55], v20 offset:1024
    ds_read_b128 v[56:59], v20 offset:6144
    v_mfma_f32_16x16x32_bf16 v[80:83], a[240:243], v[200:203], v[80:83]
    ds_read_b128 v[60:63], v20 offset:11264
    v_mfma_f32_16x16x32_bf16 v[80:83], a[72:75], v[148:151], v[80:83]
    ds_read_b128 v[68:71], v20 offset:2048
    v_mfma_f32_16x16x32_bf16 v[80:83], a[92:95], v[164:167], v[80:83]
    ds_read_b128 v[72:75], v20 offset:7168
    ds_read_b128 v[76:79], v20 offset:12288
    v_mfma_f32_16x16x32_bf16 v[80:83], a[112:115], v[240:243], v[80:83]
    ds_read_b128 v[84:87], v20 offset:3072
    v_mfma_f32_16x16x32_bf16 v[216:219], a[244:247], v[200:203], v[216:219]
    ds_read_b128 v[88:91], v20 offset:8192
    v_mfma_f32_16x16x32_bf16 v[216:219], a[76:79], v[148:151], v[216:219]
    ds_read_b128 v[92:95], v20 offset:13312
    ds_read_b128 v[220:223], v20 offset:4096
    v_mfma_f32_16x16x32_bf16 v[216:219], a[96:99], v[164:167], v[216:219]
    ds_read_b128 v[224:227], v20 offset:9216
    v_mfma_f32_16x16x32_bf16 v[216:219], a[116:119], v[240:243], v[216:219]
    ds_read_b128 v[228:231], v20 offset:14336
    v_add_u32 v5, 98304, v5
    v_add_u32 v6, 98304, v6
    v_add_u32 v7, 98304, v7
    v_add_u32 v20, 98304, v20
    s_waitcnt lgkmcnt(14)
    v_pk_add_f32 v[32:33], v[32:33], v[36:37]
    s_waitcnt lgkmcnt(12)
    v_pk_add_f32 v[40:41], v[40:41], v[44:45]
    v_pk_add_f32 v[34:35], v[34:35], v[38:39]
    v_pk_add_f32 v[42:43], v[42:43], v[46:47]
    v_pk_add_f32 v[32:33], v[32:33], v[40:41]
    v_pk_add_f32 v[34:35], v[34:35], v[42:43]
    v_pk_mul_f32 v[36:37], v[32:33], s[68:69]
    v_pk_mul_f32 v[38:39], v[34:35], s[68:69]
    v_exp_f32 v36, v36
    v_exp_f32 v37, v37
    v_exp_f32 v38, v38
    v_exp_f32 v39, v39
    v_pk_add_f32 v[36:37], v[36:37], s[70:71]
    v_pk_add_f32 v[38:39], v[38:39], s[70:71]
    v_rcp_f32 v36, v36
    v_rcp_f32 v37, v37
    v_rcp_f32 v38, v38
    v_rcp_f32 v39, v39
    v_pk_mul_f32 v[32:33], v[32:33], v[36:37]
    v_pk_mul_f32 v[34:35], v[34:35], v[38:39]
    s_add_u32 s64, s90, 16384
    buffer_load_dwordx4 v[96:99], v15, s[44:47], s64 offen sc1
    s_add_u32 s58, s90, 0
    buffer_load_dwordx4 a[0:3], v16, s[44:47], s58 offen sc1
    s_waitcnt lgkmcnt(11)
    v_pk_add_f32 v[48:49], v[48:49], v[52:53]
    s_waitcnt lgkmcnt(9)
    v_pk_add_f32 v[56:57], v[56:57], v[60:61]
    v_pk_add_f32 v[50:51], v[50:51], v[54:55]
    v_pk_add_f32 v[58:59], v[58:59], v[62:63]
    v_pk_add_f32 v[48:49], v[48:49], v[56:57]
    v_pk_add_f32 v[50:51], v[50:51], v[58:59]
    v_pk_mul_f32 v[52:53], v[48:49], s[68:69]
    v_pk_mul_f32 v[54:55], v[50:51], s[68:69]
    v_exp_f32 v52, v52
    v_exp_f32 v53, v53
    v_exp_f32 v54, v54
    v_exp_f32 v55, v55
    v_pk_add_f32 v[52:53], v[52:53], s[70:71]
    v_pk_add_f32 v[54:55], v[54:55], s[70:71]
    v_rcp_f32 v52, v52
    v_rcp_f32 v53, v53
    v_rcp_f32 v54, v54
    v_rcp_f32 v55, v55
    v_pk_mul_f32 v[48:49], v[48:49], v[52:53]
    v_pk_mul_f32 v[50:51], v[50:51], v[54:55]
    s_add_u32 s64, s90, 4096
    buffer_load_dwordx4 a[4:7], v16, s[44:47], s64 offen sc1
    s_add_u32 s58, s90, 8192
    buffer_load_dwordx4 a[8:11], v16, s[44:47], s58 offen sc1
    s_waitcnt lgkmcnt(8)
    v_pk_add_f32 v[64:65], v[64:65], v[68:69]
    s_waitcnt lgkmcnt(6)
    v_pk_add_f32 v[72:73], v[72:73], v[76:77]
    v_pk_add_f32 v[66:67], v[66:67], v[70:71]
    v_pk_add_f32 v[74:75], v[74:75], v[78:79]
    v_pk_add_f32 v[64:65], v[64:65], v[72:73]
    v_pk_add_f32 v[66:67], v[66:67], v[74:75]
    v_pk_mul_f32 v[68:69], v[64:65], s[68:69]
    v_pk_mul_f32 v[70:71], v[66:67], s[68:69]
    v_exp_f32 v68, v68
    v_exp_f32 v69, v69
    v_exp_f32 v70, v70
    v_exp_f32 v71, v71
    v_pk_add_f32 v[68:69], v[68:69], s[70:71]
    v_pk_add_f32 v[70:71], v[70:71], s[70:71]
    v_rcp_f32 v68, v68
    v_rcp_f32 v69, v69
    v_rcp_f32 v70, v70
    v_rcp_f32 v71, v71
    v_pk_mul_f32 v[64:65], v[64:65], v[68:69]
    v_pk_mul_f32 v[66:67], v[66:67], v[70:71]
    s_add_u32 s64, s90, 12288
    buffer_load_dwordx4 a[12:15], v16, s[44:47], s64 offen sc1
    s_add_u32 s58, s90, 16384
    buffer_load_dwordx4 a[16:19], v16, s[44:47], s58 offen sc1
    s_waitcnt vmcnt(12)
    v_mfma_f32_16x16x32_bf16 v[152:155], a[128:131], v[112:115], 0
    s_add_u32 s64, s90, 0
    buffer_load_dwordx4 a[20:23], v17, s[44:47], s64 offen sc1
    s_waitcnt vmcnt(11)
    v_mfma_f32_16x16x32_bf16 v[152:155], a[148:151], v[116:119], v[152:155]
    s_add_u32 s58, s90, 4096
    buffer_load_dwordx4 a[24:27], v17, s[44:47], s58 offen sc1
    s_waitcnt vmcnt(10)
    v_mfma_f32_16x16x32_bf16 v[152:155], a[168:171], v[120:123], v[152:155]
    s_add_u32 s64, s90, 8192
    s_waitcnt lgkmcnt(5)
    v_add_f32 v80, v80, v84
    s_waitcnt lgkmcnt(3)
    v_add_f32 v88, v88, v92
    s_waitcnt vmcnt(8)
    v_mfma_f32_16x16x32_bf16 v[152:155], a[188:191], v[124:127], v[152:155]
    buffer_load_dwordx4 a[28:31], v17, s[44:47], s64 offen sc1
    s_waitcnt vmcnt(8)
    v_mfma_f32_16x16x32_bf16 v[152:155], a[208:211], v[96:99], v[152:155]
    s_add_u32 s58, s90, 12288
    buffer_load_dwordx4 a[32:35], v17, s[44:47], s58 offen sc1
    v_mfma_f32_16x16x32_bf16 v[168:171], a[132:135], v[112:115], 0
    v_add_f32 v81, v81, v85
    v_add_f32 v89, v89, v93
    v_mfma_f32_16x16x32_bf16 v[168:171], a[152:155], v[116:119], v[168:171]
    s_add_u32 s64, s90, 16384
    v_add_f32 v82, v82, v86
    v_add_f32 v90, v90, v94
    v_mfma_f32_16x16x32_bf16 v[168:171], a[172:175], v[120:123], v[168:171]
    buffer_load_dwordx4 a[36:39], v17, s[44:47], s64 offen sc1
    v_mfma_f32_16x16x32_bf16 v[168:171], a[192:195], v[124:127], v[168:171]
    v_add_f32 v83, v83, v87
    v_add_f32 v91, v91, v95
    v_mfma_f32_16x16x32_bf16 v[168:171], a[212:215], v[96:99], v[168:171]
    v_add_f32 v80, v80, v88
    v_add_f32 v81, v81, v89
    v_mfma_f32_16x16x32_bf16 v[244:247], a[136:139], v[112:115], 0
    s_add_u32 s58, s90, 0
    ds_write_b128 v5, v[152:155] offset:0
    v_mfma_f32_16x16x32_bf16 v[244:247], a[156:159], v[116:119], v[244:247]
    buffer_load_dwordx4 a[40:43], v14, s[44:47], s58 offen sc1
    v_mfma_f32_16x16x32_bf16 v[244:247], a[176:179], v[120:123], v[244:247]
    v_add_f32 v82, v82, v90
    v_add_f32 v83, v83, v91
    v_mfma_f32_16x16x32_bf16 v[244:247], a[196:199], v[124:127], v[244:247]
    s_add_u32 m0, s75, 0
    v_mul_f32 v84, s72, v80
    v_mul_f32 v85, s72, v81
    v_mfma_f32_16x16x32_bf16 v[244:247], a[216:219], v[96:99], v[244:247]
    buffer_load_dwordx4 v2, s[24:27], s14 offen lds
    v_mfma_f32_16x16x32_bf16 v[188:191], a[140:143], v[112:115], 0
    ds_write_b128 v5, v[168:171] offset:1024
    v_mfma_f32_16x16x32_bf16 v[188:191], a[160:163], v[116:119], v[188:191]
    v_mul_f32 v86, s72, v82
    v_mul_f32 v87, s72, v83
    v_mfma_f32_16x16x32_bf16 v[188:191], a[180:183], v[120:123], v[188:191]
    s_add_u32 s64, s90, 4096
    v_exp_f32 v84, v84
    v_mfma_f32_16x16x32_bf16 v[188:191], a[200:203], v[124:127], v[188:191]
    buffer_load_dwordx4 a[44:47], v14, s[44:47], s64 offen sc1
    v_mfma_f32_16x16x32_bf16 v[188:191], a[220:223], v[96:99], v[188:191]
    v_exp_f32 v85, v85
    v_mfma_f32_16x16x32_bf16 v[204:207], a[144:147], v[112:115], 0
    s_add_u32 m0, s75, 1024
    ds_write_b128 v5, v[244:247] offset:2048
    v_mfma_f32_16x16x32_bf16 v[204:207], a[164:167], v[116:119], v[204:207]
    buffer_load_dwordx4 v21, s[24:27], s14 offen lds
    v_mfma_f32_16x16x32_bf16 v[204:207], a[184:187], v[120:123], v[204:207]
    v_exp_f32 v86, v86
    v_mfma_f32_16x16x32_bf16 v[204:207], a[204:207], v[124:127], v[204:207]
    v_exp_f32 v87, v87
    v_mfma_f32_16x16x32_bf16 v[204:207], a[224:227], v[96:99], v[204:207]
    v_add_f32 v84, 1.0, v84
    v_add_f32 v85, 1.0, v85
    s_waitcnt vmcnt(13)
    v_mfma_f32_16x16x32_bf16 v[156:159], a[128:131], a[0:3], 0
    s_add_u32 s58, s90, 8192
    ds_write_b128 v5, v[188:191] offset:3072
    s_waitcnt vmcnt(12)
    v_mfma_f32_16x16x32_bf16 v[156:159], a[148:151], a[4:7], v[156:159]
    buffer_load_dwordx4 a[48:51], v14, s[44:47], s58 offen sc1
    s_waitcnt vmcnt(12)
    v_mfma_f32_16x16x32_bf16 v[156:159], a[168:171], a[8:11], v[156:159]
    s_add_u32 m0, s75, 2048
    v_add_f32 v86, 1.0, v86
    v_add_f32 v87, 1.0, v87
    s_waitcnt vmcnt(11)
    v_mfma_f32_16x16x32_bf16 v[156:159], a[188:191], a[12:15], v[156:159]
    buffer_load_dwordx4 v26, s[24:27], s14 offen lds
    s_waitcnt vmcnt(11)
    v_mfma_f32_16x16x32_bf16 v[156:159], a[208:211], a[16:19], v[156:159]
    v_rcp_f32 v84, v84
    v_mfma_f32_16x16x32_bf16 v[172:175], a[132:135], a[0:3], 0
    s_add_u32 s64, s90, 12288
    ds_write_b128 v5, v[204:207] offset:4096
    v_mfma_f32_16x16x32_bf16 v[172:175], a[152:155], a[4:7], v[172:175]
    buffer_load_dwordx4 a[52:55], v14, s[44:47], s64 offen sc1
    v_mfma_f32_16x16x32_bf16 v[172:175], a[172:175], a[8:11], v[172:175]
    v_rcp_f32 v85, v85
    v_mfma_f32_16x16x32_bf16 v[172:175], a[192:195], a[12:15], v[172:175]
    v_rcp_f32 v86, v86
    v_mfma_f32_16x16x32_bf16 v[172:175], a[212:215], a[16:19], v[172:175]
    v_rcp_f32 v87, v87
    v_mfma_f32_16x16x32_bf16 v[248:251], a[136:139], a[0:3], 0
    s_add_u32 s58, s90, 16384
    ds_write_b128 v6, v[156:159] offset:0
    v_mfma_f32_16x16x32_bf16 v[248:251], a[156:159], a[4:7], v[248:251]
    buffer_load_dwordx4 a[56:59], v14, s[44:47], s58 offen sc1
    v_mfma_f32_16x16x32_bf16 v[248:251], a[176:179], a[8:11], v[248:251]
    v_mul_f32 v80, v80, v84
    v_mul_f32 v81, v81, v85
    v_mfma_f32_16x16x32_bf16 v[248:251], a[196:199], a[12:15], v[248:251]
    v_mul_f32 v82, v82, v86
    v_mul_f32 v83, v83, v87
    v_mfma_f32_16x16x32_bf16 v[248:251], a[216:219], a[16:19], v[248:251]
    s_waitcnt lgkmcnt(8)
    v_add_f32 v216, v216, v220
    s_waitcnt lgkmcnt(6)
    v_add_f32 v224, v224, v228
    v_mfma_f32_16x16x32_bf16 v[192:195], a[140:143], a[0:3], 0
    ds_write_b128 v6, v[172:175] offset:1024
    v_mfma_f32_16x16x32_bf16 v[192:195], a[160:163], a[4:7], v[192:195]
    v_add_f32 v217, v217, v221
    v_add_f32 v225, v225, v229
    v_mfma_f32_16x16x32_bf16 v[192:195], a[180:183], a[8:11], v[192:195]
    v_add_f32 v218, v218, v222
    v_add_f32 v226, v226, v230
    v_mfma_f32_16x16x32_bf16 v[192:195], a[200:203], a[12:15], v[192:195]
    v_add_f32 v219, v219, v223
    v_add_f32 v227, v227, v231
    v_mfma_f32_16x16x32_bf16 v[192:195], a[220:223], a[16:19], v[192:195]
    v_add_f32 v216, v216, v224
    v_add_f32 v217, v217, v225
    v_mfma_f32_16x16x32_bf16 v[208:211], a[144:147], a[0:3], 0
    ds_write_b128 v6, v[248:251] offset:2048
    v_mfma_f32_16x16x32_bf16 v[208:211], a[164:167], a[4:7], v[208:211]
    v_add_f32 v218, v218, v226
    v_add_f32 v219, v219, v227
    v_mfma_f32_16x16x32_bf16 v[208:211], a[184:187], a[8:11], v[208:211]
    v_mul_f32 v220, s72, v216
    v_mul_f32 v221, s72, v217
    v_mfma_f32_16x16x32_bf16 v[208:211], a[204:207], a[12:15], v[208:211]
    v_mul_f32 v222, s72, v218
    v_mul_f32 v223, s72, v219
    v_mfma_f32_16x16x32_bf16 v[208:211], a[224:227], a[16:19], v[208:211]
    v_exp_f32 v220, v220
    s_waitcnt vmcnt(12)
    v_mfma_f32_16x16x32_bf16 v[160:163], a[128:131], a[20:23], 0
    ds_write_b128 v6, v[192:195] offset:3072
    s_waitcnt vmcnt(11)
    v_mfma_f32_16x16x32_bf16 v[160:163], a[148:151], a[24:27], v[160:163]
    v_exp_f32 v221, v221
    s_waitcnt vmcnt(10)
    v_mfma_f32_16x16x32_bf16 v[160:163], a[168:171], a[28:31], v[160:163]
    v_exp_f32 v222, v222
    s_waitcnt vmcnt(9)
    v_mfma_f32_16x16x32_bf16 v[160:163], a[188:191], a[32:35], v[160:163]
    v_exp_f32 v223, v223
    s_waitcnt vmcnt(8)
    v_mfma_f32_16x16x32_bf16 v[160:163], a[208:211], a[36:39], v[160:163]
    v_add_f32 v220, 1.0, v220
    v_add_f32 v221, 1.0, v221
    v_mfma_f32_16x16x32_bf16 v[176:179], a[132:135], a[20:23], 0
    ds_write_b128 v6, v[208:211] offset:4096
    v_mfma_f32_16x16x32_bf16 v[176:179], a[152:155], a[24:27], v[176:179]
    v_add_f32 v222, 1.0, v222
    v_add_f32 v223, 1.0, v223
    v_mfma_f32_16x16x32_bf16 v[176:179], a[172:175], a[28:31], v[176:179]
    v_rcp_f32 v220, v220
    v_mfma_f32_16x16x32_bf16 v[176:179], a[192:195], a[32:35], v[176:179]
    v_rcp_f32 v221, v221
    v_mfma_f32_16x16x32_bf16 v[176:179], a[212:215], a[36:39], v[176:179]
    v_rcp_f32 v222, v222
    v_mfma_f32_16x16x32_bf16 v[252:255], a[136:139], a[20:23], 0
    ds_write_b128 v7, v[160:163] offset:0
    v_mfma_f32_16x16x32_bf16 v[252:255], a[156:159], a[24:27], v[252:255]
    v_rcp_f32 v223, v223
    v_mfma_f32_16x16x32_bf16 v[252:255], a[176:179], a[28:31], v[252:255]
    v_mul_f32 v216, v216, v220
    v_mul_f32 v217, v217, v221
    v_mfma_f32_16x16x32_bf16 v[252:255], a[196:199], a[32:35], v[252:255]
    v_mul_f32 v218, v218, v222
    v_mul_f32 v219, v219, v223
    v_mfma_f32_16x16x32_bf16 v[252:255], a[216:219], a[36:39], v[252:255]
    v_mfma_f32_16x16x32_bf16 v[196:199], a[140:143], a[20:23], 0
    ds_write_b128 v7, v[176:179] offset:1024
    v_mfma_f32_16x16x32_bf16 v[196:199], a[160:163], a[24:27], v[196:199]
    v_mfma_f32_16x16x32_bf16 v[196:199], a[180:183], a[28:31], v[196:199]
    v_mfma_f32_16x16x32_bf16 v[196:199], a[200:203], a[32:35], v[196:199]
    v_mfma_f32_16x16x32_bf16 v[196:199], a[220:223], a[36:39], v[196:199]
    v_mfma_f32_16x16x32_bf16 v[212:215], a[144:147], a[20:23], 0
    s_nop 0
    ds_write_b128 v7, v[252:255] offset:2048
    v_mfma_f32_16x16x32_bf16 v[212:215], a[164:167], a[24:27], v[212:215]
    v_mfma_f32_16x16x32_bf16 v[212:215], a[184:187], a[28:31], v[212:215]
    v_mfma_f32_16x16x32_bf16 v[212:215], a[204:207], a[32:35], v[212:215]
    v_mfma_f32_16x16x32_bf16 v[212:215], a[224:227], a[36:39], v[212:215]
    s_waitcnt vmcnt(7)
    v_mfma_f32_16x16x32_bf16 v[148:151], a[128:131], a[40:43], 0
    ds_write_b128 v7, v[196:199] offset:3072
    s_waitcnt vmcnt(5)
    v_mfma_f32_16x16x32_bf16 v[148:151], a[148:151], a[44:47], v[148:151]
    s_waitcnt vmcnt(3)
    v_mfma_f32_16x16x32_bf16 v[148:151], a[168:171], a[48:51], v[148:151]
    s_waitcnt vmcnt(2)
    ds_read_b64 v[232:233], v27 offset:0
    ds_read_b64 v[234:235], v27 offset:32
    ds_read_b64 v[236:237], v27 offset:64
    ds_read_b64 v[238:239], v27 offset:96
    ds_read_b64 v[144:145], v27 offset:128
    s_waitcnt vmcnt(1)
    v_mfma_f32_16x16x32_bf16 v[148:151], a[188:191], a[52:55], v[148:151]
    s_waitcnt vmcnt(0)
    v_mfma_f32_16x16x32_bf16 v[148:151], a[208:211], a[56:59], v[148:151]
    v_mfma_f32_16x16x32_bf16 v[164:167], a[132:135], a[40:43], 0
    ds_write_b128 v7, v[212:215] offset:4096
    v_mfma_f32_16x16x32_bf16 v[164:167], a[152:155], a[44:47], v[164:167]
    s_waitcnt lgkmcnt(5)
    v_lshlrev_b32 v36, 16, v232
    v_and_b32 v37, s62, v232
    v_mfma_f32_16x16x32_bf16 v[164:167], a[172:175], a[48:51], v[164:167]
    v_lshlrev_b32 v38, 16, v233
    v_and_b32 v39, s62, v233
    v_mfma_f32_16x16x32_bf16 v[164:167], a[192:195], a[52:55], v[164:167]
    s_waitcnt lgkmcnt(4)
    v_lshlrev_b32 v52, 16, v234
    v_and_b32 v53, s62, v234
    v_mfma_f32_16x16x32_bf16 v[164:167], a[212:215], a[56:59], v[164:167]
    s_waitcnt lgkmcnt(0)
    s_barrier
    ds_read_b128 v[152:155], v20 offset:0
    ds_read_b128 v[156:159], v20 offset:5120
    v_mfma_f32_16x16x32_bf16 v[240:243], a[136:139], a[40:43], 0
    ds_read_b128 v[160:163], v20 offset:10240
    v_lshlrev_b32 v54, 16, v235
    v_mfma_f32_16x16x32_bf16 v[240:243], a[156:159], a[44:47], v[240:243]
    ds_read_b128 v[168:171], v20 offset:1024
    ds_read_b128 v[172:175], v20 offset:6144
    v_mfma_f32_16x16x32_bf16 v[240:243], a[176:179], a[48:51], v[240:243]
    ds_read_b128 v[176:179], v20 offset:11264
    v_and_b32 v55, s62, v235
    v_mfma_f32_16x16x32_bf16 v[240:243], a[196:199], a[52:55], v[240:243]
    ds_read_b128 v[244:247], v20 offset:2048
    v_lshlrev_b32 v68, 16, v236
    v_mfma_f32_16x16x32_bf16 v[240:243], a[216:219], a[56:59], v[240:243]
    ds_read_b128 v[248:251], v20 offset:7168
    ds_read_b128 v[252:255], v20 offset:12288
    v_mfma_f32_16x16x32_bf16 v[184:187], a[140:143], a[40:43], 0
    ds_read_b128 v[188:191], v20 offset:3072
    v_and_b32 v69, s62, v236
    v_mfma_f32_16x16x32_bf16 v[184:187], a[160:163], a[44:47], v[184:187]
    ds_read_b128 v[192:195], v20 offset:8192
    v_lshlrev_b32 v70, 16, v237
    v_mfma_f32_16x16x32_bf16 v[184:187], a[180:183], a[48:51], v[184:187]
    ds_read_b128 v[196:199], v20 offset:13312
    ds_read_b128 v[204:207], v20 offset:4096
    v_mfma_f32_16x16x32_bf16 v[184:187], a[200:203], a[52:55], v[184:187]
    ds_read_b128 v[208:211], v20 offset:9216
    v_and_b32 v71, s62, v237
    v_mfma_f32_16x16x32_bf16 v[184:187], a[220:223], a[56:59], v[184:187]
    ds_read_b128 v[212:215], v20 offset:14336
    v_lshlrev_b32 v84, 16, v238
    v_mfma_f32_16x16x32_bf16 v[200:203], a[144:147], a[40:43], 0
    v_and_b32 v85, s62, v238
    v_lshlrev_b32 v86, 16, v239
    v_mfma_f32_16x16x32_bf16 v[200:203], a[164:167], a[44:47], v[200:203]
    v_and_b32 v87, s62, v239
    v_lshlrev_b32 v220, 16, v144
    v_mfma_f32_16x16x32_bf16 v[200:203], a[184:187], a[48:51], v[200:203]
    v_and_b32 v221, s62, v144
    v_lshlrev_b32 v222, 16, v145
    v_mfma_f32_16x16x32_bf16 v[200:203], a[204:207], a[52:55], v[200:203]
    v_and_b32 v223, s62, v145
    v_mfma_f32_16x16x32_bf16 v[200:203], a[224:227], a[56:59], v[200:203]
    s_waitcnt lgkmcnt(14)
    v_pk_fma_f32 v[36:37], v[152:153], v[32:33], v[36:37]
    v_pk_fma_f32 v[38:39], v[154:155], v[34:35], v[38:39]
    s_waitcnt lgkmcnt(13)
    v_pk_fma_f32 v[36:37], v[156:157], v[32:33], v[36:37]
    v_pk_fma_f32 v[38:39], v[158:159], v[34:35], v[38:39]
    s_waitcnt lgkmcnt(12)
    v_pk_fma_f32 v[36:37], v[160:161], v[32:33], v[36:37]
    v_pk_fma_f32 v[38:39], v[162:163], v[34:35], v[38:39]
    v_pk_fma_f32 v[36:37], v[148:149], v[32:33], v[36:37]
    v_pk_fma_f32 v[38:39], v[150:151], v[34:35], v[38:39]
    v_cvt_pk_bf16_f32 v148, v36, v37
    v_cvt_pk_bf16_f32 v149, v38, v39
    ds_write_b64 v8, v[148:149] offset:0
    s_waitcnt lgkmcnt(12)
    v_pk_fma_f32 v[52:53], v[168:169], v[48:49], v[52:53]
    v_pk_fma_f32 v[54:55], v[170:171], v[50:51], v[54:55]
    s_waitcnt lgkmcnt(11)
    v_pk_fma_f32 v[52:53], v[172:173], v[48:49], v[52:53]
    v_pk_fma_f32 v[54:55], v[174:175], v[50:51], v[54:55]
    s_waitcnt lgkmcnt(10)
    v_pk_fma_f32 v[52:53], v[176:177], v[48:49], v[52:53]
    v_pk_fma_f32 v[54:55], v[178:179], v[50:51], v[54:55]
    v_pk_fma_f32 v[52:53], v[164:165], v[48:49], v[52:53]
    v_pk_fma_f32 v[54:55], v[166:167], v[50:51], v[54:55]
    v_cvt_pk_bf16_f32 v164, v52, v53
    v_cvt_pk_bf16_f32 v165, v54, v55
    ds_write_b64 v8, v[164:165] offset:32
    s_waitcnt lgkmcnt(10)
    v_pk_fma_f32 v[68:69], v[244:245], v[64:65], v[68:69]
    v_pk_fma_f32 v[70:71], v[246:247], v[66:67], v[70:71]
    s_waitcnt lgkmcnt(9)
    v_pk_fma_f32 v[68:69], v[248:249], v[64:65], v[68:69]
    v_pk_fma_f32 v[70:71], v[250:251], v[66:67], v[70:71]
    s_waitcnt lgkmcnt(8)
    v_pk_fma_f32 v[68:69], v[252:253], v[64:65], v[68:69]
    v_pk_fma_f32 v[70:71], v[254:255], v[66:67], v[70:71]
    v_pk_fma_f32 v[68:69], v[240:241], v[64:65], v[68:69]
    v_pk_fma_f32 v[70:71], v[242:243], v[66:67], v[70:71]
    v_cvt_pk_bf16_f32 v240, v68, v69
    v_cvt_pk_bf16_f32 v241, v70, v71
    ds_write_b64 v8, v[240:241] offset:64
    s_waitcnt lgkmcnt(8)
    v_pk_fma_f32 v[84:85], v[188:189], v[80:81], v[84:85]
    v_pk_fma_f32 v[86:87], v[190:191], v[82:83], v[86:87]
    s_waitcnt lgkmcnt(7)
    v_pk_fma_f32 v[84:85], v[192:193], v[80:81], v[84:85]
    v_pk_fma_f32 v[86:87], v[194:195], v[82:83], v[86:87]
    s_waitcnt lgkmcnt(6)
    v_pk_fma_f32 v[84:85], v[196:197], v[80:81], v[84:85]
    v_pk_fma_f32 v[86:87], v[198:199], v[82:83], v[86:87]
    v_pk_fma_f32 v[84:85], v[184:185], v[80:81], v[84:85]
    v_pk_fma_f32 v[86:87], v[186:187], v[82:83], v[86:87]
    v_cvt_pk_bf16_f32 v184, v84, v85
    v_cvt_pk_bf16_f32 v185, v86, v87
    ds_write_b64 v8, v[184:185] offset:96
    s_waitcnt lgkmcnt(6)
    v_pk_fma_f32 v[220:221], v[204:205], v[216:217], v[220:221]
    v_pk_fma_f32 v[222:223], v[206:207], v[218:219], v[222:223]
    s_waitcnt lgkmcnt(5)
    v_pk_fma_f32 v[220:221], v[208:209], v[216:217], v[220:221]
    v_pk_fma_f32 v[222:223], v[210:211], v[218:219], v[222:223]
    s_waitcnt lgkmcnt(4)
    v_pk_fma_f32 v[220:221], v[212:213], v[216:217], v[220:221]
    v_pk_fma_f32 v[222:223], v[214:215], v[218:219], v[222:223]
    v_pk_fma_f32 v[220:221], v[200:201], v[216:217], v[220:221]
    v_pk_fma_f32 v[222:223], v[202:203], v[218:219], v[222:223]
    v_cvt_pk_bf16_f32 v200, v220, v221
    v_cvt_pk_bf16_f32 v201, v222, v223
    ds_write_b64 v8, v[200:201] offset:128
    ds_read_b128 v[96:99], v28
    ds_read_b128 v[100:103], v29
    ds_read_b128 v[104:107], v12
    s_waitcnt lgkmcnt(2)
    buffer_store_dwordx4 v[96:99], v2, s[40:43], s14 offen
    s_waitcnt lgkmcnt(1)
    buffer_store_dwordx4 v[100:103], v21, s[40:43], s14 offen
    s_waitcnt lgkmcnt(0)
    buffer_store_dwordx4 v[104:107], v26, s[40:43], s14 offen
L_end:
    s_endpgm
L_retry0:
    s_mov_b32 s65, 0x40000
L_spin0:
    s_sleep 12
    buffer_load_dword v19, v9, s[48:51], 0 offen sc1
    s_waitcnt vmcnt(0)
    v_cmp_ne_u32 vcc, 1, v19
    s_nop 1
    s_sub_u32 s65, s65, 1
    s_cbranch_scc1 L_cont0
    s_cbranch_vccnz L_spin0
    s_branch L_cont0
L_retry1:
    s_mov_b32 s65, 0x40000
L_spin1:
    s_sleep 12
    buffer_load_dword v19, v21, s[44:47], 0 offen sc1
    s_waitcnt vmcnt(0)
    v_cmp_ne_u32 vcc, 1, v19
    s_nop 1
    s_sub_u32 s65, s65, 1
    s_cbranch_scc1 L_cont1
    s_cbranch_vccnz L_spin1
    s_branch L_cont1
L_retry2:
    s_mov_b32 s65, 0x40000
L_spin2:
    s_sleep 2
    buffer_load_dword v19, v20, s[44:47], 0 offen offset:1024 sc1
    s_waitcnt vmcnt(0)
    v_cmp_ne_u32 vcc, 1, v19
    s_nop 1
    s_sub_u32 s65, s65, 1
    s_cbranch_scc1 L_cont2
    s_cbranch_vccnz L_spin2
    s_branch L_cont2
L_redo:
    s_cmp_lg_u32 s100, 0
    s_cbranch_scc1 L_ok
    s_mov_b32 s100, 1
    s_waitcnt vmcnt(0) lgkmcnt(0)
    s_nop 15
    v_mov_b32 v22, 0xf1800000
    s_mov_b32 s68, 0xffffffff
    s_mov_b32 s69, 0xfffffff0
    v_cndmask_b32 v96, 0, v22, s[68:69]
    v_cndmask_b32 v112, v22, 0, s[68:69]
    s_mov_b32 s70, 0xfffffffe
    s_mov_b32 s71, 0xffffffe0
    v_cndmask_b32 v97, 0, v22, s[70:71]
    v_cndmask_b32 v113, v22, 0, s[70:71]
    s_mov_b32 s68, 0xfffffffc
    s_mov_b32 s69, 0xffffffc0
    v_cndmask_b32 v98, 0, v22, s[68:69]
    v_cndmask_b32 v114, v22, 0, s[68:69]
    s_mov_b32 s70, 0xfffffff8
    s_mov_b32 s71, 0xffffff80
    v_cndmask_b32 v99, 0, v22, s[70:71]
    v_cndmask_b32 v115, v22, 0, s[70:71]
    s_mov_b32 s68, 0xffffff00
    s_mov_b32 s69, 0xfffff000
    v_cndmask_b32 v100, 0, v22, s[68:69]
    v_cndmask_b32 v116, v22, 0, s[68:69]
    s_mov_b32 s70, 0xfffffe00
    s_mov_b32 s71, 0xffffe000
    v_cndmask_b32 v101, 0, v22, s[70:71]
    v_cndmask_b32 v117, v22, 0, s[70:71]
    s_mov_b32 s68, 0xfffffc00
    s_mov_b32 s69, 0xffffc000
    v_cndmask_b32 v102, 0, v22, s[68:69]
    v_cndmask_b32 v118, v22, 0, s[68:69]
    s_mov_b32 s70, 0xfffff800
    s_mov_b32 s71, 0xffff8000
    v_cndmask_b32 v103, 0, v22, s[70:71]
    v_cndmask_b32 v119, v22, 0, s[70:71]
    s_mov_b32 s68, 0xffff0000
    s_mov_b32 s69, 0xfff00000
    v_cndmask_b32 v104, 0, v22, s[68:69]
    v_cndmask_b32 v120, v22, 0, s[68:69]
    s_mov_b32 s70, 0xfffe0000
    s_mov_b32 s71, 0xffe00000
    v_cndmask_b32 v105, 0, v22, s[70:71]
    v_cndmask_b32 v121, v22, 0, s[70:71]
    s_mov_b32 s68, 0xfffc0000
    s_mov_b32 s69, 0xffc00000
    v_cndmask_b32 v106, 0, v22, s[68:69]
    v_cndmask_b32 v122, v22, 0, s[68:69]
    s_mov_b32 s70, 0xfff80000
    s_mov_b32 s71, 0xff800000
    v_cndmask_b32 v107, 0, v22, s[70:71]
    v_cndmask_b32 v123, v22, 0, s[70:71]
    s_mov_b32 s68, 0xff000000
    s_mov_b32 s69, 0xf0000000
    v_cndmask_b32 v108, 0, v22, s[68:69]
    v_cndmask_b32 v124, v22, 0, s[68:69]
    s_mov_b32 s70, 0xfe000000
    s_mov_b32 s71, 0xe0000000
    v_cndmask_b32 v109, 0, v22, s[70:71]
    v_cndmask_b32 v125, v22, 0, s[70:71]
    s_mov_b32 s68, 0xfc000000
    s_mov_b32 s69, 0xc0000000
    v_cndmask_b32 v110, 0, v22, s[68:69]
    v_cndmask_b32 v126, v22, 0, s[68:69]
    s_mov_b32 s70, 0xf8000000
    s_mov_b32 s71, 0x80000000
    v_cndmask_b32 v111, 0, v22, s[70:71]
    v_cndmask_b32 v127, v22, 0, s[70:71]
    ds_read_b128 v[216:219], v2 offset:4096
    ds_read_b128 v[224:227], v21 offset:4096
    ds_read_b128 v[220:223], v2 offset:22528
    s_waitcnt lgkmcnt(2)
    v_mfma_f32_32x32x16_bf16 v[32:47], v[216:219], v[128:131], v[112:127]
    ds_read_b128 v[228:231], v2 offset:0
    ds_read_b128 v[236:239], v21 offset:0
    ds_read_b128 v[232:235], v2 offset:18432
    s_waitcnt lgkmcnt(4)
    v_mfma_f32_32x32x16_bf16 v[32:47], v[224:227], v[140:143], v[32:47]
    s_waitcnt lgkmcnt(3)
    v_mfma_f32_32x32x16_bf16 v[48:63], v[220:223], v[132:135], v[112:127]
    v_mfma_f32_32x32x16_bf16 v[48:63], v[224:227], v[144:147], v[48:63]
    s_waitcnt lgkmcnt(0)
    v_mfma_f32_32x32x16_bf16 v[240:255], v[228:231], v[128:131], v[96:111]
    ds_read_b128 v[216:219], v2 offset:512
    ds_read_b128 v[224:227], v21 offset:512
    ds_read_b128 v[220:223], v2 offset:18944
    s_nop 3
    v_max_f32 v3, v32, v33
    v_max3_f32 v3, v34, v35, v3
    v_max3_f32 v3, v36, v37, v3
    v_mfma_f32_32x32x16_bf16 v[240:255], v[236:239], v[140:143], v[240:255]
    v_max3_f32 v3, v38, v39, v3
    v_max3_f32 v3, v40, v41, v3
    v_max3_f32 v3, v42, v43, v3
    v_max3_f32 v3, v44, v45, v3
    v_max3_f32 v3, v46, v47, v3
    v_mfma_f32_32x32x16_bf16 v[32:47], v[232:235], v[132:135], v[96:111]
    v_max_f32 v4, v48, v49
    v_max3_f32 v4, v50, v51, v4
    v_max3_f32 v4, v52, v53, v4
    v_max3_f32 v4, v54, v55, v4
    v_mfma_f32_32x32x16_bf16 v[32:47], v[236:239], v[144:147], v[32:47]
    s_waitcnt lgkmcnt(0)
    v_max3_f32 v4, v56, v57, v4
    v_max3_f32 v4, v58, v59, v4
    v_max3_f32 v4, v60, v61, v4
    v_max3_f32 v4, v62, v63, v4
    v_mfma_f32_32x32x16_bf16 v[48:63], v[216:219], v[128:131], 0
    ds_read_b128 v[228:231], v2 offset:1024
    ds_read_b128 v[236:239], v21 offset:1024
    ds_read_b128 v[232:235], v2 offset:19456
    v_max3_f32 v3, v240, v241, v3
    v_max3_f32 v3, v242, v243, v3
    v_max3_f32 v3, v244, v245, v3
    v_mfma_f32_32x32x16_bf16 v[48:63], v[224:227], v[140:143], v[48:63]
    v_max3_f32 v3, v246, v247, v3
    v_max3_f32 v3, v248, v249, v3
    v_max3_f32 v3, v250, v251, v3
    v_max3_f32 v3, v252, v253, v3
    v_max3_f32 v3, v254, v255, v3
    v_mfma_f32_32x32x16_bf16 v[240:255], v[220:223], v[132:135], 0
    v_max3_f32 v4, v32, v33, v4
    v_max3_f32 v4, v34, v35, v4
    v_max3_f32 v4, v36, v37, v4
    v_max3_f32 v4, v38, v39, v4
    v_mfma_f32_32x32x16_bf16 v[240:255], v[224:227], v[144:147], v[240:255]
    s_waitcnt lgkmcnt(0)
    v_max3_f32 v4, v40, v41, v4
    v_max3_f32 v4, v42, v43, v4
    v_max3_f32 v4, v44, v45, v4
    v_max3_f32 v4, v46, v47, v4
    v_mfma_f32_32x32x16_bf16 v[32:47], v[228:231], v[128:131], 0
    ds_read_b128 v[216:219], v2 offset:1536
    ds_read_b128 v[224:227], v21 offset:1536
    ds_read_b128 v[220:223], v2 offset:19968
    v_max3_f32 v3, v48, v49, v3
    v_max3_f32 v3, v50, v51, v3
    v_max3_f32 v3, v52, v53, v3
    v_mfma_f32_32x32x16_bf16 v[32:47], v[236:239], v[140:143], v[32:47]
    v_max3_f32 v3, v54, v55, v3
    v_max3_f32 v3, v56, v57, v3
    v_max3_f32 v3, v58, v59, v3
    v_max3_f32 v3, v60, v61, v3
    v_max3_f32 v3, v62, v63, v3
    v_mfma_f32_32x32x16_bf16 v[48:63], v[232:235], v[132:135], 0
    v_max3_f32 v4, v240, v241, v4
    v_max3_f32 v4, v242, v243, v4
    v_max3_f32 v4, v244, v245, v4
    v_max3_f32 v4, v246, v247, v4
    v_mfma_f32_32x32x16_bf16 v[48:63], v[236:239], v[144:147], v[48:63]
    s_waitcnt lgkmcnt(0)
    v_max3_f32 v4, v248, v249, v4
    v_max3_f32 v4, v250, v251, v4
    v_max3_f32 v4, v252, v253, v4
    v_max3_f32 v4, v254, v255, v4
    v_mfma_f32_32x32x16_bf16 v[240:255], v[216:219], v[128:131], 0
    ds_read_b128 v[228:231], v2 offset:2048
    ds_read_b128 v[236:239], v21 offset:2048
    ds_read_b128 v[232:235], v2 offset:20480
    v_max3_f32 v3, v32, v33, v3
    v_max3_f32 v3, v34, v35, v3
    v_max3_f32 v3, v36, v37, v3
    v_mfma_f32_32x32x16_bf16 v[240:255], v[224:227], v[140:143], v[240:255]
    v_max3_f32 v3, v38, v39, v3
    v_max3_f32 v3, v40, v41, v3
    v_max3_f32 v3, v42, v43, v3
    v_max3_f32 v3, v44, v45, v3
    v_max3_f32 v3, v46, v47, v3
    v_mfma_f32_32x32x16_bf16 v[32:47], v[220:223], v[132:135], 0
    v_max3_f32 v4, v48, v49, v4
    v_max3_f32 v4, v50, v51, v4
    v_max3_f32 v4, v52, v53, v4
    v_max3_f32 v4, v54, v55, v4
    v_mfma_f32_32x32x16_bf16 v[32:47], v[224:227], v[144:147], v[32:47]
    s_waitcnt lgkmcnt(0)
    v_max3_f32 v4, v56, v57, v4
    v_max3_f32 v4, v58, v59, v4
    v_max3_f32 v4, v60, v61, v4
    v_max3_f32 v4, v62, v63, v4
    v_mfma_f32_32x32x16_bf16 v[48:63], v[228:231], v[128:131], 0
    ds_read_b128 v[216:219], v2 offset:2560
    ds_read_b128 v[224:227], v21 offset:2560
    ds_read_b128 v[220:223], v2 offset:20992
    v_max3_f32 v3, v240, v241, v3
    v_max3_f32 v3, v242, v243, v3
    v_max3_f32 v3, v244, v245, v3
    v_mfma_f32_32x32x16_bf16 v[48:63], v[236:239], v[140:143], v[48:63]
    v_max3_f32 v3, v246, v247, v3
    v_max3_f32 v3, v248, v249, v3
    v_max3_f32 v3, v250, v251, v3
    v_max3_f32 v3, v252, v253, v3
    v_max3_f32 v3, v254, v255, v3
    v_mfma_f32_32x32x16_bf16 v[240:255], v[232:235], v[132:135], 0
    v_max3_f32 v4, v32, v33, v4
    v_max3_f32 v4, v34, v35, v4
    v_max3_f32 v4, v36, v37, v4
    v_max3_f32 v4, v38, v39, v4
    v_mfma_f32_32x32x16_bf16 v[240:255], v[236:239], v[144:147], v[240:255]
    s_waitcnt lgkmcnt(0)
    v_max3_f32 v4, v40, v41, v4
    v_max3_f32 v4, v42, v43, v4
    v_max3_f32 v4, v44, v45, v4
    v_max3_f32 v4, v46, v47, v4
    v_mfma_f32_32x32x16_bf16 v[32:47], v[216:219], v[128:131], 0
    ds_read_b128 v[228:231], v2 offset:3072
    ds_read_b128 v[236:239], v21 offset:3072
    ds_read_b128 v[232:235], v2 offset:21504
    v_max3_f32 v3, v48, v49, v3
    v_max3_f32 v3, v50, v51, v3
    v_max3_f32 v3, v52, v53, v3
    v_mfma_f32_32x32x16_bf16 v[32:47], v[224:227], v[140:143], v[32:47]
    v_max3_f32 v3, v54, v55, v3
    v_max3_f32 v3, v56, v57, v3
    v_max3_f32 v3, v58, v59, v3
    v_max3_f32 v3, v60, v61, v3
    v_max3_f32 v3, v62, v63, v3
    v_mfma_f32_32x32x16_bf16 v[48:63], v[220:223], v[132:135], 0
    v_max3_f32 v4, v240, v241, v4
    v_max3_f32 v4, v242, v243, v4
    v_max3_f32 v4, v244, v245, v4
    v_max3_f32 v4, v246, v247, v4
    v_mfma_f32_32x32x16_bf16 v[48:63], v[224:227], v[144:147], v[48:63]
    s_waitcnt lgkmcnt(0)
    v_max3_f32 v4, v248, v249, v4
    v_max3_f32 v4, v250, v251, v4
    v_max3_f32 v4, v252, v253, v4
    v_max3_f32 v4, v254, v255, v4
    v_mfma_f32_32x32x16_bf16 v[240:255], v[228:231], v[128:131], 0
    ds_read_b128 v[216:219], v2 offset:3584
    ds_read_b128 v[224:227], v21 offset:3584
    ds_read_b128 v[220:223], v2 offset:22016
    v_max3_f32 v3, v32, v33, v3
    v_max3_f32 v3, v34, v35, v3
    v_max3_f32 v3, v36, v37, v3
    v_mfma_f32_32x32x16_bf16 v[240:255], v[236:239], v[140:143], v[240:255]
    v_max3_f32 v3, v38, v39, v3
    v_max3_f32 v3, v40, v41, v3
    v_max3_f32 v3, v42, v43, v3
    v_max3_f32 v3, v44, v45, v3
    v_max3_f32 v3, v46, v47, v3
    v_mfma_f32_32x32x16_bf16 v[32:47], v[232:235], v[132:135], 0
    v_max3_f32 v4, v48, v49, v4
    v_max3_f32 v4, v50, v51, v4
    v_max3_f32 v4, v52, v53, v4
    v_max3_f32 v4, v54, v55, v4
    v_mfma_f32_32x32x16_bf16 v[32:47], v[236:239], v[144:147], v[32:47]
    s_waitcnt lgkmcnt(0)
    v_max3_f32 v4, v56, v57, v4
    v_max3_f32 v4, v58, v59, v4
    v_max3_f32 v4, v60, v61, v4
    v_max3_f32 v4, v62, v63, v4
    v_mfma_f32_32x32x16_bf16 v[48:63], v[216:219], v[128:131], 0
    v_max3_f32 v3, v240, v241, v3
    v_max3_f32 v3, v242, v243, v3
    v_max3_f32 v3, v244, v245, v3
    v_mfma_f32_32x32x16_bf16 v[48:63], v[224:227], v[140:143], v[48:63]
    v_max3_f32 v3, v246, v247, v3
    v_max3_f32 v3, v248, v249, v3
    v_max3_f32 v3, v250, v251, v3
    v_max3_f32 v3, v252, v253, v3
    v_max3_f32 v3, v254, v255, v3
    v_mfma_f32_32x32x16_bf16 v[240:255], v[220:223], v[132:135], 0
    v_max3_f32 v4, v32, v33, v4
    v_max3_f32 v4, v34, v35, v4
    v_max3_f32 v4, v36, v37, v4
    v_max3_f32 v4, v38, v39, v4
    v_mfma_f32_32x32x16_bf16 v[240:255], v[224:227], v[144:147], v[240:255]
    ds_read_b128 v[216:219], v2 offset:4096
    ds_read_b128 v[224:227], v21 offset:4096
    ds_read_b128 v[220:223], v2 offset:22528
    v_max3_f32 v4, v40, v41, v4
    v_max3_f32 v4, v42, v43, v4
    v_max3_f32 v4, v44, v45, v4
    v_max3_f32 v4, v46, v47, v4
    v_max3_f32 v3, v48, v49, v3
    v_max3_f32 v3, v50, v51, v3
    v_max3_f32 v3, v52, v53, v3
    v_max3_f32 v3, v54, v55, v3
    v_max3_f32 v3, v56, v57, v3
    v_max3_f32 v3, v58, v59, v3
    v_max3_f32 v3, v60, v61, v3
    v_max3_f32 v3, v62, v63, v3
    v_max3_f32 v4, v240, v241, v4
    v_max3_f32 v4, v242, v243, v4
    v_max3_f32 v4, v244, v245, v4
    v_max3_f32 v4, v246, v247, v4
    v_max3_f32 v4, v248, v249, v4
    v_max3_f32 v4, v250, v251, v4
    v_max3_f32 v4, v252, v253, v4
    v_max3_f32 v4, v254, v255, v4
    v_mov_b32 v22, v3
    v_mov_b32 v24, v4
    s_nop 0
    v_permlane32_swap_b32 v3, v22
    v_permlane32_swap_b32 v4, v24
    v_min_f32_e64 v3, -v3, -v22
    v_and_b32 v22, s62, v3
    v_sub_f32 v23, v3, v22
    v_or_b32 v22, 0x3f80, v22
    v_cvt_pk_bf16_f32 v23, v23, 0
    v_cndmask_b32 v140, v140, v22, s[66:67]
    v_cndmask_b32 v141, v141, v23, s[66:67]
    v_min_f32_e64 v4, -v4, -v24
    v_and_b32 v24, s62, v4
    v_sub_f32 v25, v4, v24
    v_or_b32 v24, 0x3f80, v24
    v_cvt_pk_bf16_f32 v25, v25, 0
    v_cndmask_b32 v144, v144, v24, s[66:67]
    v_cndmask_b32 v145, v145, v25, s[66:67]
    s_mov_b32 s70, 0
    s_mov_b32 s71, 0x7f800000
    s_waitcnt lgkmcnt(0)
    s_nop 3
    s_branch L_stream
L_retry3:
    s_mov_b32 s65, 0x40000
L_spin3:
    s_sleep 2
    buffer_load_dword v19, v9, s[44:47], s11 offen sc1
    s_waitcnt vmcnt(0)
    v_cmp_ne_u32 vcc, 1, v19
    s_nop 1
    s_sub_u32 s65, s65, 1
    s_cbranch_scc1 L_cont3
    s_cbranch_vccnz L_spin3
    s_branch L_cont3
L_retry4:
    s_mov_b32 s65, 0x40000
L_spin4:
    s_sleep 2
    buffer_load_dword v19, v9, s[44:47], s12 offen sc1
    s_waitcnt vmcnt(0)
    v_cmp_ne_u32 vcc, 1, v19
    s_nop 1
    s_sub_u32 s65, s65, 1
    s_cbranch_scc1 L_cont4
    s_cbranch_vccnz L_spin4
    s_branch L_cont4
L_retry5:
    s_mov_b32 s65, 0x40000
L_spin5:
    s_sleep 2
    buffer_load_dword v19, v9, s[44:47], s13 offen sc1
    s_waitcnt vmcnt(0)
    v_cmp_ne_u32 vcc, 1, v19
    s_nop 1
    s_sub_u32 s65, s65, 1
    s_cbranch_scc1 L_cont5
    s_cbranch_vccnz L_spin5
    s_branch L_cont5
L_codeend:
.section .rodata,"a"
.p2align 6
.amdhsa_kernel recurrent_scan__sliding_block__swiglu_ffn__prompt_kernel
  .amdhsa_next_free_vgpr 512
  .amdhsa_next_free_sgpr 102
  .amdhsa_accum_offset 256
  .amdhsa_group_segment_fixed_size 0
  .amdhsa_kernarg_size 80
  .amdhsa_user_sgpr_count 2
  .amdhsa_user_sgpr_kernarg_segment_ptr 1
  .amdhsa_system_sgpr_workgroup_id_x 1
.end_amdhsa_kernel
```
